```python
import torch

def _softmax(x, axis=-1):
    return torch.softmax(x, dim=axis)

def _gelu(x):
    return torch.nn.functional.gelu(x, approximate='tanh')

def _silu(x):
    return torch.nn.functional.silu(x)

def _sigmoid(x):
    return torch.sigmoid(x)

def _layernorm(x, axis=-1, eps=1e-05):
    m = x.mean(dim=axis, keepdim=True)
    v = x.var(dim=axis, keepdim=True, unbiased=False)
    return (x - m) / torch.sqrt(v + eps)

def _scatter_add(tgt, idx, src, axis=0):
    return tgt.clone().index_add_(axis, idx, src)

def _segment_sum(src, seg, n):
    out = torch.zeros((n,) + src.shape[1:], dtype=src.dtype)
    return out.index_add_(0, seg, src)

def _pad(x, pw):
    flat = tuple((v for pair in reversed(pw) for v in pair))
    return torch.nn.functional.pad(x, flat)
kernel_name = 'gated_mix__linear_kernel_hedgehog__mixer_gmlp__prompt'

def setup_inputs():

    _w = lambda a: (lambda t: t.to(torch.bfloat16) if t.is_floating_point() else t)(torch.as_tensor(a))

    def _A_setup():
        B, S, D, H = (1, 2048, 1024, 32)
        Dh = D // H
        return {'x': _w((lambda *s: torch.randn(*s, dtype=torch.bfloat16) * 0.05)(B, S, D)), 'wqkv': _w((lambda *s: torch.randn(*s, dtype=torch.bfloat16) * 1.6)(D, 3 * D)), 'w_phi': _w((lambda *s: torch.randn(*s, dtype=torch.bfloat16) * 1.6)(H, Dh, Dh) * Dh ** (-0.5)), 'wo': _w((lambda *s: torch.randn(*s, dtype=torch.bfloat16) * 0.1)(D, D))}
    _A_in = _A_setup()

    def _B_setup():
        B, S, D, F = (1, 2048, 1024, 3584)
        Fh = F // 2
        return {'x': _w((lambda *s: torch.randn(*s, dtype=torch.bfloat16) * 0.05)(B, S, D)), 'w_in': _w((lambda *s: torch.randn(*s, dtype=torch.bfloat16) * 0.4)(D, 2 * Fh)), 'w_sp': _w(0.01 * (lambda *s: torch.randn(*s, dtype=torch.bfloat16) * 0.4)(S, S)), 'b_sp': _w(1.0 + 0.01 * (lambda *s: torch.randn(*s, dtype=torch.bfloat16) * 0.05)(S)), 'w_out': _w((lambda *s: torch.randn(*s, dtype=torch.bfloat16) * 0.05)(Fh, D))}
    _B_in = _B_setup()
    return {'A_x': _A_in['x'], 'A_wqkv': _A_in['wqkv'], 'A_w_phi': _A_in['w_phi'], 'A_wo': _A_in['wo'], 'B_x': _B_in['x'], 'B_w_in': _B_in['w_in'], 'B_w_sp': _B_in['w_sp'], 'B_b_sp': _B_in['b_sp'], 'B_w_out': _B_in['w_out'], 'gate_w': _w((lambda *s: torch.randn(*s, dtype=torch.bfloat16) * 0.05)(1024) * 16.0)}

def reference(A_x, A_wqkv, A_w_phi, A_wo, B_x, B_w_in, B_w_sp, B_b_sp, B_w_out, gate_w):

    def _A_ref(x, wqkv, w_phi, wo):
        B, S, D = x.shape
        H = 32
        Dh = D // H
        qkv = (lambda x, *d: x.permute(*d))((x @ wqkv).reshape(B, S, 3, H, Dh), 2, 0, 3, 1, 4)
        q, k, v = (qkv[0], qkv[1], qkv[2])
        pq = torch.einsum('bhsd,hdf->bhsf', q, w_phi)
        pk = torch.einsum('bhsd,hdf->bhsf', k, w_phi)
        phi_q = torch.concatenate([_softmax(pq, axis=-1), _softmax(-pq, axis=-1)], axis=-1)
        phi_k = torch.concatenate([_softmax(pk, axis=-1), _softmax(-pk, axis=-1)], axis=-1)
        kv = torch.einsum('bhsf,bhsd->bhfd', phi_k, v)
        z = torch.einsum('bhsf->bhf', phi_k)
        num = torch.einsum('bhqf,bhfd->bhqd', phi_q, kv)
        den = torch.einsum('bhqf,bhf->bhq', phi_q, z)[..., None] + 1e-06
        o = num / den
        return (lambda x, *d: x.permute(*d))(o, 0, 2, 1, 3).reshape(B, S, D) @ wo

    def _B_ref(x, w_in, w_sp, b_sp, w_out):
        B, S, D = x.shape
        F = w_in.shape[-1]
        Fh = F // 2
        z = _gelu(torch.einsum('bsd,df->bsf', x, w_in))
        z1 = z[..., :Fh].clone()
        z2 = _layernorm(z[..., Fh:], axis=-1)
        g = torch.einsum('ts,bsf->btf', w_sp, z2) + b_sp[None, :, None]
        return torch.einsum('bsf,fd->bsd', z1 * g, w_out)
    x = A_x
    g = _sigmoid((x * gate_w).sum(-1, keepdims=True))
    a = _A_ref(x, A_wqkv, A_w_phi, A_wo)
    b = _B_ref(x, B_w_in, B_w_sp, B_b_sp, B_w_out)
    return g * a + (1 - g) * b
```

```asm
; @launch kernel=s1_kernel grid=(256,1,1) block=(512,1,1) lds=158976
; @launch kernel=s2_kernel grid=(256,1,1) block=(512,1,1) lds=131072
; @launch kernel=s3_kernel grid=(256,1,1) block=(512,1,1) lds=98304
.amdgcn_target "amdgcn-amd-amdhsa--gfx950"
.text
.globl s1_kernel
.p2align 8
.type s1_kernel,@function
s1_kernel:
    s_cmp_ge_u32 s2, 256
    s_cbranch_scc1 L_s1_kernel_end
    s_load_dwordx8 s[4:11], s[0:1], 0
    s_load_dwordx4 s[12:15], s[0:1], 40
    s_load_dwordx4 s[16:19], s[0:1], 64
    s_load_dwordx4 s[20:23], s[0:1], 88
    v_lshrrev_b32 v2, 6, v0
    v_and_b32 v1, 63, v0
    v_readfirstlane_b32 s48, v2
    s_and_b32 s68, s2, 7
    s_lshr_b32 s69, s2, 3
    s_and_b32 s70, s68, 1
    s_lshl_b32 s70, s70, 2
    s_and_b32 s71, s69, 3
    s_add_u32 s50, s70, s71
    s_lshr_b32 s69, s69, 2
    s_lshr_b32 s68, s68, 1
    s_lshl_b32 s68, s68, 2
    s_and_b32 s70, s69, 3
    s_add_u32 s68, s68, s70
    s_lshr_b32 s70, s69, 2
    s_lshl_b32 s70, s70, 4
    s_add_u32 s51, s68, s70
    s_and_b32 s52, s51, 1
    s_lshr_b32 s70, s51, 2
    s_xor_b32 s74, s51, 24
    s_cmp_eq_u32 s70, 3
    s_cselect_b32 s71, s74, s51
    s_cmp_eq_u32 s70, 5
    s_cselect_b32 s74, s74, s71
    s_xor_b32 s75, s74, 2
    s_cmp_lt_u32 s51, 16
    s_cselect_b32 s75, s75, s74
    s_and_b32 s49, s48, 3
    v_lshlrev_b32 v22, 4, v1
    s_cmp_ge_u32 s48, 4
    s_cbranch_scc1 L_s1_kernel_gsetup
    s_waitcnt lgkmcnt(0)
    s_lshr_b32 s69, s2, 3
    s_and_b32 s70, s69, 3
    s_lshr_b32 s69, s69, 2
    s_cmp_eq_u32 s49, 0
    s_cbranch_scc0 L_s1_kernel_t1
    s_mov_b32 s40, s4
    s_mov_b32 s41, s5
    s_mov_b32 s42, 4194304
    s_mov_b32 s43, 0x20000
    s_lshl_b32 s68, s50, 8
    s_lshl_b32 s71, s69, 5
    s_add_u32 s68, s68, s71
    v_add_u32 v20, s68, v1
    v_lshlrev_b32 v20, 11, v20
    v_cmp_gt_u32 vcc, 32, v1
    v_mov_b32 v2, 0x40000000
    s_nop 0
    v_cndmask_b32 v20, v2, v20, vcc
    s_mov_b32 s64, 128
    s_branch L_s1_kernel_tdone
L_s1_kernel_t1:
    v_mul_u32_u24 v2, 43, v1
    v_lshrrev_b32 v2, 7, v2
    v_mul_u32_u24 v3, 3, v2
    v_sub_u32 v3, v1, v3
    s_lshl_b32 s68, s70, 4
    v_add_u32 v2, s68, v2
    s_cmp_eq_u32 s49, 1
    s_cbranch_scc0 L_s1_kernel_t2
    s_mov_b32 s40, s6
    s_mov_b32 s41, s7
    s_mov_b32 s42, 6291456
    s_mov_b32 s43, 0x20000
    s_and_b32 s68, s74, 1
    s_lshl_b32 s68, s68, 3
    v_add_u32 v2, s68, v2
    v_cmp_eq_u32 vcc, 0, v3
    v_mul_u32_u24 v20, 6144, v2
    v_lshlrev_b32 v3, 11, v3
    v_add_u32 v20, v20, v3
    s_lshl_b32 s68, s74, 6
    s_lshl_b32 s71, s75, 6
    v_mov_b32 v2, s68
    v_mov_b32 v3, s71
    v_cndmask_b32 v2, v2, v3, vcc
    v_add_u32 v20, v2, v20
    v_cmp_gt_u32 vcc, 24, v1
    v_mov_b32 v2, 0x40000000
    s_nop 0
    v_cndmask_b32 v20, v2, v20, vcc
    s_mov_b32 s64, 393216
    s_branch L_s1_kernel_tdone
L_s1_kernel_t2:
    s_cmp_eq_u32 s49, 2
    s_cbranch_scc0 L_s1_kernel_t3
    s_mov_b32 s40, s12
    s_mov_b32 s41, s13
    s_mov_b32 s42, 7340032
    s_mov_b32 s43, 0x20000
    v_mul_u32_u24 v20, 7168, v2
    v_lshlrev_b32 v3, 7, v3
    v_min_u32 v3, 252, v3
    v_add_u32 v20, v20, v3
    s_mul_i32 s68, s51, 224
    s_lshl_b32 s71, s52, 5
    s_sub_u32 s68, s68, s71
    v_add_u32 v20, s68, v20
    v_cmp_gt_u32 vcc, 48, v1
    v_mov_b32 v2, 0x40000000
    s_nop 0
    v_cndmask_b32 v20, v2, v20, vcc
    s_mov_b32 s64, 458752
    s_branch L_s1_kernel_tdone
L_s1_kernel_t3:
    s_mov_b32 s40, s14
    s_mov_b32 s41, s15
    s_mov_b32 s42, 8388608
    s_mov_b32 s43, 0x20000
    v_lshlrev_b32 v20, 7, v1
    s_lshl_b32 s68, s2, 15
    v_add_u32 v20, s68, v20
    s_mov_b32 s64, 8192
    s_mov_b32 s42, 0
L_s1_kernel_tdone:
    s_mov_b32 s63, 0
    s_cmp_eq_u32 s49, 3
    s_cbranch_scc1 L_s1_kernel_notouch0
    buffer_load_dword v23, v20, s[40:43], s63 offen
    s_add_u32 s63, s63, s64
    buffer_load_dword v23, v20, s[40:43], s63 offen
    s_add_u32 s63, s63, s64
L_s1_kernel_notouch0:
    v_lshrrev_b32 v2, 3, v1
    s_lshl_b32 s68, s50, 8
    s_lshl_b32 s69, s49, 6
    s_add_u32 s68, s68, s69
    v_add_u32 v2, s68, v2
    v_lshlrev_b32 v2, 11, v2
    v_and_b32 v3, 7, v1
    v_lshrrev_b32 v4, 4, v1
    v_xor_b32 v3, v3, v4
    v_lshlrev_b32 v4, 4, v3
    v_add_u32 v10, v2, v4
    v_xor_b32 v4, 64, v4
    v_add_u32 v11, v2, v4
    v_add_u32 v11, 16384, v11
    v_add_u32 v12, 32768, v10
    v_add_u32 v13, 32768, v11
    v_add_u32 v14, 32768, v12
    v_add_u32 v15, 32768, v13
    v_add_u32 v16, 32768, v14
    v_add_u32 v17, 32768, v15
    s_lshl_b32 s57, s49, 13
    s_mov_b32 s53, 0
    s_mov_b32 s24, s4
    s_mov_b32 s25, s5
    s_mov_b32 s26, 4194304
    s_mov_b32 s27, 0x20000
    s_barrier
    s_add_u32 m0, s57, 0
    s_nop 0
    buffer_load_dwordx4 v10, s[24:27], s53 offen  lds
    s_add_u32 m0, s57, 1024
    s_nop 0
    buffer_load_dwordx4 v11, s[24:27], s53 offen  lds
    s_add_u32 m0, s57, 2048
    s_nop 0
    buffer_load_dwordx4 v12, s[24:27], s53 offen  lds
    s_add_u32 m0, s57, 3072
    s_nop 0
    buffer_load_dwordx4 v13, s[24:27], s53 offen  lds
    s_add_u32 m0, s57, 4096
    s_nop 0
    buffer_load_dwordx4 v14, s[24:27], s53 offen  lds
    s_add_u32 m0, s57, 5120
    s_nop 0
    buffer_load_dwordx4 v15, s[24:27], s53 offen  lds
    s_add_u32 m0, s57, 6144
    s_nop 0
    buffer_load_dwordx4 v16, s[24:27], s53 offen  lds
    s_add_u32 m0, s57, 7168
    s_nop 0
    buffer_load_dwordx4 v17, s[24:27], s53 offen  lds
    s_add_u32 s53, s53, 128
    s_mov_b32 s72, 1.0
    s_mov_b32 s73, 1.0
    s_mov_b32 s36, s22
    s_mov_b32 s37, s23
    s_mov_b32 s38, 48013312
    s_mov_b32 s39, 0x20000
    v_and_b32 v2, 15, v1
    v_lshrrev_b32 v3, 1, v2
    v_lshrrev_b32 v4, 4, v1
    v_xor_b32 v3, v3, v4
    v_lshlrev_b32 v2, 7, v2
    s_lshl_b32 s68, s49, 13
    v_add_u32 v2, s68, v2
    v_lshlrev_b32 v4, 4, v3
    v_add_u32 v6, v2, v4
    v_xor_b32 v7, 64, v6
    v_add_u32 v8, 65536, v6
    v_add_u32 v9, 65536, v7
    v_mov_b32 v2, 0
    v_lshlrev_b32 v3, 2, v1
    v_add_u32 v3, 158720, v3
    ds_write_b32 v3, v2
    v_lshrrev_b32 v2, 4, v1
    v_mul_u32_u24 v3, 1536, v2
    v_bfe_u32 v4, v1, 2, 2
    v_lshlrev_b32 v4, 6, v4
    v_add_u32 v3, v3, v4
    v_and_b32 v4, 3, v1
    v_lshlrev_b32 v4, 3, v4
    v_add_u32 v3, v3, v4
    v_and_b32 v2, 1, v2
    v_lshlrev_b32 v2, 5, v2
    v_add_u32 v3, 98304, v3
    v_add_u32 v18, v3, v2
    v_xor_b32 v2, 32, v2
    v_add_u32 v19, v3, v2
    s_cmp_gt_u32 s51, 7
    s_cselect_b32 s69, 2, 0
    s_sub_u32 s68, s51, s69
    s_mul_i32 s69, s50, 12
    s_add_u32 s68, s68, s69
    s_mul_i32 s69, s49, 96
    s_add_u32 s68, s68, s69
    s_and_b32 s69, s51, 0x16
    s_cmp_eq_u32 s69, 6
    s_cselect_b32 s68, 4096, s68
    s_cmp_ge_u32 s51, 16
    s_cselect_b32 s68, 4096, s68
    s_mov_b32 s69, s68
    s_mov_b32 s70, 0
    s_cmp_lt_u32 s69, 128
    s_cselect_b32 s44, s10, s16
    s_cselect_b32 s45, s11, s17
    s_mov_b32 s71, 3670016
    s_cselect_b32 s46, 2097152, s71
    s_mov_b32 s47, 0x20000
    s_cselect_b32 s71, 0, 128
    s_sub_u32 s71, s69, s71
    s_lshl_b32 s71, s71, 14
    s_lshl_b32 s65, s70, 10
    s_add_u32 s65, s65, s71
    s_mul_i32 s66, s70, 2883584
    s_lshl_b32 s71, s69, 10
    s_add_u32 s66, s66, s71
    s_add_u32 s66, s66, 33824768
    s_cmp_lt_u32 s68, 352
    s_cselect_b32 s65, s65, 0x40000000
    s_cselect_b32 s66, s66, 0x40000000
    v_lshrrev_b32 v2, 3, v1
    v_lshrrev_b32 v3, 1, v2
    v_bfe_u32 v4, v1, 1, 2
    v_xor_b32 v4, v4, v3
    v_lshlrev_b32 v4, 5, v4
    v_and_b32 v3, 1, v1
    v_lshlrev_b32 v3, 4, v3
    v_add_u32 v4, v4, v3
    v_lshlrev_b32 v2, 11, v2
    v_add_u32 v21, v2, v4
    s_branch L_s1_kernel_amain
L_s1_kernel_gsetup:
    v_lshrrev_b32 v2, 2, v1
    v_and_b32 v3, 3, v2
    v_lshrrev_b32 v4, 2, v2
    v_and_b32 v5, 3, v1
    s_mul_i32 s71, s51, 224
    s_lshl_b32 s70, s52, 5
    s_sub_u32 s71, s71, s70
    s_cmp_ge_u32 s49, 2
    s_cbranch_scc1 L_s1_kernel_g23
    s_mov_b32 s56, 196608
    s_mul_i32 s68, s49, 12
    s_add_u32 s68, s68, 0
    v_add_u32 v10, s68, v4
    v_mul_u32_u24 v23, 11, v10
    v_lshrrev_b32 v23, 5, v23
    v_mul_u32_u24 v20, 3, v23
    v_sub_u32 v20, v10, v20
    v_cmp_eq_u32 vcc, 0, v20
    v_lshlrev_b32 v20, 11, v20
    v_and_b32 v10, 2, v23
    v_xor_b32 v10, v10, v5
    v_lshlrev_b32 v10, 4, v10
    v_add_u32 v20, v20, v10
    v_lshlrev_b32 v23, 2, v23
    v_add_u32 v23, v23, v3
    v_mul_u32_u24 v23, 6144, v23
    v_add_u32 v20, v20, v23
    s_lshl_b32 s68, s74, 6
    s_lshl_b32 s69, s75, 6
    v_mov_b32 v23, s68
    v_mov_b32 v10, s69
    v_cndmask_b32 v23, v23, v10, vcc
    v_add_u32 v10, v23, v20
    s_mul_i32 s68, s49, 3072
    s_add_u32 s59, s68, 98304
    s_mul_i32 s68, s49, 12
    s_add_u32 s68, s68, 4
    v_add_u32 v11, s68, v4
    v_mul_u32_u24 v23, 11, v11
    v_lshrrev_b32 v23, 5, v23
    v_mul_u32_u24 v20, 3, v23
    v_sub_u32 v20, v11, v20
    v_cmp_eq_u32 vcc, 0, v20
    v_lshlrev_b32 v20, 11, v20
    v_and_b32 v11, 2, v23
    v_xor_b32 v11, v11, v5
    v_lshlrev_b32 v11, 4, v11
    v_add_u32 v20, v20, v11
    v_lshlrev_b32 v23, 2, v23
    v_add_u32 v23, v23, v3
    v_mul_u32_u24 v23, 6144, v23
    v_add_u32 v20, v20, v23
    s_lshl_b32 s68, s74, 6
    s_lshl_b32 s69, s75, 6
    v_mov_b32 v23, s68
    v_mov_b32 v11, s69
    v_cndmask_b32 v23, v23, v11, vcc
    v_add_u32 v11, v23, v20
    s_mul_i32 s68, s49, 3072
    s_add_u32 s60, s68, 99328
    s_mul_i32 s68, s49, 12
    s_add_u32 s68, s68, 8
    v_add_u32 v12, s68, v4
    v_mul_u32_u24 v23, 11, v12
    v_lshrrev_b32 v23, 5, v23
    v_mul_u32_u24 v20, 3, v23
    v_sub_u32 v20, v12, v20
    v_cmp_eq_u32 vcc, 0, v20
    v_lshlrev_b32 v20, 11, v20
    v_and_b32 v12, 2, v23
    v_xor_b32 v12, v12, v5
    v_lshlrev_b32 v12, 4, v12
    v_add_u32 v20, v20, v12
    v_lshlrev_b32 v23, 2, v23
    v_add_u32 v23, v23, v3
    v_mul_u32_u24 v23, 6144, v23
    v_add_u32 v20, v20, v23
    s_lshl_b32 s68, s74, 6
    s_lshl_b32 s69, s75, 6
    v_mov_b32 v23, s68
    v_mov_b32 v12, s69
    v_cndmask_b32 v23, v23, v12, vcc
    v_add_u32 v12, v23, v20
    s_mul_i32 s68, s49, 3072
    s_add_u32 s61, s68, 100352
    s_mov_b32 s69, s49
    s_lshl_b32 s68, s69, 2
    v_add_u32 v13, s68, v3
    v_mul_u32_u24 v13, 7168, v13
    s_and_b32 s68, s69, 2
    v_xor_b32 v23, s68, v5
    v_lshlrev_b32 v23, 4, v23
    v_add_u32 v13, v13, v23
    v_lshlrev_b32 v23, 6, v4
    v_add_u32 v13, v13, v23
    v_add_u32 v13, s71, v13
    s_lshl_b32 s68, s49, 10
    s_add_u32 s62, s68, 104448
    s_waitcnt lgkmcnt(0)
    s_mov_b32 s28, s6
    s_mov_b32 s29, s7
    s_mov_b32 s30, 6291456
    s_mov_b32 s31, 0x20000
    s_branch L_s1_kernel_g23done
L_s1_kernel_g23:
    s_mov_b32 s56, 229376
    s_mul_i32 s69, s49, 3
    s_add_u32 s69, s69, 0
    s_sub_u32 s69, s69, 4
    s_lshl_b32 s68, s69, 2
    v_add_u32 v10, s68, v3
    v_mul_u32_u24 v10, 7168, v10
    s_and_b32 s68, s69, 2
    v_xor_b32 v23, s68, v5
    v_lshlrev_b32 v23, 4, v23
    v_add_u32 v10, v10, v23
    v_lshlrev_b32 v23, 6, v4
    v_add_u32 v10, v10, v23
    v_add_u32 v10, s71, v10
    s_lshl_b32 s68, s69, 10
    s_add_u32 s59, s68, 104448
    s_mul_i32 s69, s49, 3
    s_add_u32 s69, s69, 1
    s_sub_u32 s69, s69, 4
    s_lshl_b32 s68, s69, 2
    v_add_u32 v11, s68, v3
    v_mul_u32_u24 v11, 7168, v11
    s_and_b32 s68, s69, 2
    v_xor_b32 v23, s68, v5
    v_lshlrev_b32 v23, 4, v23
    v_add_u32 v11, v11, v23
    v_lshlrev_b32 v23, 6, v4
    v_add_u32 v11, v11, v23
    v_add_u32 v11, s71, v11
    s_lshl_b32 s68, s69, 10
    s_add_u32 s60, s68, 104448
    s_mul_i32 s69, s49, 3
    s_add_u32 s69, s69, 2
    s_sub_u32 s69, s69, 4
    s_lshl_b32 s68, s69, 2
    v_add_u32 v12, s68, v3
    v_mul_u32_u24 v12, 7168, v12
    s_and_b32 s68, s69, 2
    v_xor_b32 v23, s68, v5
    v_lshlrev_b32 v23, 4, v23
    v_add_u32 v12, v12, v23
    v_lshlrev_b32 v23, 6, v4
    v_add_u32 v12, v12, v23
    v_add_u32 v12, s71, v12
    s_lshl_b32 s68, s69, 10
    s_add_u32 s61, s68, 104448
    v_mov_b32 v13, 0x40000000
    s_mov_b32 s62, 157696
    s_waitcnt lgkmcnt(0)
    s_mov_b32 s28, s12
    s_mov_b32 s29, s13
    s_mov_b32 s30, 7340032
    s_mov_b32 s31, 0x20000
L_s1_kernel_g23done:
    s_mov_b32 s32, s12
    s_mov_b32 s33, s13
    s_mov_b32 s34, 7340032
    s_mov_b32 s35, 0x20000
    s_cmp_ge_u32 s49, 2
    s_cselect_b32 s58, 0, 14336
    s_mov_b32 s54, 0
    s_mov_b32 s55, 0
    s_mov_b32 s36, s22
    s_mov_b32 s37, s23
    s_mov_b32 s38, 48013312
    s_mov_b32 s39, 0x20000
    s_lshl_b32 s68, s50, 4
    s_add_u32 s68, s68, s51
    s_sub_u32 s68, s68, 16
    s_lshl_b32 s68, s68, 11
    s_lshl_b32 s69, s49, 9
    s_add_u32 s68, s68, s69
    s_add_u32 s3, s68, 33554432
    s_cmp_lt_u32 s51, 16
    s_cselect_b32 s3, 0x40000000, s3
    v_mov_b32 v232, 0
    v_mov_b32 v233, -1.0
    v_lshlrev_b32 v234, 3, v1
    buffer_store_dwordx2 v[232:233], v234, s[36:39], s3 offen sc1
    s_cmp_eq_u32 s48, 7
    s_cbranch_scc0 L_s1_kernel_nocw
    s_getpc_b64 s[70:71]
L_s1_kernel_pc:
    s_lshr_b32 s68, s2, 3
    s_lshl_b32 s68, s68, 4
    v_and_b32 v236, 15, v1
    v_add_u32 v236, s68, v236
    v_lshlrev_b32 v236, 7, v236
    v_mov_b32 v239, s71
    v_add_co_u32 v238, vcc, s70, v236
    s_nop 1
    v_addc_co_u32 v239, vcc, 0, v239, vcc
    s_mov_b32 s68, L_text_end-L_s1_kernel_pc
    v_cmp_gt_u32 vcc, s68, v236
    s_nop 0
    s_and_saveexec_b64 s[70:71], vcc
    s_cbranch_execz L_s1_kernel_cwx
    global_load_dword v237, v[238:239], off
L_s1_kernel_cwx:
    s_mov_b64 exec, s[70:71]
L_s1_kernel_nocw:
    s_barrier
    s_add_u32 m0, s59, 0
    s_nop 0
    buffer_load_dwordx4 v10, s[28:31], s54 offen  lds
    s_add_u32 m0, s60, 0
    s_nop 0
    buffer_load_dwordx4 v11, s[28:31], s54 offen  lds
    s_add_u32 m0, s61, 0
    s_nop 0
    buffer_load_dwordx4 v12, s[28:31], s54 offen  lds
    s_mul_i32 s68, s58, 0
    s_add_u32 m0, s62, s68
    s_nop 0
    buffer_load_dwordx4 v13, s[32:35], s55 offen  lds
    s_add_u32 s54, s54, s56
    s_add_u32 s55, s55, 229376
    s_mov_b32 s72, 1.0
    s_mov_b32 s73, 1.0
    s_mov_b32 s36, s22
    s_mov_b32 s37, s23
    s_mov_b32 s38, 48013312
    s_mov_b32 s39, 0x20000
    v_and_b32 v2, 15, v1
    v_lshrrev_b32 v3, 1, v2
    v_lshrrev_b32 v4, 4, v1
    v_xor_b32 v3, v3, v4
    v_lshlrev_b32 v2, 7, v2
    s_lshl_b32 s68, s49, 13
    v_add_u32 v2, s68, v2
    v_lshlrev_b32 v4, 4, v3
    v_add_u32 v6, v2, v4
    v_xor_b32 v7, 64, v6
    v_add_u32 v8, 65536, v6
    v_add_u32 v9, 65536, v7
    s_mov_b32 s24, s4
    s_mov_b32 s25, s5
    s_mov_b32 s26, 4194304
    s_mov_b32 s27, 0x20000
    v_lshrrev_b32 v2, 4, v1
    v_lshlrev_b32 v3, 11, v2
    v_bfe_u32 v4, v1, 2, 2
    v_lshlrev_b32 v4, 6, v4
    v_add_u32 v3, v3, v4
    v_and_b32 v4, 3, v1
    v_lshlrev_b32 v4, 3, v4
    v_add_u32 v3, v3, v4
    v_add_u32 v3, 104448, v3
    v_and_b32 v2, 1, v2
    v_xor_b32 v2, s52, v2
    v_lshlrev_b32 v2, 5, v2
    v_add_u32 v18, v3, v2
    v_xor_b32 v2, 32, v2
    v_add_u32 v19, v3, v2
    s_lshl_b32 s68, s52, 8
    v_add_u32 v19, s68, v19
    s_branch L_s1_kernel_gmain
L_s1_kernel_amain:
    v_mov_b32 v112, 0
    v_mov_b32 v113, 0
    v_mov_b32 v114, 0
    v_mov_b32 v115, 0
    v_mov_b32 v116, 0
    v_mov_b32 v117, 0
    v_mov_b32 v118, 0
    v_mov_b32 v119, 0
    v_mov_b32 v120, 0
    v_mov_b32 v121, 0
    v_mov_b32 v122, 0
    v_mov_b32 v123, 0
    v_mov_b32 v124, 0
    v_mov_b32 v125, 0
    v_mov_b32 v126, 0
    v_mov_b32 v127, 0
    v_mov_b32 v128, 0
    v_mov_b32 v129, 0
    v_mov_b32 v130, 0
    v_mov_b32 v131, 0
    v_mov_b32 v132, 0
    v_mov_b32 v133, 0
    v_mov_b32 v134, 0
    v_mov_b32 v135, 0
    v_mov_b32 v136, 0
    v_mov_b32 v137, 0
    v_mov_b32 v138, 0
    v_mov_b32 v139, 0
    v_mov_b32 v140, 0
    v_mov_b32 v141, 0
    v_mov_b32 v142, 0
    v_mov_b32 v143, 0
    v_mov_b32 v144, 0
    v_mov_b32 v145, 0
    v_mov_b32 v146, 0
    v_mov_b32 v147, 0
    v_mov_b32 v148, 0
    v_mov_b32 v149, 0
    v_mov_b32 v150, 0
    v_mov_b32 v151, 0
    v_mov_b32 v152, 0
    v_mov_b32 v153, 0
    v_mov_b32 v154, 0
    v_mov_b32 v155, 0
    v_mov_b32 v156, 0
    v_mov_b32 v157, 0
    v_mov_b32 v158, 0
    v_mov_b32 v159, 0
    v_mov_b32 v160, 0
    v_mov_b32 v161, 0
    v_mov_b32 v162, 0
    v_mov_b32 v163, 0
    v_mov_b32 v164, 0
    v_mov_b32 v165, 0
    v_mov_b32 v166, 0
    v_mov_b32 v167, 0
    v_mov_b32 v168, 0
    v_mov_b32 v169, 0
    v_mov_b32 v170, 0
    v_mov_b32 v171, 0
    v_mov_b32 v172, 0
    v_mov_b32 v173, 0
    v_mov_b32 v174, 0
    v_mov_b32 v175, 0
    v_mov_b32 v176, 0
    v_mov_b32 v177, 0
    v_mov_b32 v178, 0
    v_mov_b32 v179, 0
    v_mov_b32 v180, 0
    v_mov_b32 v181, 0
    v_mov_b32 v182, 0
    v_mov_b32 v183, 0
    v_mov_b32 v184, 0
    v_mov_b32 v185, 0
    v_mov_b32 v186, 0
    v_mov_b32 v187, 0
    v_mov_b32 v188, 0
    v_mov_b32 v189, 0
    v_mov_b32 v190, 0
    v_mov_b32 v191, 0
    v_mov_b32 v192, 0
    v_mov_b32 v193, 0
    v_mov_b32 v194, 0
    v_mov_b32 v195, 0
    v_mov_b32 v196, 0
    v_mov_b32 v197, 0
    v_mov_b32 v198, 0
    v_mov_b32 v199, 0
    v_mov_b32 v200, 0
    v_mov_b32 v201, 0
    v_mov_b32 v202, 0
    v_mov_b32 v203, 0
    v_mov_b32 v204, 0
    v_mov_b32 v205, 0
    v_mov_b32 v206, 0
    v_mov_b32 v207, 0
    s_waitcnt vmcnt(0) lgkmcnt(0)
    s_barrier
    ds_read_b128 v[32:35], v6 offset:0
    ds_read_b128 v[36:39], v6 offset:2048
    ds_read_b128 v[40:43], v6 offset:4096
    ds_read_b128 v[44:47], v6 offset:6144
    ds_read_b64_tr_b16 v[64:65], v18 offset:0
    ds_read_b64_tr_b16 v[66:67], v18 offset:768
    ds_read_b64_tr_b16 v[68:69], v19 offset:0
    ds_read_b64_tr_b16 v[70:71], v19 offset:768
    ds_read_b64_tr_b16 v[72:73], v18 offset:256
    ds_read_b64_tr_b16 v[74:75], v18 offset:1024
    ds_read_b64_tr_b16 v[76:77], v19 offset:256
    ds_read_b64_tr_b16 v[78:79], v19 offset:1024
    ds_read_b64_tr_b16 v[80:81], v18 offset:512
    ds_read_b64_tr_b16 v[82:83], v18 offset:1280
    ds_read_b64_tr_b16 v[84:85], v19 offset:512
    ds_read_b64_tr_b16 v[86:87], v19 offset:1280
    s_add_u32 m0, s57, 32768
    s_nop 0
    buffer_load_dwordx4 v10, s[24:27], s53 offen  lds
    s_add_u32 m0, s57, 33792
    s_nop 0
    buffer_load_dwordx4 v11, s[24:27], s53 offen  lds
    s_add_u32 m0, s57, 34816
    s_nop 0
    buffer_load_dwordx4 v12, s[24:27], s53 offen  lds
    s_add_u32 m0, s57, 35840
    s_nop 0
    buffer_load_dwordx4 v13, s[24:27], s53 offen  lds
    s_add_u32 m0, s57, 36864
    s_nop 0
    buffer_load_dwordx4 v14, s[24:27], s53 offen  lds
    s_add_u32 m0, s57, 37888
    s_nop 0
    buffer_load_dwordx4 v15, s[24:27], s53 offen  lds
    s_add_u32 m0, s57, 38912
    s_nop 0
    buffer_load_dwordx4 v16, s[24:27], s53 offen  lds
    s_add_u32 m0, s57, 39936
    s_nop 0
    buffer_load_dwordx4 v17, s[24:27], s53 offen  lds
    s_add_u32 s53, s53, 128
    s_waitcnt lgkmcnt(0)
    s_barrier
    v_mfma_f32_16x16x32_bf16 v[112:115], v[64:67], v[32:35], v[112:115]
    ds_read_b128 v[48:51], v7 offset:0
    s_add_u32 m0, s57, 65536
    v_mfma_f32_16x16x32_bf16 v[116:119], v[64:67], v[36:39], v[116:119]
    buffer_load_dwordx4 v10, s[24:27], s53 offen  lds
    ds_read_b128 v[52:55], v7 offset:2048
    v_mfma_f32_16x16x32_bf16 v[120:123], v[64:67], v[40:43], v[120:123]
    ds_read_b128 v[56:59], v7 offset:4096
    s_add_u32 m0, s57, 66560
    v_mfma_f32_16x16x32_bf16 v[124:127], v[64:67], v[44:47], v[124:127]
    buffer_load_dwordx4 v11, s[24:27], s53 offen  lds
    ds_read_b128 v[60:63], v7 offset:6144
    v_mfma_f32_16x16x32_bf16 v[140:143], v[68:71], v[44:47], v[140:143]
    ds_read_b64_tr_b16 v[88:89], v18 offset:14336
    s_add_u32 m0, s57, 67584
    v_mfma_f32_16x16x32_bf16 v[136:139], v[68:71], v[40:43], v[136:139]
    buffer_load_dwordx4 v12, s[24:27], s53 offen  lds
    ds_read_b64_tr_b16 v[90:91], v18 offset:15104
    v_mfma_f32_16x16x32_bf16 v[132:135], v[68:71], v[36:39], v[132:135]
    s_add_u32 m0, s57, 68608
    v_mfma_f32_16x16x32_bf16 v[128:131], v[68:71], v[32:35], v[128:131]
    buffer_load_dwordx4 v13, s[24:27], s53 offen  lds
    ds_read_b64_tr_b16 v[92:93], v19 offset:14336
    v_mfma_f32_16x16x32_bf16 v[144:147], v[72:75], v[32:35], v[144:147]
    ds_read_b64_tr_b16 v[94:95], v19 offset:15104
    s_add_u32 m0, s57, 69632
    v_mfma_f32_16x16x32_bf16 v[148:151], v[72:75], v[36:39], v[148:151]
    buffer_load_dwordx4 v14, s[24:27], s53 offen  lds
    ds_read_b64_tr_b16 v[96:97], v18 offset:14592
    v_mfma_f32_16x16x32_bf16 v[152:155], v[72:75], v[40:43], v[152:155]
    ds_read_b64_tr_b16 v[98:99], v18 offset:15360
    s_add_u32 m0, s57, 70656
    v_mfma_f32_16x16x32_bf16 v[156:159], v[72:75], v[44:47], v[156:159]
    buffer_load_dwordx4 v15, s[24:27], s53 offen  lds
    ds_read_b64_tr_b16 v[100:101], v19 offset:14592
    v_mfma_f32_16x16x32_bf16 v[172:175], v[76:79], v[44:47], v[172:175]
    s_add_u32 m0, s57, 71680
    v_mfma_f32_16x16x32_bf16 v[168:171], v[76:79], v[40:43], v[168:171]
    buffer_load_dwordx4 v16, s[24:27], s53 offen  lds
    ds_read_b64_tr_b16 v[102:103], v19 offset:15360
    v_mfma_f32_16x16x32_bf16 v[164:167], v[76:79], v[36:39], v[164:167]
    ds_read_b64_tr_b16 v[104:105], v18 offset:14848
    s_add_u32 m0, s57, 72704
    v_mfma_f32_16x16x32_bf16 v[160:163], v[76:79], v[32:35], v[160:163]
    buffer_load_dwordx4 v17, s[24:27], s53 offen  lds
    s_add_u32 s53, s53, 128
    ds_read_b64_tr_b16 v[106:107], v18 offset:15616
    v_mfma_f32_16x16x32_bf16 v[176:179], v[32:35], v[80:83], v[176:179]
    ds_read_b64_tr_b16 v[108:109], v19 offset:14848
    v_mfma_f32_16x16x32_bf16 v[180:183], v[36:39], v[80:83], v[180:183]
    ds_read_b64_tr_b16 v[110:111], v19 offset:15616
    buffer_load_dword v23, v20, s[40:43], s63 offen
    s_add_u32 s63, s63, s64
    v_mfma_f32_16x16x32_bf16 v[184:187], v[40:43], v[80:83], v[184:187]
    v_mfma_f32_16x16x32_bf16 v[188:191], v[44:47], v[80:83], v[188:191]
    buffer_load_dword v23, v20, s[40:43], s63 offen
    s_add_u32 s63, s63, s64
    v_mfma_f32_16x16x32_bf16 v[204:207], v[44:47], v[84:87], v[204:207]
    v_mfma_f32_16x16x32_bf16 v[200:203], v[40:43], v[84:87], v[200:203]
    v_mfma_f32_16x16x32_bf16 v[196:199], v[36:39], v[84:87], v[196:199]
    v_mfma_f32_16x16x32_bf16 v[192:195], v[32:35], v[84:87], v[192:195]
    s_waitcnt vmcnt(10) lgkmcnt(0)
    s_barrier
    v_mfma_f32_16x16x32_bf16 v[112:115], v[88:91], v[48:51], v[112:115]
    ds_read_b128 v[32:35], v6 offset:32768
    s_add_u32 m0, s57, 0
    v_mfma_f32_16x16x32_bf16 v[116:119], v[88:91], v[52:55], v[116:119]
    buffer_load_dwordx4 v10, s[24:27], s53 offen  lds
    ds_read_b128 v[36:39], v6 offset:34816
    v_mfma_f32_16x16x32_bf16 v[120:123], v[88:91], v[56:59], v[120:123]
    ds_read_b128 v[40:43], v6 offset:36864
    v_mfma_f32_16x16x32_bf16 v[124:127], v[88:91], v[60:63], v[124:127]
    ds_read_b128 v[44:47], v6 offset:38912
    s_add_u32 m0, s57, 1024
    v_mfma_f32_16x16x32_bf16 v[140:143], v[92:95], v[60:63], v[140:143]
    buffer_load_dwordx4 v11, s[24:27], s53 offen  lds
    ds_read_b64_tr_b16 v[64:65], v18 offset:28672
    v_mfma_f32_16x16x32_bf16 v[136:139], v[92:95], v[56:59], v[136:139]
    ds_read_b64_tr_b16 v[66:67], v18 offset:29440
    v_mfma_f32_16x16x32_bf16 v[132:135], v[92:95], v[52:55], v[132:135]
    v_mfma_f32_16x16x32_bf16 v[128:131], v[92:95], v[48:51], v[128:131]
    ds_read_b64_tr_b16 v[68:69], v19 offset:28672
    s_add_u32 m0, s57, 2048
    v_mfma_f32_16x16x32_bf16 v[144:147], v[96:99], v[48:51], v[144:147]
    buffer_load_dwordx4 v12, s[24:27], s53 offen  lds
    ds_read_b64_tr_b16 v[70:71], v19 offset:29440
    v_mfma_f32_16x16x32_bf16 v[148:151], v[96:99], v[52:55], v[148:151]
    ds_read_b64_tr_b16 v[72:73], v18 offset:28928
    v_mfma_f32_16x16x32_bf16 v[152:155], v[96:99], v[56:59], v[152:155]
    ds_read_b64_tr_b16 v[74:75], v18 offset:29696
    s_add_u32 m0, s57, 3072
    v_mfma_f32_16x16x32_bf16 v[156:159], v[96:99], v[60:63], v[156:159]
    buffer_load_dwordx4 v13, s[24:27], s53 offen  lds
    ds_read_b64_tr_b16 v[76:77], v19 offset:28928
    v_mfma_f32_16x16x32_bf16 v[172:175], v[100:103], v[60:63], v[172:175]
    v_mfma_f32_16x16x32_bf16 v[168:171], v[100:103], v[56:59], v[168:171]
    ds_read_b64_tr_b16 v[78:79], v19 offset:29696
    v_mfma_f32_16x16x32_bf16 v[164:167], v[100:103], v[52:55], v[164:167]
    ds_read_b64_tr_b16 v[80:81], v18 offset:29184
    v_mfma_f32_16x16x32_bf16 v[160:163], v[100:103], v[48:51], v[160:163]
    ds_read_b64_tr_b16 v[82:83], v18 offset:29952
    s_mov_b32 s28, s8
    s_mov_b32 s29, s9
    s_mov_b32 s30, 65536
    s_mov_b32 s31, 0x20000
    s_and_b32 s68, s49, 1
    s_lshl_b32 s68, s68, 10
    s_lshl_b32 s69, s74, 11
    s_add_u32 s69, s69, s68
    s_add_u32 m0, s68, 155648
    s_nop 0
    buffer_load_dwordx4 v22, s[28:31], s69 offen lds
    v_mfma_f32_16x16x32_bf16 v[176:179], v[48:51], v[104:107], v[176:179]
    ds_read_b64_tr_b16 v[84:85], v19 offset:29184
    v_mfma_f32_16x16x32_bf16 v[180:183], v[52:55], v[104:107], v[180:183]
    ds_read_b64_tr_b16 v[86:87], v19 offset:29952
    v_mfma_f32_16x16x32_bf16 v[184:187], v[56:59], v[104:107], v[184:187]
    buffer_load_dword v23, v20, s[40:43], s63 offen
    s_add_u32 s63, s63, s64
    v_mfma_f32_16x16x32_bf16 v[188:191], v[60:63], v[104:107], v[188:191]
    v_mfma_f32_16x16x32_bf16 v[204:207], v[60:63], v[108:111], v[204:207]
    v_mfma_f32_16x16x32_bf16 v[200:203], v[56:59], v[108:111], v[200:203]
    v_mfma_f32_16x16x32_bf16 v[196:199], v[52:55], v[108:111], v[196:199]
    v_mfma_f32_16x16x32_bf16 v[192:195], v[48:51], v[108:111], v[192:195]
    s_waitcnt vmcnt(16) lgkmcnt(0)
    s_barrier
    s_mov_b32 s67, 0
.p2align 6
L_s1_kernel_loopA:
    v_mfma_f32_16x16x32_bf16 v[112:115], v[64:67], v[32:35], v[112:115]
    ds_read_b128 v[48:51], v7 offset:32768
    s_add_u32 m0, s57, 4096
    v_mfma_f32_16x16x32_bf16 v[116:119], v[64:67], v[36:39], v[116:119]
    buffer_load_dwordx4 v14, s[24:27], s53 offen  lds
    ds_read_b128 v[52:55], v7 offset:34816
    v_mfma_f32_16x16x32_bf16 v[120:123], v[64:67], v[40:43], v[120:123]
    ds_read_b128 v[56:59], v7 offset:36864
    v_mfma_f32_16x16x32_bf16 v[124:127], v[64:67], v[44:47], v[124:127]
    ds_read_b128 v[60:63], v7 offset:38912
    s_add_u32 m0, s57, 5120
    v_mfma_f32_16x16x32_bf16 v[140:143], v[68:71], v[44:47], v[140:143]
    buffer_load_dwordx4 v15, s[24:27], s53 offen  lds
    ds_read_b64_tr_b16 v[88:89], v18 offset:43008
    v_mfma_f32_16x16x32_bf16 v[136:139], v[68:71], v[40:43], v[136:139]
    ds_read_b64_tr_b16 v[90:91], v18 offset:43776
    v_mfma_f32_16x16x32_bf16 v[132:135], v[68:71], v[36:39], v[132:135]
    v_mfma_f32_16x16x32_bf16 v[128:131], v[68:71], v[32:35], v[128:131]
    ds_read_b64_tr_b16 v[92:93], v19 offset:43008
    s_add_u32 m0, s57, 6144
    v_mfma_f32_16x16x32_bf16 v[144:147], v[72:75], v[32:35], v[144:147]
    buffer_load_dwordx4 v16, s[24:27], s53 offen  lds
    ds_read_b64_tr_b16 v[94:95], v19 offset:43776
    v_mfma_f32_16x16x32_bf16 v[148:151], v[72:75], v[36:39], v[148:151]
    ds_read_b64_tr_b16 v[96:97], v18 offset:43264
    v_mfma_f32_16x16x32_bf16 v[152:155], v[72:75], v[40:43], v[152:155]
    ds_read_b64_tr_b16 v[98:99], v18 offset:44032
    s_add_u32 m0, s57, 7168
    v_mfma_f32_16x16x32_bf16 v[156:159], v[72:75], v[44:47], v[156:159]
    buffer_load_dwordx4 v17, s[24:27], s53 offen  lds
    s_add_u32 s53, s53, 128
    ds_read_b64_tr_b16 v[100:101], v19 offset:43264
    v_mfma_f32_16x16x32_bf16 v[172:175], v[76:79], v[44:47], v[172:175]
    v_mfma_f32_16x16x32_bf16 v[168:171], v[76:79], v[40:43], v[168:171]
    ds_read_b64_tr_b16 v[102:103], v19 offset:44032
    v_mfma_f32_16x16x32_bf16 v[164:167], v[76:79], v[36:39], v[164:167]
    ds_read_b64_tr_b16 v[104:105], v18 offset:43520
    v_mfma_f32_16x16x32_bf16 v[160:163], v[76:79], v[32:35], v[160:163]
    ds_read_b64_tr_b16 v[106:107], v18 offset:44288
    buffer_load_dword v23, v20, s[40:43], s63 offen
    s_add_u32 s63, s63, s64
    v_mfma_f32_16x16x32_bf16 v[176:179], v[32:35], v[80:83], v[176:179]
    ds_read_b64_tr_b16 v[108:109], v19 offset:43520
    v_mfma_f32_16x16x32_bf16 v[180:183], v[36:39], v[80:83], v[180:183]
    ds_read_b64_tr_b16 v[110:111], v19 offset:44288
    v_mfma_f32_16x16x32_bf16 v[184:187], v[40:43], v[80:83], v[184:187]
    buffer_load_dwordx4 v[208:211], v21, s[44:47], s65 offen
    s_add_u32 s65, s65, 128
    buffer_load_dwordx4 v[212:215], v21, s[44:47], s65 offen
    s_add_u32 s65, s65, 128
    v_mfma_f32_16x16x32_bf16 v[188:191], v[44:47], v[80:83], v[188:191]
    v_mfma_f32_16x16x32_bf16 v[204:207], v[44:47], v[84:87], v[204:207]
    v_mfma_f32_16x16x32_bf16 v[200:203], v[40:43], v[84:87], v[200:203]
    v_mfma_f32_16x16x32_bf16 v[196:199], v[36:39], v[84:87], v[196:199]
    v_mfma_f32_16x16x32_bf16 v[192:195], v[32:35], v[84:87], v[192:195]
    s_waitcnt vmcnt(15) lgkmcnt(0)
    s_barrier
    v_mfma_f32_16x16x32_bf16 v[112:115], v[88:91], v[48:51], v[112:115]
    ds_read_b128 v[32:35], v8 offset:0
    s_add_u32 m0, s57, 32768
    v_mfma_f32_16x16x32_bf16 v[116:119], v[88:91], v[52:55], v[116:119]
    buffer_load_dwordx4 v10, s[24:27], s53 offen  lds
    ds_read_b128 v[36:39], v8 offset:2048
    v_mfma_f32_16x16x32_bf16 v[120:123], v[88:91], v[56:59], v[120:123]
    ds_read_b128 v[40:43], v8 offset:4096
    v_mfma_f32_16x16x32_bf16 v[124:127], v[88:91], v[60:63], v[124:127]
    ds_read_b128 v[44:47], v8 offset:6144
    v_mfma_f32_16x16x32_bf16 v[140:143], v[92:95], v[60:63], v[140:143]
    ds_read_b64_tr_b16 v[64:65], v18 offset:0
    v_mfma_f32_16x16x32_bf16 v[136:139], v[92:95], v[56:59], v[136:139]
    ds_read_b64_tr_b16 v[66:67], v18 offset:768
    s_add_u32 m0, s57, 33792
    v_mfma_f32_16x16x32_bf16 v[132:135], v[92:95], v[52:55], v[132:135]
    buffer_load_dwordx4 v11, s[24:27], s53 offen  lds
    v_mfma_f32_16x16x32_bf16 v[128:131], v[92:95], v[48:51], v[128:131]
    ds_read_b64_tr_b16 v[68:69], v19 offset:0
    v_mfma_f32_16x16x32_bf16 v[144:147], v[96:99], v[48:51], v[144:147]
    ds_read_b64_tr_b16 v[70:71], v19 offset:768
    v_mfma_f32_16x16x32_bf16 v[148:151], v[96:99], v[52:55], v[148:151]
    ds_read_b64_tr_b16 v[72:73], v18 offset:256
    v_mfma_f32_16x16x32_bf16 v[152:155], v[96:99], v[56:59], v[152:155]
    ds_read_b64_tr_b16 v[74:75], v18 offset:1024
    s_add_u32 m0, s57, 34816
    v_mfma_f32_16x16x32_bf16 v[156:159], v[96:99], v[60:63], v[156:159]
    buffer_load_dwordx4 v12, s[24:27], s53 offen  lds
    ds_read_b64_tr_b16 v[76:77], v19 offset:256
    v_mfma_f32_16x16x32_bf16 v[172:175], v[100:103], v[60:63], v[172:175]
    v_mfma_f32_16x16x32_bf16 v[168:171], v[100:103], v[56:59], v[168:171]
    ds_read_b64_tr_b16 v[78:79], v19 offset:1024
    v_mfma_f32_16x16x32_bf16 v[164:167], v[100:103], v[52:55], v[164:167]
    ds_read_b64_tr_b16 v[80:81], v18 offset:512
    v_mfma_f32_16x16x32_bf16 v[160:163], v[100:103], v[48:51], v[160:163]
    ds_read_b64_tr_b16 v[82:83], v18 offset:1280
    s_add_u32 m0, s57, 35840
    v_mfma_f32_16x16x32_bf16 v[176:179], v[48:51], v[104:107], v[176:179]
    buffer_load_dwordx4 v13, s[24:27], s53 offen  lds
    ds_read_b64_tr_b16 v[84:85], v19 offset:512
    v_mfma_f32_16x16x32_bf16 v[180:183], v[52:55], v[104:107], v[180:183]
    ds_read_b64_tr_b16 v[86:87], v19 offset:1280
    v_mfma_f32_16x16x32_bf16 v[184:187], v[56:59], v[104:107], v[184:187]
    v_mfma_f32_16x16x32_bf16 v[188:191], v[60:63], v[104:107], v[188:191]
    v_mfma_f32_16x16x32_bf16 v[204:207], v[60:63], v[108:111], v[204:207]
    v_mfma_f32_16x16x32_bf16 v[200:203], v[56:59], v[108:111], v[200:203]
    v_mfma_f32_16x16x32_bf16 v[196:199], v[52:55], v[108:111], v[196:199]
    v_mfma_f32_16x16x32_bf16 v[192:195], v[48:51], v[108:111], v[192:195]
    s_waitcnt vmcnt(19) lgkmcnt(0)
    s_barrier
    v_mfma_f32_16x16x32_bf16 v[112:115], v[64:67], v[32:35], v[112:115]
    ds_read_b128 v[48:51], v9 offset:0
    s_add_u32 m0, s57, 36864
    v_mfma_f32_16x16x32_bf16 v[116:119], v[64:67], v[36:39], v[116:119]
    buffer_load_dwordx4 v14, s[24:27], s53 offen  lds
    ds_read_b128 v[52:55], v9 offset:2048
    v_mfma_f32_16x16x32_bf16 v[120:123], v[64:67], v[40:43], v[120:123]
    ds_read_b128 v[56:59], v9 offset:4096
    v_mfma_f32_16x16x32_bf16 v[124:127], v[64:67], v[44:47], v[124:127]
    ds_read_b128 v[60:63], v9 offset:6144
    s_add_u32 m0, s57, 37888
    v_mfma_f32_16x16x32_bf16 v[140:143], v[68:71], v[44:47], v[140:143]
    buffer_load_dwordx4 v15, s[24:27], s53 offen  lds
    ds_read_b64_tr_b16 v[88:89], v18 offset:14336
    v_mfma_f32_16x16x32_bf16 v[136:139], v[68:71], v[40:43], v[136:139]
    ds_read_b64_tr_b16 v[90:91], v18 offset:15104
    v_mfma_f32_16x16x32_bf16 v[132:135], v[68:71], v[36:39], v[132:135]
    v_mfma_f32_16x16x32_bf16 v[128:131], v[68:71], v[32:35], v[128:131]
    ds_read_b64_tr_b16 v[92:93], v19 offset:14336
    s_add_u32 m0, s57, 38912
    v_mfma_f32_16x16x32_bf16 v[144:147], v[72:75], v[32:35], v[144:147]
    buffer_load_dwordx4 v16, s[24:27], s53 offen  lds
    ds_read_b64_tr_b16 v[94:95], v19 offset:15104
    v_mfma_f32_16x16x32_bf16 v[148:151], v[72:75], v[36:39], v[148:151]
    ds_read_b64_tr_b16 v[96:97], v18 offset:14592
    v_mfma_f32_16x16x32_bf16 v[152:155], v[72:75], v[40:43], v[152:155]
    ds_read_b64_tr_b16 v[98:99], v18 offset:15360
    s_add_u32 m0, s57, 39936
    v_mfma_f32_16x16x32_bf16 v[156:159], v[72:75], v[44:47], v[156:159]
    buffer_load_dwordx4 v17, s[24:27], s53 offen  lds
    s_add_u32 s53, s53, 128
    ds_read_b64_tr_b16 v[100:101], v19 offset:14592
    v_mfma_f32_16x16x32_bf16 v[172:175], v[76:79], v[44:47], v[172:175]
    v_mfma_f32_16x16x32_bf16 v[168:171], v[76:79], v[40:43], v[168:171]
    ds_read_b64_tr_b16 v[102:103], v19 offset:15360
    v_mfma_f32_16x16x32_bf16 v[164:167], v[76:79], v[36:39], v[164:167]
    ds_read_b64_tr_b16 v[104:105], v18 offset:14848
    v_mfma_f32_16x16x32_bf16 v[160:163], v[76:79], v[32:35], v[160:163]
    ds_read_b64_tr_b16 v[106:107], v18 offset:15616
    buffer_load_dword v23, v20, s[40:43], s63 offen
    s_add_u32 s63, s63, s64
    v_mfma_f32_16x16x32_bf16 v[176:179], v[32:35], v[80:83], v[176:179]
    ds_read_b64_tr_b16 v[108:109], v19 offset:14848
    v_mfma_f32_16x16x32_bf16 v[180:183], v[36:39], v[80:83], v[180:183]
    ds_read_b64_tr_b16 v[110:111], v19 offset:15616
    v_mfma_f32_16x16x32_bf16 v[184:187], v[40:43], v[80:83], v[184:187]
    buffer_load_dwordx4 v[216:219], v21, s[44:47], s65 offen
    s_add_u32 s65, s65, 128
    buffer_load_dwordx4 v[220:223], v21, s[44:47], s65 offen
    s_add_u32 s65, s65, 128
    v_mfma_f32_16x16x32_bf16 v[188:191], v[44:47], v[80:83], v[188:191]
    v_mfma_f32_16x16x32_bf16 v[204:207], v[44:47], v[84:87], v[204:207]
    v_mfma_f32_16x16x32_bf16 v[200:203], v[40:43], v[84:87], v[200:203]
    v_mfma_f32_16x16x32_bf16 v[196:199], v[36:39], v[84:87], v[196:199]
    v_mfma_f32_16x16x32_bf16 v[192:195], v[32:35], v[84:87], v[192:195]
    s_waitcnt vmcnt(14) lgkmcnt(0)
    s_barrier
    v_mfma_f32_16x16x32_bf16 v[112:115], v[88:91], v[48:51], v[112:115]
    ds_read_b128 v[32:35], v6 offset:0
    s_add_u32 m0, s57, 65536
    v_mfma_f32_16x16x32_bf16 v[116:119], v[88:91], v[52:55], v[116:119]
    buffer_load_dwordx4 v10, s[24:27], s53 offen  lds
    ds_read_b128 v[36:39], v6 offset:2048
    v_mfma_f32_16x16x32_bf16 v[120:123], v[88:91], v[56:59], v[120:123]
    ds_read_b128 v[40:43], v6 offset:4096
    v_mfma_f32_16x16x32_bf16 v[124:127], v[88:91], v[60:63], v[124:127]
    ds_read_b128 v[44:47], v6 offset:6144
    v_mfma_f32_16x16x32_bf16 v[140:143], v[92:95], v[60:63], v[140:143]
    ds_read_b64_tr_b16 v[64:65], v18 offset:28672
    v_mfma_f32_16x16x32_bf16 v[136:139], v[92:95], v[56:59], v[136:139]
    ds_read_b64_tr_b16 v[66:67], v18 offset:29440
    s_add_u32 m0, s57, 66560
    v_mfma_f32_16x16x32_bf16 v[132:135], v[92:95], v[52:55], v[132:135]
    buffer_load_dwordx4 v11, s[24:27], s53 offen  lds
    v_mfma_f32_16x16x32_bf16 v[128:131], v[92:95], v[48:51], v[128:131]
    ds_read_b64_tr_b16 v[68:69], v19 offset:28672
    v_mfma_f32_16x16x32_bf16 v[144:147], v[96:99], v[48:51], v[144:147]
    ds_read_b64_tr_b16 v[70:71], v19 offset:29440
    v_mfma_f32_16x16x32_bf16 v[148:151], v[96:99], v[52:55], v[148:151]
    ds_read_b64_tr_b16 v[72:73], v18 offset:28928
    v_mfma_f32_16x16x32_bf16 v[152:155], v[96:99], v[56:59], v[152:155]
    ds_read_b64_tr_b16 v[74:75], v18 offset:29696
    s_add_u32 m0, s57, 67584
    v_mfma_f32_16x16x32_bf16 v[156:159], v[96:99], v[60:63], v[156:159]
    buffer_load_dwordx4 v12, s[24:27], s53 offen  lds
    ds_read_b64_tr_b16 v[76:77], v19 offset:28928
    v_mfma_f32_16x16x32_bf16 v[172:175], v[100:103], v[60:63], v[172:175]
    v_mfma_f32_16x16x32_bf16 v[168:171], v[100:103], v[56:59], v[168:171]
    ds_read_b64_tr_b16 v[78:79], v19 offset:29696
    v_mfma_f32_16x16x32_bf16 v[164:167], v[100:103], v[52:55], v[164:167]
    ds_read_b64_tr_b16 v[80:81], v18 offset:29184
    v_mfma_f32_16x16x32_bf16 v[160:163], v[100:103], v[48:51], v[160:163]
    ds_read_b64_tr_b16 v[82:83], v18 offset:29952
    s_add_u32 m0, s57, 68608
    v_mfma_f32_16x16x32_bf16 v[176:179], v[48:51], v[104:107], v[176:179]
    buffer_load_dwordx4 v13, s[24:27], s53 offen  lds
    ds_read_b64_tr_b16 v[84:85], v19 offset:29184
    v_mfma_f32_16x16x32_bf16 v[180:183], v[52:55], v[104:107], v[180:183]
    ds_read_b64_tr_b16 v[86:87], v19 offset:29952
    v_mfma_f32_16x16x32_bf16 v[184:187], v[56:59], v[104:107], v[184:187]
    v_mfma_f32_16x16x32_bf16 v[188:191], v[60:63], v[104:107], v[188:191]
    v_mfma_f32_16x16x32_bf16 v[204:207], v[60:63], v[108:111], v[204:207]
    v_mfma_f32_16x16x32_bf16 v[200:203], v[56:59], v[108:111], v[200:203]
    v_mfma_f32_16x16x32_bf16 v[196:199], v[52:55], v[108:111], v[196:199]
    v_mfma_f32_16x16x32_bf16 v[192:195], v[48:51], v[108:111], v[192:195]
    s_waitcnt vmcnt(18) lgkmcnt(0)
    s_barrier
    v_mfma_f32_16x16x32_bf16 v[112:115], v[64:67], v[32:35], v[112:115]
    ds_read_b128 v[48:51], v7 offset:0
    s_add_u32 m0, s57, 69632
    v_mfma_f32_16x16x32_bf16 v[116:119], v[64:67], v[36:39], v[116:119]
    buffer_load_dwordx4 v14, s[24:27], s53 offen  lds
    ds_read_b128 v[52:55], v7 offset:2048
    v_mfma_f32_16x16x32_bf16 v[120:123], v[64:67], v[40:43], v[120:123]
    ds_read_b128 v[56:59], v7 offset:4096
    v_mfma_f32_16x16x32_bf16 v[124:127], v[64:67], v[44:47], v[124:127]
    ds_read_b128 v[60:63], v7 offset:6144
    s_add_u32 m0, s57, 70656
    v_mfma_f32_16x16x32_bf16 v[140:143], v[68:71], v[44:47], v[140:143]
    buffer_load_dwordx4 v15, s[24:27], s53 offen  lds
    ds_read_b64_tr_b16 v[88:89], v18 offset:43008
    v_mfma_f32_16x16x32_bf16 v[136:139], v[68:71], v[40:43], v[136:139]
    ds_read_b64_tr_b16 v[90:91], v18 offset:43776
    v_mfma_f32_16x16x32_bf16 v[132:135], v[68:71], v[36:39], v[132:135]
    v_mfma_f32_16x16x32_bf16 v[128:131], v[68:71], v[32:35], v[128:131]
    ds_read_b64_tr_b16 v[92:93], v19 offset:43008
    s_add_u32 m0, s57, 71680
    v_mfma_f32_16x16x32_bf16 v[144:147], v[72:75], v[32:35], v[144:147]
    buffer_load_dwordx4 v16, s[24:27], s53 offen  lds
    ds_read_b64_tr_b16 v[94:95], v19 offset:43776
    v_mfma_f32_16x16x32_bf16 v[148:151], v[72:75], v[36:39], v[148:151]
    ds_read_b64_tr_b16 v[96:97], v18 offset:43264
    v_mfma_f32_16x16x32_bf16 v[152:155], v[72:75], v[40:43], v[152:155]
    ds_read_b64_tr_b16 v[98:99], v18 offset:44032
    s_add_u32 m0, s57, 72704
    v_mfma_f32_16x16x32_bf16 v[156:159], v[72:75], v[44:47], v[156:159]
    buffer_load_dwordx4 v17, s[24:27], s53 offen  lds
    s_add_u32 s53, s53, 128
    ds_read_b64_tr_b16 v[100:101], v19 offset:43264
    v_mfma_f32_16x16x32_bf16 v[172:175], v[76:79], v[44:47], v[172:175]
    v_mfma_f32_16x16x32_bf16 v[168:171], v[76:79], v[40:43], v[168:171]
    ds_read_b64_tr_b16 v[102:103], v19 offset:44032
    v_mfma_f32_16x16x32_bf16 v[164:167], v[76:79], v[36:39], v[164:167]
    ds_read_b64_tr_b16 v[104:105], v18 offset:43520
    v_mfma_f32_16x16x32_bf16 v[160:163], v[76:79], v[32:35], v[160:163]
    ds_read_b64_tr_b16 v[106:107], v18 offset:44288
    buffer_load_dword v23, v20, s[40:43], s63 offen
    s_add_u32 s63, s63, s64
    v_mfma_f32_16x16x32_bf16 v[176:179], v[32:35], v[80:83], v[176:179]
    ds_read_b64_tr_b16 v[108:109], v19 offset:43520
    v_mfma_f32_16x16x32_bf16 v[180:183], v[36:39], v[80:83], v[180:183]
    ds_read_b64_tr_b16 v[110:111], v19 offset:44288
    v_mfma_f32_16x16x32_bf16 v[184:187], v[40:43], v[80:83], v[184:187]
    s_waitcnt vmcnt(20)
    buffer_store_dwordx4 v[208:211], v22, s[36:39], s66 offen sc1
    s_add_u32 s66, s66, 360448
    buffer_store_dwordx4 v[212:215], v22, s[36:39], s66 offen sc1
    s_add_u32 s66, s66, 360448
    v_mfma_f32_16x16x32_bf16 v[188:191], v[44:47], v[80:83], v[188:191]
    v_mfma_f32_16x16x32_bf16 v[204:207], v[44:47], v[84:87], v[204:207]
    v_mfma_f32_16x16x32_bf16 v[200:203], v[40:43], v[84:87], v[200:203]
    v_mfma_f32_16x16x32_bf16 v[196:199], v[36:39], v[84:87], v[196:199]
    v_mfma_f32_16x16x32_bf16 v[192:195], v[32:35], v[84:87], v[192:195]
    s_waitcnt vmcnt(14) lgkmcnt(0)
    s_barrier
    v_mfma_f32_16x16x32_bf16 v[112:115], v[88:91], v[48:51], v[112:115]
    ds_read_b128 v[32:35], v6 offset:32768
    s_add_u32 m0, s57, 0
    v_mfma_f32_16x16x32_bf16 v[116:119], v[88:91], v[52:55], v[116:119]
    buffer_load_dwordx4 v10, s[24:27], s53 offen  lds
    ds_read_b128 v[36:39], v6 offset:34816
    v_mfma_f32_16x16x32_bf16 v[120:123], v[88:91], v[56:59], v[120:123]
    ds_read_b128 v[40:43], v6 offset:36864
    v_mfma_f32_16x16x32_bf16 v[124:127], v[88:91], v[60:63], v[124:127]
    ds_read_b128 v[44:47], v6 offset:38912
    v_mfma_f32_16x16x32_bf16 v[140:143], v[92:95], v[60:63], v[140:143]
    ds_read_b64_tr_b16 v[64:65], v18 offset:0
    s_add_u32 m0, s57, 1024
    v_mfma_f32_16x16x32_bf16 v[136:139], v[92:95], v[56:59], v[136:139]
    buffer_load_dwordx4 v11, s[24:27], s53 offen  lds
    ds_read_b64_tr_b16 v[66:67], v18 offset:768
    v_mfma_f32_16x16x32_bf16 v[132:135], v[92:95], v[52:55], v[132:135]
    v_mfma_f32_16x16x32_bf16 v[128:131], v[92:95], v[48:51], v[128:131]
    ds_read_b64_tr_b16 v[68:69], v19 offset:0
    v_mfma_f32_16x16x32_bf16 v[144:147], v[96:99], v[48:51], v[144:147]
    ds_read_b64_tr_b16 v[70:71], v19 offset:768
    s_add_u32 m0, s57, 2048
    v_mfma_f32_16x16x32_bf16 v[148:151], v[96:99], v[52:55], v[148:151]
    buffer_load_dwordx4 v12, s[24:27], s53 offen  lds
    ds_read_b64_tr_b16 v[72:73], v18 offset:256
    v_mfma_f32_16x16x32_bf16 v[152:155], v[96:99], v[56:59], v[152:155]
    ds_read_b64_tr_b16 v[74:75], v18 offset:1024
    v_mfma_f32_16x16x32_bf16 v[156:159], v[96:99], v[60:63], v[156:159]
    ds_read_b64_tr_b16 v[76:77], v19 offset:256
    v_mfma_f32_16x16x32_bf16 v[172:175], v[100:103], v[60:63], v[172:175]
    s_add_u32 m0, s57, 3072
    v_mfma_f32_16x16x32_bf16 v[168:171], v[100:103], v[56:59], v[168:171]
    buffer_load_dwordx4 v13, s[24:27], s53 offen  lds
    ds_read_b64_tr_b16 v[78:79], v19 offset:1024
    v_mfma_f32_16x16x32_bf16 v[164:167], v[100:103], v[52:55], v[164:167]
    ds_read_b64_tr_b16 v[80:81], v18 offset:512
    v_mfma_f32_16x16x32_bf16 v[160:163], v[100:103], v[48:51], v[160:163]
    ds_read_b64_tr_b16 v[82:83], v18 offset:1280
    v_mfma_f32_16x16x32_bf16 v[176:179], v[48:51], v[104:107], v[176:179]
    ds_read_b64_tr_b16 v[84:85], v19 offset:512
    v_mfma_f32_16x16x32_bf16 v[180:183], v[52:55], v[104:107], v[180:183]
    ds_read_b64_tr_b16 v[86:87], v19 offset:1280
    s_waitcnt vmcnt(15)
    buffer_store_dwordx4 v[216:219], v22, s[36:39], s66 offen sc1
    s_add_u32 s66, s66, 360448
    buffer_store_dwordx4 v[220:223], v22, s[36:39], s66 offen sc1
    s_add_u32 s66, s66, 360448
    v_mfma_f32_16x16x32_bf16 v[184:187], v[56:59], v[104:107], v[184:187]
    v_mfma_f32_16x16x32_bf16 v[188:191], v[60:63], v[104:107], v[188:191]
    v_mfma_f32_16x16x32_bf16 v[204:207], v[60:63], v[108:111], v[204:207]
    v_mfma_f32_16x16x32_bf16 v[200:203], v[56:59], v[108:111], v[200:203]
    v_mfma_f32_16x16x32_bf16 v[196:199], v[52:55], v[108:111], v[196:199]
    v_mfma_f32_16x16x32_bf16 v[192:195], v[48:51], v[108:111], v[192:195]
    s_waitcnt vmcnt(20) lgkmcnt(0)
    s_barrier
    v_mfma_f32_16x16x32_bf16 v[112:115], v[64:67], v[32:35], v[112:115]
    ds_read_b128 v[48:51], v7 offset:32768
    s_add_u32 m0, s57, 4096
    v_mfma_f32_16x16x32_bf16 v[116:119], v[64:67], v[36:39], v[116:119]
    buffer_load_dwordx4 v14, s[24:27], s53 offen  lds
    ds_read_b128 v[52:55], v7 offset:34816
    v_mfma_f32_16x16x32_bf16 v[120:123], v[64:67], v[40:43], v[120:123]
    ds_read_b128 v[56:59], v7 offset:36864
    v_mfma_f32_16x16x32_bf16 v[124:127], v[64:67], v[44:47], v[124:127]
    ds_read_b128 v[60:63], v7 offset:38912
    s_add_u32 m0, s57, 5120
    v_mfma_f32_16x16x32_bf16 v[140:143], v[68:71], v[44:47], v[140:143]
    buffer_load_dwordx4 v15, s[24:27], s53 offen  lds
    ds_read_b64_tr_b16 v[88:89], v18 offset:14336
    v_mfma_f32_16x16x32_bf16 v[136:139], v[68:71], v[40:43], v[136:139]
    ds_read_b64_tr_b16 v[90:91], v18 offset:15104
    v_mfma_f32_16x16x32_bf16 v[132:135], v[68:71], v[36:39], v[132:135]
    v_mfma_f32_16x16x32_bf16 v[128:131], v[68:71], v[32:35], v[128:131]
    ds_read_b64_tr_b16 v[92:93], v19 offset:14336
    s_add_u32 m0, s57, 6144
    v_mfma_f32_16x16x32_bf16 v[144:147], v[72:75], v[32:35], v[144:147]
    buffer_load_dwordx4 v16, s[24:27], s53 offen  lds
    ds_read_b64_tr_b16 v[94:95], v19 offset:15104
    v_mfma_f32_16x16x32_bf16 v[148:151], v[72:75], v[36:39], v[148:151]
    ds_read_b64_tr_b16 v[96:97], v18 offset:14592
    v_mfma_f32_16x16x32_bf16 v[152:155], v[72:75], v[40:43], v[152:155]
    ds_read_b64_tr_b16 v[98:99], v18 offset:15360
    s_add_u32 m0, s57, 7168
    v_mfma_f32_16x16x32_bf16 v[156:159], v[72:75], v[44:47], v[156:159]
    buffer_load_dwordx4 v17, s[24:27], s53 offen  lds
    s_add_u32 s53, s53, 128
    ds_read_b64_tr_b16 v[100:101], v19 offset:14592
    v_mfma_f32_16x16x32_bf16 v[172:175], v[76:79], v[44:47], v[172:175]
    v_mfma_f32_16x16x32_bf16 v[168:171], v[76:79], v[40:43], v[168:171]
    ds_read_b64_tr_b16 v[102:103], v19 offset:15360
    v_mfma_f32_16x16x32_bf16 v[164:167], v[76:79], v[36:39], v[164:167]
    ds_read_b64_tr_b16 v[104:105], v18 offset:14848
    v_mfma_f32_16x16x32_bf16 v[160:163], v[76:79], v[32:35], v[160:163]
    ds_read_b64_tr_b16 v[106:107], v18 offset:15616
    buffer_load_dword v23, v20, s[40:43], s63 offen
    s_add_u32 s63, s63, s64
    v_mfma_f32_16x16x32_bf16 v[176:179], v[32:35], v[80:83], v[176:179]
    ds_read_b64_tr_b16 v[108:109], v19 offset:14848
    v_mfma_f32_16x16x32_bf16 v[180:183], v[36:39], v[80:83], v[180:183]
    ds_read_b64_tr_b16 v[110:111], v19 offset:15616
    v_mfma_f32_16x16x32_bf16 v[184:187], v[40:43], v[80:83], v[184:187]
    buffer_load_dwordx4 v[208:211], v21, s[44:47], s65 offen
    s_add_u32 s65, s65, 128
    buffer_load_dwordx4 v[212:215], v21, s[44:47], s65 offen
    s_add_u32 s65, s65, 128
    v_mfma_f32_16x16x32_bf16 v[188:191], v[44:47], v[80:83], v[188:191]
    v_mfma_f32_16x16x32_bf16 v[204:207], v[44:47], v[84:87], v[204:207]
    v_mfma_f32_16x16x32_bf16 v[200:203], v[40:43], v[84:87], v[200:203]
    v_mfma_f32_16x16x32_bf16 v[196:199], v[36:39], v[84:87], v[196:199]
    v_mfma_f32_16x16x32_bf16 v[192:195], v[32:35], v[84:87], v[192:195]
    s_waitcnt vmcnt(16) lgkmcnt(0)
    s_barrier
    v_mfma_f32_16x16x32_bf16 v[112:115], v[88:91], v[48:51], v[112:115]
    ds_read_b128 v[32:35], v8 offset:0
    s_add_u32 m0, s57, 32768
    v_mfma_f32_16x16x32_bf16 v[116:119], v[88:91], v[52:55], v[116:119]
    buffer_load_dwordx4 v10, s[24:27], s53 offen  lds
    ds_read_b128 v[36:39], v8 offset:2048
    v_mfma_f32_16x16x32_bf16 v[120:123], v[88:91], v[56:59], v[120:123]
    ds_read_b128 v[40:43], v8 offset:4096
    v_mfma_f32_16x16x32_bf16 v[124:127], v[88:91], v[60:63], v[124:127]
    ds_read_b128 v[44:47], v8 offset:6144
    v_mfma_f32_16x16x32_bf16 v[140:143], v[92:95], v[60:63], v[140:143]
    ds_read_b64_tr_b16 v[64:65], v18 offset:28672
    v_mfma_f32_16x16x32_bf16 v[136:139], v[92:95], v[56:59], v[136:139]
    ds_read_b64_tr_b16 v[66:67], v18 offset:29440
    s_add_u32 m0, s57, 33792
    v_mfma_f32_16x16x32_bf16 v[132:135], v[92:95], v[52:55], v[132:135]
    buffer_load_dwordx4 v11, s[24:27], s53 offen  lds
    v_mfma_f32_16x16x32_bf16 v[128:131], v[92:95], v[48:51], v[128:131]
    ds_read_b64_tr_b16 v[68:69], v19 offset:28672
    v_mfma_f32_16x16x32_bf16 v[144:147], v[96:99], v[48:51], v[144:147]
    ds_read_b64_tr_b16 v[70:71], v19 offset:29440
    v_mfma_f32_16x16x32_bf16 v[148:151], v[96:99], v[52:55], v[148:151]
    ds_read_b64_tr_b16 v[72:73], v18 offset:28928
    v_mfma_f32_16x16x32_bf16 v[152:155], v[96:99], v[56:59], v[152:155]
    ds_read_b64_tr_b16 v[74:75], v18 offset:29696
    s_add_u32 m0, s57, 34816
    v_mfma_f32_16x16x32_bf16 v[156:159], v[96:99], v[60:63], v[156:159]
    buffer_load_dwordx4 v12, s[24:27], s53 offen  lds
    ds_read_b64_tr_b16 v[76:77], v19 offset:28928
    v_mfma_f32_16x16x32_bf16 v[172:175], v[100:103], v[60:63], v[172:175]
    v_mfma_f32_16x16x32_bf16 v[168:171], v[100:103], v[56:59], v[168:171]
    ds_read_b64_tr_b16 v[78:79], v19 offset:29696
    v_mfma_f32_16x16x32_bf16 v[164:167], v[100:103], v[52:55], v[164:167]
    ds_read_b64_tr_b16 v[80:81], v18 offset:29184
    v_mfma_f32_16x16x32_bf16 v[160:163], v[100:103], v[48:51], v[160:163]
    ds_read_b64_tr_b16 v[82:83], v18 offset:29952
    s_add_u32 m0, s57, 35840
    v_mfma_f32_16x16x32_bf16 v[176:179], v[48:51], v[104:107], v[176:179]
    buffer_load_dwordx4 v13, s[24:27], s53 offen  lds
    ds_read_b64_tr_b16 v[84:85], v19 offset:29184
    v_mfma_f32_16x16x32_bf16 v[180:183], v[52:55], v[104:107], v[180:183]
    ds_read_b64_tr_b16 v[86:87], v19 offset:29952
    v_mfma_f32_16x16x32_bf16 v[184:187], v[56:59], v[104:107], v[184:187]
    v_mfma_f32_16x16x32_bf16 v[188:191], v[60:63], v[104:107], v[188:191]
    v_mfma_f32_16x16x32_bf16 v[204:207], v[60:63], v[108:111], v[204:207]
    v_mfma_f32_16x16x32_bf16 v[200:203], v[56:59], v[108:111], v[200:203]
    v_mfma_f32_16x16x32_bf16 v[196:199], v[52:55], v[108:111], v[196:199]
    v_mfma_f32_16x16x32_bf16 v[192:195], v[48:51], v[108:111], v[192:195]
    s_waitcnt vmcnt(20) lgkmcnt(0)
    s_barrier
    v_mfma_f32_16x16x32_bf16 v[112:115], v[64:67], v[32:35], v[112:115]
    ds_read_b128 v[48:51], v9 offset:0
    s_add_u32 m0, s57, 36864
    v_mfma_f32_16x16x32_bf16 v[116:119], v[64:67], v[36:39], v[116:119]
    buffer_load_dwordx4 v14, s[24:27], s53 offen  lds
    ds_read_b128 v[52:55], v9 offset:2048
    v_mfma_f32_16x16x32_bf16 v[120:123], v[64:67], v[40:43], v[120:123]
    ds_read_b128 v[56:59], v9 offset:4096
    v_mfma_f32_16x16x32_bf16 v[124:127], v[64:67], v[44:47], v[124:127]
    ds_read_b128 v[60:63], v9 offset:6144
    s_add_u32 m0, s57, 37888
    v_mfma_f32_16x16x32_bf16 v[140:143], v[68:71], v[44:47], v[140:143]
    buffer_load_dwordx4 v15, s[24:27], s53 offen  lds
    ds_read_b64_tr_b16 v[88:89], v18 offset:43008
    v_mfma_f32_16x16x32_bf16 v[136:139], v[68:71], v[40:43], v[136:139]
    ds_read_b64_tr_b16 v[90:91], v18 offset:43776
    v_mfma_f32_16x16x32_bf16 v[132:135], v[68:71], v[36:39], v[132:135]
    v_mfma_f32_16x16x32_bf16 v[128:131], v[68:71], v[32:35], v[128:131]
    ds_read_b64_tr_b16 v[92:93], v19 offset:43008
    s_add_u32 m0, s57, 38912
    v_mfma_f32_16x16x32_bf16 v[144:147], v[72:75], v[32:35], v[144:147]
    buffer_load_dwordx4 v16, s[24:27], s53 offen  lds
    ds_read_b64_tr_b16 v[94:95], v19 offset:43776
    v_mfma_f32_16x16x32_bf16 v[148:151], v[72:75], v[36:39], v[148:151]
    ds_read_b64_tr_b16 v[96:97], v18 offset:43264
    v_mfma_f32_16x16x32_bf16 v[152:155], v[72:75], v[40:43], v[152:155]
    ds_read_b64_tr_b16 v[98:99], v18 offset:44032
    s_add_u32 m0, s57, 39936
    v_mfma_f32_16x16x32_bf16 v[156:159], v[72:75], v[44:47], v[156:159]
    buffer_load_dwordx4 v17, s[24:27], s53 offen  lds
    s_add_u32 s53, s53, 128
    ds_read_b64_tr_b16 v[100:101], v19 offset:43264
    v_mfma_f32_16x16x32_bf16 v[172:175], v[76:79], v[44:47], v[172:175]
    v_mfma_f32_16x16x32_bf16 v[168:171], v[76:79], v[40:43], v[168:171]
    ds_read_b64_tr_b16 v[102:103], v19 offset:44032
    v_mfma_f32_16x16x32_bf16 v[164:167], v[76:79], v[36:39], v[164:167]
    ds_read_b64_tr_b16 v[104:105], v18 offset:43520
    v_mfma_f32_16x16x32_bf16 v[160:163], v[76:79], v[32:35], v[160:163]
    ds_read_b64_tr_b16 v[106:107], v18 offset:44288
    buffer_load_dword v23, v20, s[40:43], s63 offen
    s_add_u32 s63, s63, s64
    v_mfma_f32_16x16x32_bf16 v[176:179], v[32:35], v[80:83], v[176:179]
    ds_read_b64_tr_b16 v[108:109], v19 offset:43520
    v_mfma_f32_16x16x32_bf16 v[180:183], v[36:39], v[80:83], v[180:183]
    ds_read_b64_tr_b16 v[110:111], v19 offset:44288
    v_mfma_f32_16x16x32_bf16 v[184:187], v[40:43], v[80:83], v[184:187]
    buffer_load_dwordx4 v[216:219], v21, s[44:47], s65 offen
    s_add_u32 s65, s65, 128
    buffer_load_dwordx4 v[220:223], v21, s[44:47], s65 offen
    s_add_u32 s65, s65, 128
    v_mfma_f32_16x16x32_bf16 v[188:191], v[44:47], v[80:83], v[188:191]
    v_mfma_f32_16x16x32_bf16 v[204:207], v[44:47], v[84:87], v[204:207]
    v_mfma_f32_16x16x32_bf16 v[200:203], v[40:43], v[84:87], v[200:203]
    v_mfma_f32_16x16x32_bf16 v[196:199], v[36:39], v[84:87], v[196:199]
    v_mfma_f32_16x16x32_bf16 v[192:195], v[32:35], v[84:87], v[192:195]
    s_waitcnt vmcnt(14) lgkmcnt(0)
    s_barrier
    v_mfma_f32_16x16x32_bf16 v[112:115], v[88:91], v[48:51], v[112:115]
    ds_read_b128 v[32:35], v6 offset:0
    s_add_u32 m0, s57, 65536
    v_mfma_f32_16x16x32_bf16 v[116:119], v[88:91], v[52:55], v[116:119]
    buffer_load_dwordx4 v10, s[24:27], s53 offen  lds
    ds_read_b128 v[36:39], v6 offset:2048
    v_mfma_f32_16x16x32_bf16 v[120:123], v[88:91], v[56:59], v[120:123]
    ds_read_b128 v[40:43], v6 offset:4096
    v_mfma_f32_16x16x32_bf16 v[124:127], v[88:91], v[60:63], v[124:127]
    ds_read_b128 v[44:47], v6 offset:6144
    v_mfma_f32_16x16x32_bf16 v[140:143], v[92:95], v[60:63], v[140:143]
    ds_read_b64_tr_b16 v[64:65], v18 offset:0
    v_mfma_f32_16x16x32_bf16 v[136:139], v[92:95], v[56:59], v[136:139]
    ds_read_b64_tr_b16 v[66:67], v18 offset:768
    s_add_u32 m0, s57, 66560
    v_mfma_f32_16x16x32_bf16 v[132:135], v[92:95], v[52:55], v[132:135]
    buffer_load_dwordx4 v11, s[24:27], s53 offen  lds
    v_mfma_f32_16x16x32_bf16 v[128:131], v[92:95], v[48:51], v[128:131]
    ds_read_b64_tr_b16 v[68:69], v19 offset:0
    v_mfma_f32_16x16x32_bf16 v[144:147], v[96:99], v[48:51], v[144:147]
    ds_read_b64_tr_b16 v[70:71], v19 offset:768
    v_mfma_f32_16x16x32_bf16 v[148:151], v[96:99], v[52:55], v[148:151]
    ds_read_b64_tr_b16 v[72:73], v18 offset:256
    v_mfma_f32_16x16x32_bf16 v[152:155], v[96:99], v[56:59], v[152:155]
    ds_read_b64_tr_b16 v[74:75], v18 offset:1024
    s_add_u32 m0, s57, 67584
    v_mfma_f32_16x16x32_bf16 v[156:159], v[96:99], v[60:63], v[156:159]
    buffer_load_dwordx4 v12, s[24:27], s53 offen  lds
    ds_read_b64_tr_b16 v[76:77], v19 offset:256
    v_mfma_f32_16x16x32_bf16 v[172:175], v[100:103], v[60:63], v[172:175]
    v_mfma_f32_16x16x32_bf16 v[168:171], v[100:103], v[56:59], v[168:171]
    ds_read_b64_tr_b16 v[78:79], v19 offset:1024
    v_mfma_f32_16x16x32_bf16 v[164:167], v[100:103], v[52:55], v[164:167]
    ds_read_b64_tr_b16 v[80:81], v18 offset:512
    v_mfma_f32_16x16x32_bf16 v[160:163], v[100:103], v[48:51], v[160:163]
    ds_read_b64_tr_b16 v[82:83], v18 offset:1280
    s_add_u32 m0, s57, 68608
    v_mfma_f32_16x16x32_bf16 v[176:179], v[48:51], v[104:107], v[176:179]
    buffer_load_dwordx4 v13, s[24:27], s53 offen  lds
    ds_read_b64_tr_b16 v[84:85], v19 offset:512
    v_mfma_f32_16x16x32_bf16 v[180:183], v[52:55], v[104:107], v[180:183]
    ds_read_b64_tr_b16 v[86:87], v19 offset:1280
    v_mfma_f32_16x16x32_bf16 v[184:187], v[56:59], v[104:107], v[184:187]
    v_mfma_f32_16x16x32_bf16 v[188:191], v[60:63], v[104:107], v[188:191]
    v_mfma_f32_16x16x32_bf16 v[204:207], v[60:63], v[108:111], v[204:207]
    v_mfma_f32_16x16x32_bf16 v[200:203], v[56:59], v[108:111], v[200:203]
    v_mfma_f32_16x16x32_bf16 v[196:199], v[52:55], v[108:111], v[196:199]
    v_mfma_f32_16x16x32_bf16 v[192:195], v[48:51], v[108:111], v[192:195]
    s_waitcnt vmcnt(18) lgkmcnt(0)
    s_barrier
    v_mfma_f32_16x16x32_bf16 v[112:115], v[64:67], v[32:35], v[112:115]
    ds_read_b128 v[48:51], v7 offset:0
    s_add_u32 m0, s57, 69632
    v_mfma_f32_16x16x32_bf16 v[116:119], v[64:67], v[36:39], v[116:119]
    buffer_load_dwordx4 v14, s[24:27], s53 offen  lds
    ds_read_b128 v[52:55], v7 offset:2048
    v_mfma_f32_16x16x32_bf16 v[120:123], v[64:67], v[40:43], v[120:123]
    ds_read_b128 v[56:59], v7 offset:4096
    v_mfma_f32_16x16x32_bf16 v[124:127], v[64:67], v[44:47], v[124:127]
    ds_read_b128 v[60:63], v7 offset:6144
    s_add_u32 m0, s57, 70656
    v_mfma_f32_16x16x32_bf16 v[140:143], v[68:71], v[44:47], v[140:143]
    buffer_load_dwordx4 v15, s[24:27], s53 offen  lds
    ds_read_b64_tr_b16 v[88:89], v18 offset:14336
    v_mfma_f32_16x16x32_bf16 v[136:139], v[68:71], v[40:43], v[136:139]
    ds_read_b64_tr_b16 v[90:91], v18 offset:15104
    v_mfma_f32_16x16x32_bf16 v[132:135], v[68:71], v[36:39], v[132:135]
    v_mfma_f32_16x16x32_bf16 v[128:131], v[68:71], v[32:35], v[128:131]
    ds_read_b64_tr_b16 v[92:93], v19 offset:14336
    s_add_u32 m0, s57, 71680
    v_mfma_f32_16x16x32_bf16 v[144:147], v[72:75], v[32:35], v[144:147]
    buffer_load_dwordx4 v16, s[24:27], s53 offen  lds
    ds_read_b64_tr_b16 v[94:95], v19 offset:15104
    v_mfma_f32_16x16x32_bf16 v[148:151], v[72:75], v[36:39], v[148:151]
    ds_read_b64_tr_b16 v[96:97], v18 offset:14592
    v_mfma_f32_16x16x32_bf16 v[152:155], v[72:75], v[40:43], v[152:155]
    ds_read_b64_tr_b16 v[98:99], v18 offset:15360
    s_add_u32 m0, s57, 72704
    v_mfma_f32_16x16x32_bf16 v[156:159], v[72:75], v[44:47], v[156:159]
    buffer_load_dwordx4 v17, s[24:27], s53 offen  lds
    s_add_u32 s53, s53, 128
    ds_read_b64_tr_b16 v[100:101], v19 offset:14592
    v_mfma_f32_16x16x32_bf16 v[172:175], v[76:79], v[44:47], v[172:175]
    v_mfma_f32_16x16x32_bf16 v[168:171], v[76:79], v[40:43], v[168:171]
    ds_read_b64_tr_b16 v[102:103], v19 offset:15360
    v_mfma_f32_16x16x32_bf16 v[164:167], v[76:79], v[36:39], v[164:167]
    ds_read_b64_tr_b16 v[104:105], v18 offset:14848
    v_mfma_f32_16x16x32_bf16 v[160:163], v[76:79], v[32:35], v[160:163]
    ds_read_b64_tr_b16 v[106:107], v18 offset:15616
    buffer_load_dword v23, v20, s[40:43], s63 offen
    s_add_u32 s63, s63, s64
    v_mfma_f32_16x16x32_bf16 v[176:179], v[32:35], v[80:83], v[176:179]
    ds_read_b64_tr_b16 v[108:109], v19 offset:14848
    v_mfma_f32_16x16x32_bf16 v[180:183], v[36:39], v[80:83], v[180:183]
    ds_read_b64_tr_b16 v[110:111], v19 offset:15616
    v_mfma_f32_16x16x32_bf16 v[184:187], v[40:43], v[80:83], v[184:187]
    s_waitcnt vmcnt(20)
    buffer_store_dwordx4 v[208:211], v22, s[36:39], s66 offen sc1
    s_add_u32 s66, s66, 360448
    buffer_store_dwordx4 v[212:215], v22, s[36:39], s66 offen sc1
    s_add_u32 s66, s66, 360448
    v_mfma_f32_16x16x32_bf16 v[188:191], v[44:47], v[80:83], v[188:191]
    v_mfma_f32_16x16x32_bf16 v[204:207], v[44:47], v[84:87], v[204:207]
    v_mfma_f32_16x16x32_bf16 v[200:203], v[40:43], v[84:87], v[200:203]
    v_mfma_f32_16x16x32_bf16 v[196:199], v[36:39], v[84:87], v[196:199]
    v_mfma_f32_16x16x32_bf16 v[192:195], v[32:35], v[84:87], v[192:195]
    s_waitcnt vmcnt(14) lgkmcnt(0)
    s_barrier
    v_mfma_f32_16x16x32_bf16 v[112:115], v[88:91], v[48:51], v[112:115]
    ds_read_b128 v[32:35], v6 offset:32768
    s_add_u32 m0, s57, 0
    v_mfma_f32_16x16x32_bf16 v[116:119], v[88:91], v[52:55], v[116:119]
    buffer_load_dwordx4 v10, s[24:27], s53 offen  lds
    ds_read_b128 v[36:39], v6 offset:34816
    v_mfma_f32_16x16x32_bf16 v[120:123], v[88:91], v[56:59], v[120:123]
    ds_read_b128 v[40:43], v6 offset:36864
    v_mfma_f32_16x16x32_bf16 v[124:127], v[88:91], v[60:63], v[124:127]
    ds_read_b128 v[44:47], v6 offset:38912
    v_mfma_f32_16x16x32_bf16 v[140:143], v[92:95], v[60:63], v[140:143]
    ds_read_b64_tr_b16 v[64:65], v18 offset:28672
    s_add_u32 m0, s57, 1024
    v_mfma_f32_16x16x32_bf16 v[136:139], v[92:95], v[56:59], v[136:139]
    buffer_load_dwordx4 v11, s[24:27], s53 offen  lds
    ds_read_b64_tr_b16 v[66:67], v18 offset:29440
    v_mfma_f32_16x16x32_bf16 v[132:135], v[92:95], v[52:55], v[132:135]
    v_mfma_f32_16x16x32_bf16 v[128:131], v[92:95], v[48:51], v[128:131]
    ds_read_b64_tr_b16 v[68:69], v19 offset:28672
    v_mfma_f32_16x16x32_bf16 v[144:147], v[96:99], v[48:51], v[144:147]
    ds_read_b64_tr_b16 v[70:71], v19 offset:29440
    s_add_u32 m0, s57, 2048
    v_mfma_f32_16x16x32_bf16 v[148:151], v[96:99], v[52:55], v[148:151]
    buffer_load_dwordx4 v12, s[24:27], s53 offen  lds
    ds_read_b64_tr_b16 v[72:73], v18 offset:28928
    v_mfma_f32_16x16x32_bf16 v[152:155], v[96:99], v[56:59], v[152:155]
    ds_read_b64_tr_b16 v[74:75], v18 offset:29696
    v_mfma_f32_16x16x32_bf16 v[156:159], v[96:99], v[60:63], v[156:159]
    ds_read_b64_tr_b16 v[76:77], v19 offset:28928
    v_mfma_f32_16x16x32_bf16 v[172:175], v[100:103], v[60:63], v[172:175]
    s_add_u32 m0, s57, 3072
    v_mfma_f32_16x16x32_bf16 v[168:171], v[100:103], v[56:59], v[168:171]
    buffer_load_dwordx4 v13, s[24:27], s53 offen  lds
    ds_read_b64_tr_b16 v[78:79], v19 offset:29696
    v_mfma_f32_16x16x32_bf16 v[164:167], v[100:103], v[52:55], v[164:167]
    ds_read_b64_tr_b16 v[80:81], v18 offset:29184
    v_mfma_f32_16x16x32_bf16 v[160:163], v[100:103], v[48:51], v[160:163]
    ds_read_b64_tr_b16 v[82:83], v18 offset:29952
    v_mfma_f32_16x16x32_bf16 v[176:179], v[48:51], v[104:107], v[176:179]
    ds_read_b64_tr_b16 v[84:85], v19 offset:29184
    v_mfma_f32_16x16x32_bf16 v[180:183], v[52:55], v[104:107], v[180:183]
    ds_read_b64_tr_b16 v[86:87], v19 offset:29952
    s_waitcnt vmcnt(15)
    buffer_store_dwordx4 v[216:219], v22, s[36:39], s66 offen sc1
    s_add_u32 s66, s66, 360448
    buffer_store_dwordx4 v[220:223], v22, s[36:39], s66 offen sc1
    s_add_u32 s66, s66, 360448
    v_mfma_f32_16x16x32_bf16 v[184:187], v[56:59], v[104:107], v[184:187]
    v_mfma_f32_16x16x32_bf16 v[188:191], v[60:63], v[104:107], v[188:191]
    v_mfma_f32_16x16x32_bf16 v[204:207], v[60:63], v[108:111], v[204:207]
    v_mfma_f32_16x16x32_bf16 v[200:203], v[56:59], v[108:111], v[200:203]
    v_mfma_f32_16x16x32_bf16 v[196:199], v[52:55], v[108:111], v[196:199]
    v_mfma_f32_16x16x32_bf16 v[192:195], v[48:51], v[108:111], v[192:195]
    s_waitcnt vmcnt(20) lgkmcnt(0)
    s_barrier
    s_add_u32 s67, s67, 1
    s_cmp_lt_u32 s67, 2
    s_cbranch_scc1 L_s1_kernel_loopA
    v_mfma_f32_16x16x32_bf16 v[112:115], v[64:67], v[32:35], v[112:115]
    ds_read_b128 v[48:51], v7 offset:32768
    s_add_u32 m0, s57, 4096
    v_mfma_f32_16x16x32_bf16 v[116:119], v[64:67], v[36:39], v[116:119]
    buffer_load_dwordx4 v14, s[24:27], s53 offen  lds
    ds_read_b128 v[52:55], v7 offset:34816
    v_mfma_f32_16x16x32_bf16 v[120:123], v[64:67], v[40:43], v[120:123]
    ds_read_b128 v[56:59], v7 offset:36864
    v_mfma_f32_16x16x32_bf16 v[124:127], v[64:67], v[44:47], v[124:127]
    ds_read_b128 v[60:63], v7 offset:38912
    v_mfma_f32_16x16x32_bf16 v[140:143], v[68:71], v[44:47], v[140:143]
    ds_read_b64_tr_b16 v[88:89], v18 offset:43008
    s_add_u32 m0, s57, 5120
    v_mfma_f32_16x16x32_bf16 v[136:139], v[68:71], v[40:43], v[136:139]
    buffer_load_dwordx4 v15, s[24:27], s53 offen  lds
    ds_read_b64_tr_b16 v[90:91], v18 offset:43776
    v_mfma_f32_16x16x32_bf16 v[132:135], v[68:71], v[36:39], v[132:135]
    v_mfma_f32_16x16x32_bf16 v[128:131], v[68:71], v[32:35], v[128:131]
    ds_read_b64_tr_b16 v[92:93], v19 offset:43008
    v_mfma_f32_16x16x32_bf16 v[144:147], v[72:75], v[32:35], v[144:147]
    ds_read_b64_tr_b16 v[94:95], v19 offset:43776
    s_add_u32 m0, s57, 6144
    v_mfma_f32_16x16x32_bf16 v[148:151], v[72:75], v[36:39], v[148:151]
    buffer_load_dwordx4 v16, s[24:27], s53 offen  lds
    ds_read_b64_tr_b16 v[96:97], v18 offset:43264
    v_mfma_f32_16x16x32_bf16 v[152:155], v[72:75], v[40:43], v[152:155]
    ds_read_b64_tr_b16 v[98:99], v18 offset:44032
    v_mfma_f32_16x16x32_bf16 v[156:159], v[72:75], v[44:47], v[156:159]
    ds_read_b64_tr_b16 v[100:101], v19 offset:43264
    v_mfma_f32_16x16x32_bf16 v[172:175], v[76:79], v[44:47], v[172:175]
    s_add_u32 m0, s57, 7168
    v_mfma_f32_16x16x32_bf16 v[168:171], v[76:79], v[40:43], v[168:171]
    buffer_load_dwordx4 v17, s[24:27], s53 offen  lds
    s_add_u32 s53, s53, 128
    ds_read_b64_tr_b16 v[102:103], v19 offset:44032
    v_mfma_f32_16x16x32_bf16 v[164:167], v[76:79], v[36:39], v[164:167]
    ds_read_b64_tr_b16 v[104:105], v18 offset:43520
    v_mfma_f32_16x16x32_bf16 v[160:163], v[76:79], v[32:35], v[160:163]
    ds_read_b64_tr_b16 v[106:107], v18 offset:44288
    v_mfma_f32_16x16x32_bf16 v[176:179], v[32:35], v[80:83], v[176:179]
    ds_read_b64_tr_b16 v[108:109], v19 offset:43520
    v_mfma_f32_16x16x32_bf16 v[180:183], v[36:39], v[80:83], v[180:183]
    ds_read_b64_tr_b16 v[110:111], v19 offset:44288
    s_lshl_b32 s68, s50, 8
    s_lshl_b32 s69, s51, 3
    s_add_u32 s68, s68, s69
    s_add_u32 s68, s68, s48
    s_lshl_b32 s63, s68, 2
    s_add_u32 s63, s63, 33816576
    s_lshl_b32 s68, s68, 11
    s_mov_b32 s40, s18
    s_mov_b32 s41, s19
    s_mov_b32 s42, 2048
    s_mov_b32 s43, 0x20000
    buffer_load_dwordx4 v[232:235], v22, s[24:27], s68 offen
    buffer_load_dwordx4 v[236:239], v22, s[24:27], s68 offen offset:1024
    buffer_load_dwordx4 v[240:243], v22, s[40:43], 0 offen
    buffer_load_dwordx4 v[244:247], v22, s[40:43], 0 offen offset:1024
    v_mfma_f32_16x16x32_bf16 v[184:187], v[40:43], v[80:83], v[184:187]
    v_mfma_f32_16x16x32_bf16 v[188:191], v[44:47], v[80:83], v[188:191]
    v_mfma_f32_16x16x32_bf16 v[204:207], v[44:47], v[84:87], v[204:207]
    v_mfma_f32_16x16x32_bf16 v[200:203], v[40:43], v[84:87], v[200:203]
    v_mfma_f32_16x16x32_bf16 v[196:199], v[36:39], v[84:87], v[196:199]
    v_mfma_f32_16x16x32_bf16 v[192:195], v[32:35], v[84:87], v[192:195]
    s_waitcnt vmcnt(17) lgkmcnt(0)
    s_barrier
    v_mfma_f32_16x16x32_bf16 v[112:115], v[88:91], v[48:51], v[112:115]
    ds_read_b128 v[32:35], v8 offset:0
    v_mfma_f32_16x16x32_bf16 v[116:119], v[88:91], v[52:55], v[116:119]
    ds_read_b128 v[36:39], v8 offset:2048
    v_mfma_f32_16x16x32_bf16 v[120:123], v[88:91], v[56:59], v[120:123]
    ds_read_b128 v[40:43], v8 offset:4096
    v_mfma_f32_16x16x32_bf16 v[124:127], v[88:91], v[60:63], v[124:127]
    ds_read_b128 v[44:47], v8 offset:6144
    v_mfma_f32_16x16x32_bf16 v[140:143], v[92:95], v[60:63], v[140:143]
    ds_read_b64_tr_b16 v[64:65], v18 offset:0
    v_mfma_f32_16x16x32_bf16 v[136:139], v[92:95], v[56:59], v[136:139]
    ds_read_b64_tr_b16 v[66:67], v18 offset:768
    v_mfma_f32_16x16x32_bf16 v[132:135], v[92:95], v[52:55], v[132:135]
    v_mfma_f32_16x16x32_bf16 v[128:131], v[92:95], v[48:51], v[128:131]
    ds_read_b64_tr_b16 v[68:69], v19 offset:0
    v_mfma_f32_16x16x32_bf16 v[144:147], v[96:99], v[48:51], v[144:147]
    ds_read_b64_tr_b16 v[70:71], v19 offset:768
    v_mfma_f32_16x16x32_bf16 v[148:151], v[96:99], v[52:55], v[148:151]
    ds_read_b64_tr_b16 v[72:73], v18 offset:256
    v_mfma_f32_16x16x32_bf16 v[152:155], v[96:99], v[56:59], v[152:155]
    ds_read_b64_tr_b16 v[74:75], v18 offset:1024
    v_mfma_f32_16x16x32_bf16 v[156:159], v[96:99], v[60:63], v[156:159]
    ds_read_b64_tr_b16 v[76:77], v19 offset:256
    v_mfma_f32_16x16x32_bf16 v[172:175], v[100:103], v[60:63], v[172:175]
    v_mfma_f32_16x16x32_bf16 v[168:171], v[100:103], v[56:59], v[168:171]
    ds_read_b64_tr_b16 v[78:79], v19 offset:1024
    v_mfma_f32_16x16x32_bf16 v[164:167], v[100:103], v[52:55], v[164:167]
    ds_read_b64_tr_b16 v[80:81], v18 offset:512
    v_mfma_f32_16x16x32_bf16 v[160:163], v[100:103], v[48:51], v[160:163]
    ds_read_b64_tr_b16 v[82:83], v18 offset:1280
    v_mfma_f32_16x16x32_bf16 v[176:179], v[48:51], v[104:107], v[176:179]
    ds_read_b64_tr_b16 v[84:85], v19 offset:512
    v_mfma_f32_16x16x32_bf16 v[180:183], v[52:55], v[104:107], v[180:183]
    ds_read_b64_tr_b16 v[86:87], v19 offset:1280
    v_mfma_f32_16x16x32_bf16 v[184:187], v[56:59], v[104:107], v[184:187]
    v_mfma_f32_16x16x32_bf16 v[188:191], v[60:63], v[104:107], v[188:191]
    v_mfma_f32_16x16x32_bf16 v[204:207], v[60:63], v[108:111], v[204:207]
    v_mfma_f32_16x16x32_bf16 v[200:203], v[56:59], v[108:111], v[200:203]
    v_mfma_f32_16x16x32_bf16 v[196:199], v[52:55], v[108:111], v[196:199]
    v_mfma_f32_16x16x32_bf16 v[192:195], v[48:51], v[108:111], v[192:195]
    s_waitcnt vmcnt(17) lgkmcnt(0)
    s_barrier
    v_mfma_f32_16x16x32_bf16 v[112:115], v[64:67], v[32:35], v[112:115]
    ds_read_b128 v[48:51], v9 offset:0
    s_waitcnt vmcnt(0)
    v_mfma_f32_16x16x32_bf16 v[116:119], v[64:67], v[36:39], v[116:119]
    ds_read_b128 v[52:55], v9 offset:2048
    v_mov_b32 v250, 0
    v_mov_b32 v251, 0
    v_mfma_f32_16x16x32_bf16 v[120:123], v[64:67], v[40:43], v[120:123]
    ds_read_b128 v[56:59], v9 offset:4096
    v_lshlrev_b32 v248, 16, v232
    v_mfma_f32_16x16x32_bf16 v[124:127], v[64:67], v[44:47], v[124:127]
    ds_read_b128 v[60:63], v9 offset:6144
    v_and_b32 v249, 0xffff0000, v232
    v_mfma_f32_16x16x32_bf16 v[140:143], v[68:71], v[44:47], v[140:143]
    ds_read_b64_tr_b16 v[88:89], v18 offset:14336
    v_lshlrev_b32 v252, 16, v240
    v_mfma_f32_16x16x32_bf16 v[136:139], v[68:71], v[40:43], v[136:139]
    ds_read_b64_tr_b16 v[90:91], v18 offset:15104
    v_and_b32 v253, 0xffff0000, v240
    v_mfma_f32_16x16x32_bf16 v[132:135], v[68:71], v[36:39], v[132:135]
    v_fma_f32 v250, v248, v252, v250
    v_mfma_f32_16x16x32_bf16 v[128:131], v[68:71], v[32:35], v[128:131]
    ds_read_b64_tr_b16 v[92:93], v19 offset:14336
    v_fma_f32 v251, v249, v253, v251
    v_mfma_f32_16x16x32_bf16 v[144:147], v[72:75], v[32:35], v[144:147]
    ds_read_b64_tr_b16 v[94:95], v19 offset:15104
    v_lshlrev_b32 v248, 16, v233
    v_mfma_f32_16x16x32_bf16 v[148:151], v[72:75], v[36:39], v[148:151]
    ds_read_b64_tr_b16 v[96:97], v18 offset:14592
    v_and_b32 v249, 0xffff0000, v233
    v_mfma_f32_16x16x32_bf16 v[152:155], v[72:75], v[40:43], v[152:155]
    ds_read_b64_tr_b16 v[98:99], v18 offset:15360
    v_lshlrev_b32 v252, 16, v241
    v_mfma_f32_16x16x32_bf16 v[156:159], v[72:75], v[44:47], v[156:159]
    ds_read_b64_tr_b16 v[100:101], v19 offset:14592
    v_and_b32 v253, 0xffff0000, v241
    v_mfma_f32_16x16x32_bf16 v[172:175], v[76:79], v[44:47], v[172:175]
    v_fma_f32 v250, v248, v252, v250
    v_mfma_f32_16x16x32_bf16 v[168:171], v[76:79], v[40:43], v[168:171]
    ds_read_b64_tr_b16 v[102:103], v19 offset:15360
    v_fma_f32 v251, v249, v253, v251
    v_mfma_f32_16x16x32_bf16 v[164:167], v[76:79], v[36:39], v[164:167]
    ds_read_b64_tr_b16 v[104:105], v18 offset:14848
    v_lshlrev_b32 v248, 16, v234
    v_mfma_f32_16x16x32_bf16 v[160:163], v[76:79], v[32:35], v[160:163]
    ds_read_b64_tr_b16 v[106:107], v18 offset:15616
    v_and_b32 v249, 0xffff0000, v234
    v_mfma_f32_16x16x32_bf16 v[176:179], v[32:35], v[80:83], v[176:179]
    ds_read_b64_tr_b16 v[108:109], v19 offset:14848
    v_lshlrev_b32 v252, 16, v242
    v_mfma_f32_16x16x32_bf16 v[180:183], v[36:39], v[80:83], v[180:183]
    ds_read_b64_tr_b16 v[110:111], v19 offset:15616
    v_and_b32 v253, 0xffff0000, v242
    v_mfma_f32_16x16x32_bf16 v[184:187], v[40:43], v[80:83], v[184:187]
    v_fma_f32 v250, v248, v252, v250
    v_mfma_f32_16x16x32_bf16 v[188:191], v[44:47], v[80:83], v[188:191]
    v_fma_f32 v251, v249, v253, v251
    v_mfma_f32_16x16x32_bf16 v[204:207], v[44:47], v[84:87], v[204:207]
    v_lshlrev_b32 v248, 16, v235
    v_mfma_f32_16x16x32_bf16 v[200:203], v[40:43], v[84:87], v[200:203]
    v_and_b32 v249, 0xffff0000, v235
    v_mfma_f32_16x16x32_bf16 v[196:199], v[36:39], v[84:87], v[196:199]
    v_lshlrev_b32 v252, 16, v243
    v_mfma_f32_16x16x32_bf16 v[192:195], v[32:35], v[84:87], v[192:195]
    s_waitcnt vmcnt(4) lgkmcnt(0)
    s_barrier
    v_mfma_f32_16x16x32_bf16 v[112:115], v[88:91], v[48:51], v[112:115]
    ds_read_b128 v[32:35], v6 offset:0
    v_mfma_f32_16x16x32_bf16 v[116:119], v[88:91], v[52:55], v[116:119]
    ds_read_b128 v[36:39], v6 offset:2048
    s_mov_b32 s44, s14
    s_mov_b32 s45, s15
    s_mov_b32 s46, 8388608
    s_mov_b32 s47, 0x20000
    s_and_b32 s68, s2, 7
    s_lshr_b32 s70, s68, 1
    s_lshl_b32 s70, s70, 21
    s_lshr_b32 s71, s2, 3
    s_and_b32 s68, s68, 1
    s_lshl_b32 s68, s68, 5
    s_add_u32 s71, s71, s68
    s_lshl_b32 s71, s71, 15
    s_lshl_b32 s69, s49, 13
    s_add_u32 s68, s70, s71
    s_add_u32 s68, s68, s69
    v_lshlrev_b32 v21, 7, v1
    buffer_load_dword v23, v21, s[44:47], s68 offen
    v_and_b32 v253, 0xffff0000, v243
    v_fma_f32 v250, v248, v252, v250
    v_mfma_f32_16x16x32_bf16 v[120:123], v[88:91], v[56:59], v[120:123]
    ds_read_b128 v[40:43], v6 offset:4096
    v_fma_f32 v251, v249, v253, v251
    v_mfma_f32_16x16x32_bf16 v[124:127], v[88:91], v[60:63], v[124:127]
    ds_read_b128 v[44:47], v6 offset:6144
    v_lshlrev_b32 v248, 16, v236
    v_mfma_f32_16x16x32_bf16 v[140:143], v[92:95], v[60:63], v[140:143]
    ds_read_b64_tr_b16 v[64:65], v18 offset:28672
    v_and_b32 v249, 0xffff0000, v236
    v_mfma_f32_16x16x32_bf16 v[136:139], v[92:95], v[56:59], v[136:139]
    ds_read_b64_tr_b16 v[66:67], v18 offset:29440
    v_lshlrev_b32 v252, 16, v244
    v_mfma_f32_16x16x32_bf16 v[132:135], v[92:95], v[52:55], v[132:135]
    v_and_b32 v253, 0xffff0000, v244
    v_mfma_f32_16x16x32_bf16 v[128:131], v[92:95], v[48:51], v[128:131]
    ds_read_b64_tr_b16 v[68:69], v19 offset:28672
    v_fma_f32 v250, v248, v252, v250
    v_mfma_f32_16x16x32_bf16 v[144:147], v[96:99], v[48:51], v[144:147]
    ds_read_b64_tr_b16 v[70:71], v19 offset:29440
    v_fma_f32 v251, v249, v253, v251
    v_mfma_f32_16x16x32_bf16 v[148:151], v[96:99], v[52:55], v[148:151]
    ds_read_b64_tr_b16 v[72:73], v18 offset:28928
    v_lshlrev_b32 v248, 16, v237
    v_mfma_f32_16x16x32_bf16 v[152:155], v[96:99], v[56:59], v[152:155]
    ds_read_b64_tr_b16 v[74:75], v18 offset:29696
    v_and_b32 v249, 0xffff0000, v237
    v_mfma_f32_16x16x32_bf16 v[156:159], v[96:99], v[60:63], v[156:159]
    ds_read_b64_tr_b16 v[76:77], v19 offset:28928
    v_lshlrev_b32 v252, 16, v245
    v_mfma_f32_16x16x32_bf16 v[172:175], v[100:103], v[60:63], v[172:175]
    v_and_b32 v253, 0xffff0000, v245
    v_mfma_f32_16x16x32_bf16 v[168:171], v[100:103], v[56:59], v[168:171]
    ds_read_b64_tr_b16 v[78:79], v19 offset:29696
    v_fma_f32 v250, v248, v252, v250
    v_mfma_f32_16x16x32_bf16 v[164:167], v[100:103], v[52:55], v[164:167]
    ds_read_b64_tr_b16 v[80:81], v18 offset:29184
    v_fma_f32 v251, v249, v253, v251
    v_mfma_f32_16x16x32_bf16 v[160:163], v[100:103], v[48:51], v[160:163]
    ds_read_b64_tr_b16 v[82:83], v18 offset:29952
    v_lshlrev_b32 v248, 16, v238
    v_mfma_f32_16x16x32_bf16 v[176:179], v[48:51], v[104:107], v[176:179]
    ds_read_b64_tr_b16 v[84:85], v19 offset:29184
    v_and_b32 v249, 0xffff0000, v238
    v_mfma_f32_16x16x32_bf16 v[180:183], v[52:55], v[104:107], v[180:183]
    ds_read_b64_tr_b16 v[86:87], v19 offset:29952
    v_lshlrev_b32 v252, 16, v246
    v_mfma_f32_16x16x32_bf16 v[184:187], v[56:59], v[104:107], v[184:187]
    v_and_b32 v253, 0xffff0000, v246
    v_mfma_f32_16x16x32_bf16 v[188:191], v[60:63], v[104:107], v[188:191]
    v_fma_f32 v250, v248, v252, v250
    v_mfma_f32_16x16x32_bf16 v[204:207], v[60:63], v[108:111], v[204:207]
    v_fma_f32 v251, v249, v253, v251
    v_mfma_f32_16x16x32_bf16 v[200:203], v[56:59], v[108:111], v[200:203]
    v_lshlrev_b32 v248, 16, v239
    v_mfma_f32_16x16x32_bf16 v[196:199], v[52:55], v[108:111], v[196:199]
    v_and_b32 v249, 0xffff0000, v239
    v_mfma_f32_16x16x32_bf16 v[192:195], v[48:51], v[108:111], v[192:195]
    s_waitcnt vmcnt(5) lgkmcnt(0)
    s_barrier
    v_mfma_f32_16x16x32_bf16 v[112:115], v[64:67], v[32:35], v[112:115]
    ds_read_b128 v[48:51], v7 offset:0
    v_mfma_f32_16x16x32_bf16 v[116:119], v[64:67], v[36:39], v[116:119]
    ds_read_b128 v[52:55], v7 offset:2048
    v_lshlrev_b32 v252, 16, v247
    v_and_b32 v253, 0xffff0000, v247
    v_mfma_f32_16x16x32_bf16 v[120:123], v[64:67], v[40:43], v[120:123]
    ds_read_b128 v[56:59], v7 offset:4096
    v_fma_f32 v250, v248, v252, v250
    v_mfma_f32_16x16x32_bf16 v[124:127], v[64:67], v[44:47], v[124:127]
    ds_read_b128 v[60:63], v7 offset:6144
    v_fma_f32 v251, v249, v253, v251
    v_mfma_f32_16x16x32_bf16 v[140:143], v[68:71], v[44:47], v[140:143]
    ds_read_b64_tr_b16 v[88:89], v18 offset:43008
    v_add_f32 v248, v250, v251
    v_mfma_f32_16x16x32_bf16 v[136:139], v[68:71], v[40:43], v[136:139]
    ds_read_b64_tr_b16 v[90:91], v18 offset:43776
    v_add_f32_dpp v248, v248, v248 row_ror:8 row_mask:0xf bank_mask:0xf
    v_mfma_f32_16x16x32_bf16 v[132:135], v[68:71], v[36:39], v[132:135]
    s_nop 0
    v_add_f32_dpp v248, v248, v248 row_ror:4 row_mask:0xf bank_mask:0xf
    v_mfma_f32_16x16x32_bf16 v[128:131], v[68:71], v[32:35], v[128:131]
    ds_read_b64_tr_b16 v[92:93], v19 offset:43008
    v_add_f32_dpp v248, v248, v248 row_ror:2 row_mask:0xf bank_mask:0xf
    v_mfma_f32_16x16x32_bf16 v[144:147], v[72:75], v[32:35], v[144:147]
    ds_read_b64_tr_b16 v[94:95], v19 offset:43776
    v_add_f32_dpp v248, v248, v248 row_ror:1 row_mask:0xf bank_mask:0xf
    v_mfma_f32_16x16x32_bf16 v[148:151], v[72:75], v[36:39], v[148:151]
    ds_read_b64_tr_b16 v[96:97], v18 offset:43264
    v_mov_b32 v249, v248
    v_mfma_f32_16x16x32_bf16 v[152:155], v[72:75], v[40:43], v[152:155]
    ds_read_b64_tr_b16 v[98:99], v18 offset:44032
    v_permlane16_swap_b32 v248, v249
    v_mfma_f32_16x16x32_bf16 v[156:159], v[72:75], v[44:47], v[156:159]
    ds_read_b64_tr_b16 v[100:101], v19 offset:43264
    v_add_f32 v248, v248, v249
    v_mfma_f32_16x16x32_bf16 v[172:175], v[76:79], v[44:47], v[172:175]
    v_mov_b32 v249, v248
    v_mfma_f32_16x16x32_bf16 v[168:171], v[76:79], v[40:43], v[168:171]
    ds_read_b64_tr_b16 v[102:103], v19 offset:44032
    v_permlane32_swap_b32 v248, v249
    v_mfma_f32_16x16x32_bf16 v[164:167], v[76:79], v[36:39], v[164:167]
    ds_read_b64_tr_b16 v[104:105], v18 offset:43520
    v_add_f32 v248, v248, v249
    v_mfma_f32_16x16x32_bf16 v[160:163], v[76:79], v[32:35], v[160:163]
    ds_read_b64_tr_b16 v[106:107], v18 offset:44288
    v_mul_f32 v248, 0xbfb8aa3b, v248
    v_mfma_f32_16x16x32_bf16 v[176:179], v[32:35], v[80:83], v[176:179]
    ds_read_b64_tr_b16 v[108:109], v19 offset:43520
    v_exp_f32 v248, v248
    v_mfma_f32_16x16x32_bf16 v[180:183], v[36:39], v[80:83], v[180:183]
    ds_read_b64_tr_b16 v[110:111], v19 offset:44288
    v_add_f32 v248, 1.0, v248
    v_mfma_f32_16x16x32_bf16 v[184:187], v[40:43], v[80:83], v[184:187]
    v_rcp_f32 v248, v248
    v_mfma_f32_16x16x32_bf16 v[188:191], v[44:47], v[80:83], v[188:191]
    v_lshlrev_b32 v249, 2, v1
    v_mfma_f32_16x16x32_bf16 v[204:207], v[44:47], v[84:87], v[204:207]
    v_cmp_eq_u32 vcc, 0, v1
    v_mfma_f32_16x16x32_bf16 v[200:203], v[40:43], v[84:87], v[200:203]
    v_mov_b32 v250, 0x40000000
    v_mfma_f32_16x16x32_bf16 v[196:199], v[36:39], v[84:87], v[196:199]
    v_cndmask_b32 v249, v250, v249, vcc
    v_mfma_f32_16x16x32_bf16 v[192:195], v[32:35], v[84:87], v[192:195]
    s_waitcnt lgkmcnt(0)
    s_barrier
    v_mfma_f32_16x16x32_bf16 v[112:115], v[88:91], v[48:51], v[112:115]
    v_mfma_f32_16x16x32_bf16 v[116:119], v[88:91], v[52:55], v[116:119]
    v_mfma_f32_16x16x32_bf16 v[120:123], v[88:91], v[56:59], v[120:123]
    buffer_store_dword v248, v249, s[36:39], s63 offen
    v_mfma_f32_16x16x32_bf16 v[124:127], v[88:91], v[60:63], v[124:127]
    v_mfma_f32_16x16x32_bf16 v[140:143], v[92:95], v[60:63], v[140:143]
    v_mfma_f32_16x16x32_bf16 v[136:139], v[92:95], v[56:59], v[136:139]
    v_mfma_f32_16x16x32_bf16 v[132:135], v[92:95], v[52:55], v[132:135]
    v_mfma_f32_16x16x32_bf16 v[128:131], v[92:95], v[48:51], v[128:131]
    v_mfma_f32_16x16x32_bf16 v[144:147], v[96:99], v[48:51], v[144:147]
    v_mfma_f32_16x16x32_bf16 v[148:151], v[96:99], v[52:55], v[148:151]
    v_mfma_f32_16x16x32_bf16 v[152:155], v[96:99], v[56:59], v[152:155]
    v_mfma_f32_16x16x32_bf16 v[156:159], v[96:99], v[60:63], v[156:159]
    v_mfma_f32_16x16x32_bf16 v[172:175], v[100:103], v[60:63], v[172:175]
    v_mfma_f32_16x16x32_bf16 v[168:171], v[100:103], v[56:59], v[168:171]
    v_mfma_f32_16x16x32_bf16 v[164:167], v[100:103], v[52:55], v[164:167]
    v_mfma_f32_16x16x32_bf16 v[160:163], v[100:103], v[48:51], v[160:163]
    v_mfma_f32_16x16x32_bf16 v[176:179], v[48:51], v[104:107], v[176:179]
    v_mfma_f32_16x16x32_bf16 v[180:183], v[52:55], v[104:107], v[180:183]
    v_mfma_f32_16x16x32_bf16 v[184:187], v[56:59], v[104:107], v[184:187]
    v_mfma_f32_16x16x32_bf16 v[188:191], v[60:63], v[104:107], v[188:191]
    v_mfma_f32_16x16x32_bf16 v[204:207], v[60:63], v[108:111], v[204:207]
    v_mfma_f32_16x16x32_bf16 v[200:203], v[56:59], v[108:111], v[200:203]
    v_mfma_f32_16x16x32_bf16 v[196:199], v[52:55], v[108:111], v[196:199]
    v_mfma_f32_16x16x32_bf16 v[192:195], v[48:51], v[108:111], v[192:195]
    v_lshrrev_b32 v2, 2, v1
    v_lshlrev_b32 v2, 6, v2
    v_and_b32 v3, 3, v1
    v_lshlrev_b32 v3, 3, v3
    v_add_u32 v2, v2, v3
    v_add_u32 v2, 155648, v2
    ds_read_b64_tr_b16 v[32:33], v2 offset:0
    ds_read_b64_tr_b16 v[34:35], v2 offset:1024
    ds_read_b64_tr_b16 v[36:37], v2 offset:32
    ds_read_b64_tr_b16 v[38:39], v2 offset:1056
    s_lshl_b32 s68, s75, 7
    s_lshl_b32 s69, s50, 4
    s_add_u32 s68, s68, s69
    s_lshl_b32 s69, s49, 2
    s_add_u32 s68, s68, s69
    s_lshl_b32 s68, s68, 10
    s_add_u32 s68, s68, 11534336
    v_cvt_pk_bf16_f32 v40, v112, v113
    v_cvt_pk_bf16_f32 v41, v114, v115
    v_cvt_pk_bf16_f32 v42, v128, v129
    v_cvt_pk_bf16_f32 v43, v130, v131
    buffer_store_dwordx4 v[40:43], v22, s[36:39], s68 offen offset:0 sc1
    v_cvt_pk_bf16_f32 v44, v116, v117
    v_cvt_pk_bf16_f32 v45, v118, v119
    v_cvt_pk_bf16_f32 v46, v132, v133
    v_cvt_pk_bf16_f32 v47, v134, v135
    buffer_store_dwordx4 v[44:47], v22, s[36:39], s68 offen offset:1024 sc1
    v_cvt_pk_bf16_f32 v48, v120, v121
    v_cvt_pk_bf16_f32 v49, v122, v123
    v_cvt_pk_bf16_f32 v50, v136, v137
    v_cvt_pk_bf16_f32 v51, v138, v139
    buffer_store_dwordx4 v[48:51], v22, s[36:39], s68 offen offset:2048 sc1
    v_cvt_pk_bf16_f32 v52, v124, v125
    v_cvt_pk_bf16_f32 v53, v126, v127
    v_cvt_pk_bf16_f32 v54, v140, v141
    v_cvt_pk_bf16_f32 v55, v142, v143
    buffer_store_dwordx4 v[52:55], v22, s[36:39], s68 offen offset:3072 sc1
    v_cvt_pk_bf16_f32 v56, v144, v145
    v_cvt_pk_bf16_f32 v57, v146, v147
    v_cvt_pk_bf16_f32 v58, v160, v161
    v_cvt_pk_bf16_f32 v59, v162, v163
    v_cvt_pk_bf16_f32 v60, v148, v149
    v_cvt_pk_bf16_f32 v61, v150, v151
    v_cvt_pk_bf16_f32 v62, v164, v165
    v_cvt_pk_bf16_f32 v63, v166, v167
    v_cvt_pk_bf16_f32 v64, v152, v153
    v_cvt_pk_bf16_f32 v65, v154, v155
    v_cvt_pk_bf16_f32 v66, v168, v169
    v_cvt_pk_bf16_f32 v67, v170, v171
    v_cvt_pk_bf16_f32 v68, v156, v157
    v_cvt_pk_bf16_f32 v69, v158, v159
    v_cvt_pk_bf16_f32 v70, v172, v173
    v_cvt_pk_bf16_f32 v71, v174, v175
    s_waitcnt lgkmcnt(0)
    v_mfma_f32_16x16x32_bf16 v[112:115], v[32:35], v[56:59], 0
    v_mfma_f32_16x16x32_bf16 v[116:119], v[36:39], v[56:59], 0
    v_mfma_f32_16x16x32_bf16 v[120:123], v[32:35], v[60:63], 0
    v_mfma_f32_16x16x32_bf16 v[124:127], v[36:39], v[60:63], 0
    v_mfma_f32_16x16x32_bf16 v[128:131], v[32:35], v[64:67], 0
    v_mfma_f32_16x16x32_bf16 v[132:135], v[36:39], v[64:67], 0
    v_mfma_f32_16x16x32_bf16 v[136:139], v[32:35], v[68:71], 0
    v_mfma_f32_16x16x32_bf16 v[140:143], v[36:39], v[68:71], 0
    v_cvt_pk_bf16_f32 v72, v176, v177
    v_cvt_pk_bf16_f32 v73, v178, v179
    v_cvt_pk_bf16_f32 v74, v180, v181
    v_cvt_pk_bf16_f32 v75, v182, v183
    v_cvt_pk_bf16_f32 v76, v192, v193
    v_cvt_pk_bf16_f32 v77, v194, v195
    v_cvt_pk_bf16_f32 v78, v196, v197
    v_cvt_pk_bf16_f32 v79, v198, v199
    v_cvt_pk_bf16_f32 v80, v184, v185
    v_cvt_pk_bf16_f32 v81, v186, v187
    v_cvt_pk_bf16_f32 v82, v188, v189
    v_cvt_pk_bf16_f32 v83, v190, v191
    v_cvt_pk_bf16_f32 v84, v200, v201
    v_cvt_pk_bf16_f32 v85, v202, v203
    v_cvt_pk_bf16_f32 v86, v204, v205
    v_cvt_pk_bf16_f32 v87, v206, v207
    v_and_b32 v2, 15, v1
    v_lshlrev_b32 v2, 5, v2
    v_lshrrev_b32 v3, 4, v1
    v_lshlrev_b32 v3, 3, v3
    v_add_u32 v88, v2, v3
    s_lshl_b32 s68, s49, 13
    s_add_u32 s68, s68, 0
    v_add_u32 v88, s68, v88
    v_lshrrev_b32 v2, 2, v1
    v_lshlrev_b32 v2, 5, v2
    v_and_b32 v3, 3, v1
    v_lshlrev_b32 v3, 3, v3
    v_add_u32 v89, v2, v3
    v_add_u32 v89, s68, v89
    v_max3_f32 v144, v112, v113, v114
    v_min3_f32 v145, v112, v113, v114
    v_max3_f32 v144, v144, v115, v116
    v_min3_f32 v145, v145, v115, v116
    v_max3_f32 v144, v144, v117, v118
    v_min3_f32 v145, v145, v117, v118
    v_max_f32 v144, v144, v119
    v_min_f32 v145, v145, v119
    v_sub_f32 v145, 0, v145
    v_mov_b32 v146, v144
    v_mov_b32 v147, v145
    s_nop 0
    v_permlane16_swap_b32 v144, v146
    v_permlane16_swap_b32 v145, v147
    v_max_f32 v144, v144, v146
    v_max_f32 v145, v145, v147
    v_mov_b32 v146, v144
    v_mov_b32 v147, v145
    s_nop 0
    v_permlane32_swap_b32 v144, v146
    v_permlane32_swap_b32 v145, v147
    v_max_f32 v144, v144, v146
    v_max_f32 v145, v145, v147
    v_mul_f32 v148, 0xbfb8aa3b, v144
    v_mul_f32 v149, 0xbfb8aa3b, v144
    v_mul_f32 v150, 0xbfb8aa3b, v145
    v_mul_f32 v151, 0xbfb8aa3b, v145
    v_mov_b32 v152, 0x3fb8aa3b
    v_mov_b32 v153, 0x3fb8aa3b
    v_mov_b32 v154, 0xbfb8aa3b
    v_mov_b32 v155, 0xbfb8aa3b
    v_pk_fma_f32 v[156:157], v[112:113], v[152:153], v[148:149]
    v_pk_fma_f32 v[164:165], v[112:113], v[154:155], v[150:151]
    v_pk_fma_f32 v[158:159], v[114:115], v[152:153], v[148:149]
    v_pk_fma_f32 v[166:167], v[114:115], v[154:155], v[150:151]
    v_pk_fma_f32 v[160:161], v[116:117], v[152:153], v[148:149]
    v_pk_fma_f32 v[168:169], v[116:117], v[154:155], v[150:151]
    v_pk_fma_f32 v[162:163], v[118:119], v[152:153], v[148:149]
    v_pk_fma_f32 v[170:171], v[118:119], v[154:155], v[150:151]
    v_exp_f32 v156, v156
    v_exp_f32 v164, v164
    v_exp_f32 v157, v157
    v_exp_f32 v165, v165
    v_exp_f32 v158, v158
    v_exp_f32 v166, v166
    v_exp_f32 v159, v159
    v_exp_f32 v167, v167
    v_exp_f32 v160, v160
    v_exp_f32 v168, v168
    v_exp_f32 v161, v161
    v_exp_f32 v169, v169
    v_exp_f32 v162, v162
    v_exp_f32 v170, v170
    v_exp_f32 v163, v163
    v_exp_f32 v171, v171
    v_pk_add_f32 v[112:113], v[156:157], v[158:159]
    v_pk_add_f32 v[114:115], v[164:165], v[166:167]
    v_pk_add_f32 v[116:117], v[160:161], v[162:163]
    v_pk_add_f32 v[118:119], v[168:169], v[170:171]
    v_pk_add_f32 v[112:113], v[112:113], v[116:117]
    v_pk_add_f32 v[114:115], v[114:115], v[118:119]
    v_add_f32 v144, v112, v113
    v_add_f32 v145, v114, v115
    v_mov_b32 v146, v144
    v_mov_b32 v147, v145
    s_nop 0
    v_permlane16_swap_b32 v144, v146
    v_permlane16_swap_b32 v145, v147
    v_add_f32 v144, v144, v146
    v_add_f32 v145, v145, v147
    v_mov_b32 v146, v144
    v_mov_b32 v147, v145
    s_nop 0
    v_permlane32_swap_b32 v144, v146
    v_permlane32_swap_b32 v145, v147
    v_add_f32 v144, v144, v146
    v_add_f32 v145, v145, v147
    v_rcp_f32 v148, v144
    v_rcp_f32 v150, v145
    v_mov_b32 v149, v148
    v_mov_b32 v151, v150
    v_pk_mul_f32 v[156:157], v[156:157], v[148:149]
    v_pk_mul_f32 v[164:165], v[164:165], v[150:151]
    v_pk_mul_f32 v[158:159], v[158:159], v[148:149]
    v_pk_mul_f32 v[166:167], v[166:167], v[150:151]
    v_pk_mul_f32 v[160:161], v[160:161], v[148:149]
    v_pk_mul_f32 v[168:169], v[168:169], v[150:151]
    v_pk_mul_f32 v[162:163], v[162:163], v[148:149]
    v_pk_mul_f32 v[170:171], v[170:171], v[150:151]
    v_cvt_pk_bf16_f32 v90, v156, v157
    v_cvt_pk_bf16_f32 v94, v164, v165
    v_cvt_pk_bf16_f32 v91, v158, v159
    v_cvt_pk_bf16_f32 v95, v166, v167
    v_cvt_pk_bf16_f32 v92, v160, v161
    v_cvt_pk_bf16_f32 v96, v168, v169
    v_cvt_pk_bf16_f32 v93, v162, v163
    v_cvt_pk_bf16_f32 v97, v170, v171
    ds_write_b64 v88, v[90:91] offset:0
    ds_write_b64 v88, v[92:93] offset:2048
    ds_write_b64 v88, v[94:95] offset:4096
    ds_write_b64 v88, v[96:97] offset:6144
    v_max3_f32 v144, v120, v121, v122
    v_min3_f32 v145, v120, v121, v122
    v_max3_f32 v144, v144, v123, v124
    v_min3_f32 v145, v145, v123, v124
    v_max3_f32 v144, v144, v125, v126
    v_min3_f32 v145, v145, v125, v126
    v_max_f32 v144, v144, v127
    v_min_f32 v145, v145, v127
    v_sub_f32 v145, 0, v145
    v_mov_b32 v146, v144
    v_mov_b32 v147, v145
    s_nop 0
    v_permlane16_swap_b32 v144, v146
    v_permlane16_swap_b32 v145, v147
    v_max_f32 v144, v144, v146
    v_max_f32 v145, v145, v147
    v_mov_b32 v146, v144
    v_mov_b32 v147, v145
    s_nop 0
    v_permlane32_swap_b32 v144, v146
    v_permlane32_swap_b32 v145, v147
    v_max_f32 v144, v144, v146
    v_max_f32 v145, v145, v147
    v_mul_f32 v148, 0xbfb8aa3b, v144
    v_mul_f32 v149, 0xbfb8aa3b, v144
    v_mul_f32 v150, 0xbfb8aa3b, v145
    v_mul_f32 v151, 0xbfb8aa3b, v145
    v_mov_b32 v152, 0x3fb8aa3b
    v_mov_b32 v153, 0x3fb8aa3b
    v_mov_b32 v154, 0xbfb8aa3b
    v_mov_b32 v155, 0xbfb8aa3b
    v_pk_fma_f32 v[156:157], v[120:121], v[152:153], v[148:149]
    v_pk_fma_f32 v[164:165], v[120:121], v[154:155], v[150:151]
    v_pk_fma_f32 v[158:159], v[122:123], v[152:153], v[148:149]
    v_pk_fma_f32 v[166:167], v[122:123], v[154:155], v[150:151]
    v_pk_fma_f32 v[160:161], v[124:125], v[152:153], v[148:149]
    v_pk_fma_f32 v[168:169], v[124:125], v[154:155], v[150:151]
    v_pk_fma_f32 v[162:163], v[126:127], v[152:153], v[148:149]
    v_pk_fma_f32 v[170:171], v[126:127], v[154:155], v[150:151]
    v_exp_f32 v156, v156
    v_exp_f32 v164, v164
    v_exp_f32 v157, v157
    v_exp_f32 v165, v165
    v_exp_f32 v158, v158
    v_exp_f32 v166, v166
    v_exp_f32 v159, v159
    v_exp_f32 v167, v167
    v_exp_f32 v160, v160
    v_exp_f32 v168, v168
    v_exp_f32 v161, v161
    v_exp_f32 v169, v169
    v_exp_f32 v162, v162
    v_exp_f32 v170, v170
    v_exp_f32 v163, v163
    v_exp_f32 v171, v171
    v_pk_add_f32 v[120:121], v[156:157], v[158:159]
    v_pk_add_f32 v[122:123], v[164:165], v[166:167]
    v_pk_add_f32 v[124:125], v[160:161], v[162:163]
    v_pk_add_f32 v[126:127], v[168:169], v[170:171]
    v_pk_add_f32 v[120:121], v[120:121], v[124:125]
    v_pk_add_f32 v[122:123], v[122:123], v[126:127]
    v_add_f32 v144, v120, v121
    v_add_f32 v145, v122, v123
    v_mov_b32 v146, v144
    v_mov_b32 v147, v145
    s_nop 0
    v_permlane16_swap_b32 v144, v146
    v_permlane16_swap_b32 v145, v147
    v_add_f32 v144, v144, v146
    v_add_f32 v145, v145, v147
    v_mov_b32 v146, v144
    v_mov_b32 v147, v145
    s_nop 0
    v_permlane32_swap_b32 v144, v146
    v_permlane32_swap_b32 v145, v147
    v_add_f32 v144, v144, v146
    v_add_f32 v145, v145, v147
    v_rcp_f32 v148, v144
    v_rcp_f32 v150, v145
    v_mov_b32 v149, v148
    v_mov_b32 v151, v150
    v_pk_mul_f32 v[156:157], v[156:157], v[148:149]
    v_pk_mul_f32 v[164:165], v[164:165], v[150:151]
    v_pk_mul_f32 v[158:159], v[158:159], v[148:149]
    v_pk_mul_f32 v[166:167], v[166:167], v[150:151]
    v_pk_mul_f32 v[160:161], v[160:161], v[148:149]
    v_pk_mul_f32 v[168:169], v[168:169], v[150:151]
    v_pk_mul_f32 v[162:163], v[162:163], v[148:149]
    v_pk_mul_f32 v[170:171], v[170:171], v[150:151]
    v_cvt_pk_bf16_f32 v90, v156, v157
    v_cvt_pk_bf16_f32 v94, v164, v165
    v_cvt_pk_bf16_f32 v91, v158, v159
    v_cvt_pk_bf16_f32 v95, v166, v167
    v_cvt_pk_bf16_f32 v92, v160, v161
    v_cvt_pk_bf16_f32 v96, v168, v169
    v_cvt_pk_bf16_f32 v93, v162, v163
    v_cvt_pk_bf16_f32 v97, v170, v171
    ds_write_b64 v88, v[90:91] offset:512
    ds_write_b64 v88, v[92:93] offset:2560
    ds_write_b64 v88, v[94:95] offset:4608
    ds_write_b64 v88, v[96:97] offset:6656
    v_max3_f32 v144, v128, v129, v130
    v_min3_f32 v145, v128, v129, v130
    v_max3_f32 v144, v144, v131, v132
    v_min3_f32 v145, v145, v131, v132
    v_max3_f32 v144, v144, v133, v134
    v_min3_f32 v145, v145, v133, v134
    v_max_f32 v144, v144, v135
    v_min_f32 v145, v145, v135
    v_sub_f32 v145, 0, v145
    v_mov_b32 v146, v144
    v_mov_b32 v147, v145
    s_nop 0
    v_permlane16_swap_b32 v144, v146
    v_permlane16_swap_b32 v145, v147
    v_max_f32 v144, v144, v146
    v_max_f32 v145, v145, v147
    v_mov_b32 v146, v144
    v_mov_b32 v147, v145
    s_nop 0
    v_permlane32_swap_b32 v144, v146
    v_permlane32_swap_b32 v145, v147
    v_max_f32 v144, v144, v146
    v_max_f32 v145, v145, v147
    v_mul_f32 v148, 0xbfb8aa3b, v144
    v_mul_f32 v149, 0xbfb8aa3b, v144
    v_mul_f32 v150, 0xbfb8aa3b, v145
    v_mul_f32 v151, 0xbfb8aa3b, v145
    v_mov_b32 v152, 0x3fb8aa3b
    v_mov_b32 v153, 0x3fb8aa3b
    v_mov_b32 v154, 0xbfb8aa3b
    v_mov_b32 v155, 0xbfb8aa3b
    v_pk_fma_f32 v[156:157], v[128:129], v[152:153], v[148:149]
    v_pk_fma_f32 v[164:165], v[128:129], v[154:155], v[150:151]
    v_pk_fma_f32 v[158:159], v[130:131], v[152:153], v[148:149]
    v_pk_fma_f32 v[166:167], v[130:131], v[154:155], v[150:151]
    v_pk_fma_f32 v[160:161], v[132:133], v[152:153], v[148:149]
    v_pk_fma_f32 v[168:169], v[132:133], v[154:155], v[150:151]
    v_pk_fma_f32 v[162:163], v[134:135], v[152:153], v[148:149]
    v_pk_fma_f32 v[170:171], v[134:135], v[154:155], v[150:151]
    v_exp_f32 v156, v156
    v_exp_f32 v164, v164
    v_exp_f32 v157, v157
    v_exp_f32 v165, v165
    v_exp_f32 v158, v158
    v_exp_f32 v166, v166
    v_exp_f32 v159, v159
    v_exp_f32 v167, v167
    v_exp_f32 v160, v160
    v_exp_f32 v168, v168
    v_exp_f32 v161, v161
    v_exp_f32 v169, v169
    v_exp_f32 v162, v162
    v_exp_f32 v170, v170
    v_exp_f32 v163, v163
    v_exp_f32 v171, v171
    v_pk_add_f32 v[128:129], v[156:157], v[158:159]
    v_pk_add_f32 v[130:131], v[164:165], v[166:167]
    v_pk_add_f32 v[132:133], v[160:161], v[162:163]
    v_pk_add_f32 v[134:135], v[168:169], v[170:171]
    v_pk_add_f32 v[128:129], v[128:129], v[132:133]
    v_pk_add_f32 v[130:131], v[130:131], v[134:135]
    v_add_f32 v144, v128, v129
    v_add_f32 v145, v130, v131
    v_mov_b32 v146, v144
    v_mov_b32 v147, v145
    s_nop 0
    v_permlane16_swap_b32 v144, v146
    v_permlane16_swap_b32 v145, v147
    v_add_f32 v144, v144, v146
    v_add_f32 v145, v145, v147
    v_mov_b32 v146, v144
    v_mov_b32 v147, v145
    s_nop 0
    v_permlane32_swap_b32 v144, v146
    v_permlane32_swap_b32 v145, v147
    v_add_f32 v144, v144, v146
    v_add_f32 v145, v145, v147
    v_rcp_f32 v148, v144
    v_rcp_f32 v150, v145
    v_mov_b32 v149, v148
    v_mov_b32 v151, v150
    v_pk_mul_f32 v[156:157], v[156:157], v[148:149]
    v_pk_mul_f32 v[164:165], v[164:165], v[150:151]
    v_pk_mul_f32 v[158:159], v[158:159], v[148:149]
    v_pk_mul_f32 v[166:167], v[166:167], v[150:151]
    v_pk_mul_f32 v[160:161], v[160:161], v[148:149]
    v_pk_mul_f32 v[168:169], v[168:169], v[150:151]
    v_pk_mul_f32 v[162:163], v[162:163], v[148:149]
    v_pk_mul_f32 v[170:171], v[170:171], v[150:151]
    v_cvt_pk_bf16_f32 v90, v156, v157
    v_cvt_pk_bf16_f32 v94, v164, v165
    v_cvt_pk_bf16_f32 v91, v158, v159
    v_cvt_pk_bf16_f32 v95, v166, v167
    v_cvt_pk_bf16_f32 v92, v160, v161
    v_cvt_pk_bf16_f32 v96, v168, v169
    v_cvt_pk_bf16_f32 v93, v162, v163
    v_cvt_pk_bf16_f32 v97, v170, v171
    ds_write_b64 v88, v[90:91] offset:1024
    ds_write_b64 v88, v[92:93] offset:3072
    ds_write_b64 v88, v[94:95] offset:5120
    ds_write_b64 v88, v[96:97] offset:7168
    v_max3_f32 v144, v136, v137, v138
    v_min3_f32 v145, v136, v137, v138
    v_max3_f32 v144, v144, v139, v140
    v_min3_f32 v145, v145, v139, v140
    v_max3_f32 v144, v144, v141, v142
    v_min3_f32 v145, v145, v141, v142
    v_max_f32 v144, v144, v143
    v_min_f32 v145, v145, v143
    v_sub_f32 v145, 0, v145
    v_mov_b32 v146, v144
    v_mov_b32 v147, v145
    s_nop 0
    v_permlane16_swap_b32 v144, v146
    v_permlane16_swap_b32 v145, v147
    v_max_f32 v144, v144, v146
    v_max_f32 v145, v145, v147
    v_mov_b32 v146, v144
    v_mov_b32 v147, v145
    s_nop 0
    v_permlane32_swap_b32 v144, v146
    v_permlane32_swap_b32 v145, v147
    v_max_f32 v144, v144, v146
    v_max_f32 v145, v145, v147
    v_mul_f32 v148, 0xbfb8aa3b, v144
    v_mul_f32 v149, 0xbfb8aa3b, v144
    v_mul_f32 v150, 0xbfb8aa3b, v145
    v_mul_f32 v151, 0xbfb8aa3b, v145
    v_mov_b32 v152, 0x3fb8aa3b
    v_mov_b32 v153, 0x3fb8aa3b
    v_mov_b32 v154, 0xbfb8aa3b
    v_mov_b32 v155, 0xbfb8aa3b
    v_pk_fma_f32 v[156:157], v[136:137], v[152:153], v[148:149]
    v_pk_fma_f32 v[164:165], v[136:137], v[154:155], v[150:151]
    v_pk_fma_f32 v[158:159], v[138:139], v[152:153], v[148:149]
    v_pk_fma_f32 v[166:167], v[138:139], v[154:155], v[150:151]
    v_pk_fma_f32 v[160:161], v[140:141], v[152:153], v[148:149]
    v_pk_fma_f32 v[168:169], v[140:141], v[154:155], v[150:151]
    v_pk_fma_f32 v[162:163], v[142:143], v[152:153], v[148:149]
    v_pk_fma_f32 v[170:171], v[142:143], v[154:155], v[150:151]
    v_exp_f32 v156, v156
    v_exp_f32 v164, v164
    v_exp_f32 v157, v157
    v_exp_f32 v165, v165
    v_exp_f32 v158, v158
    v_exp_f32 v166, v166
    v_exp_f32 v159, v159
    v_exp_f32 v167, v167
    v_exp_f32 v160, v160
    v_exp_f32 v168, v168
    v_exp_f32 v161, v161
    v_exp_f32 v169, v169
    v_exp_f32 v162, v162
    v_exp_f32 v170, v170
    v_exp_f32 v163, v163
    v_exp_f32 v171, v171
    v_pk_add_f32 v[136:137], v[156:157], v[158:159]
    v_pk_add_f32 v[138:139], v[164:165], v[166:167]
    v_pk_add_f32 v[140:141], v[160:161], v[162:163]
    v_pk_add_f32 v[142:143], v[168:169], v[170:171]
    v_pk_add_f32 v[136:137], v[136:137], v[140:141]
    v_pk_add_f32 v[138:139], v[138:139], v[142:143]
    v_add_f32 v144, v136, v137
    v_add_f32 v145, v138, v139
    v_mov_b32 v146, v144
    v_mov_b32 v147, v145
    s_nop 0
    v_permlane16_swap_b32 v144, v146
    v_permlane16_swap_b32 v145, v147
    v_add_f32 v144, v144, v146
    v_add_f32 v145, v145, v147
    v_mov_b32 v146, v144
    v_mov_b32 v147, v145
    s_nop 0
    v_permlane32_swap_b32 v144, v146
    v_permlane32_swap_b32 v145, v147
    v_add_f32 v144, v144, v146
    v_add_f32 v145, v145, v147
    v_rcp_f32 v148, v144
    v_rcp_f32 v150, v145
    v_mov_b32 v149, v148
    v_mov_b32 v151, v150
    v_pk_mul_f32 v[156:157], v[156:157], v[148:149]
    v_pk_mul_f32 v[164:165], v[164:165], v[150:151]
    v_pk_mul_f32 v[158:159], v[158:159], v[148:149]
    v_pk_mul_f32 v[166:167], v[166:167], v[150:151]
    v_pk_mul_f32 v[160:161], v[160:161], v[148:149]
    v_pk_mul_f32 v[168:169], v[168:169], v[150:151]
    v_pk_mul_f32 v[162:163], v[162:163], v[148:149]
    v_pk_mul_f32 v[170:171], v[170:171], v[150:151]
    v_cvt_pk_bf16_f32 v90, v156, v157
    v_cvt_pk_bf16_f32 v94, v164, v165
    v_cvt_pk_bf16_f32 v91, v158, v159
    v_cvt_pk_bf16_f32 v95, v166, v167
    v_cvt_pk_bf16_f32 v92, v160, v161
    v_cvt_pk_bf16_f32 v96, v168, v169
    v_cvt_pk_bf16_f32 v93, v162, v163
    v_cvt_pk_bf16_f32 v97, v170, v171
    ds_write_b64 v88, v[90:91] offset:1536
    ds_write_b64 v88, v[92:93] offset:3584
    ds_write_b64 v88, v[94:95] offset:5632
    ds_write_b64 v88, v[96:97] offset:7680
    s_waitcnt lgkmcnt(0)
    ds_read_b64_tr_b16 v[112:113], v89 offset:0
    ds_read_b64_tr_b16 v[114:115], v89 offset:512
    ds_read_b64_tr_b16 v[116:117], v89 offset:2048
    ds_read_b64_tr_b16 v[118:119], v89 offset:2560
    ds_read_b64_tr_b16 v[120:121], v89 offset:4096
    ds_read_b64_tr_b16 v[122:123], v89 offset:4608
    ds_read_b64_tr_b16 v[124:125], v89 offset:6144
    ds_read_b64_tr_b16 v[126:127], v89 offset:6656
    ds_read_b64_tr_b16 v[128:129], v89 offset:1024
    ds_read_b64_tr_b16 v[130:131], v89 offset:1536
    ds_read_b64_tr_b16 v[132:133], v89 offset:3072
    ds_read_b64_tr_b16 v[134:135], v89 offset:3584
    ds_read_b64_tr_b16 v[136:137], v89 offset:5120
    ds_read_b64_tr_b16 v[138:139], v89 offset:5632
    ds_read_b64_tr_b16 v[140:141], v89 offset:7168
    ds_read_b64_tr_b16 v[142:143], v89 offset:7680
    v_mov_b32 v98, 0x3f803f80
    v_mov_b32 v99, 0x3f803f80
    v_mov_b32 v100, 0x3f803f80
    v_mov_b32 v101, 0x3f803f80
    s_waitcnt lgkmcnt(0)
    v_mfma_f32_16x16x32_bf16 v[144:147], v[112:115], v[72:75], 0
    v_mfma_f32_16x16x32_bf16 v[148:151], v[112:115], v[76:79], 0
    v_mfma_f32_16x16x32_bf16 v[152:155], v[112:115], v[98:101], 0
    v_mfma_f32_16x16x32_bf16 v[156:159], v[116:119], v[72:75], 0
    v_mfma_f32_16x16x32_bf16 v[160:163], v[116:119], v[76:79], 0
    v_mfma_f32_16x16x32_bf16 v[164:167], v[116:119], v[98:101], 0
    v_mfma_f32_16x16x32_bf16 v[168:171], v[120:123], v[72:75], 0
    v_mfma_f32_16x16x32_bf16 v[172:175], v[120:123], v[76:79], 0
    v_mfma_f32_16x16x32_bf16 v[176:179], v[120:123], v[98:101], 0
    v_mfma_f32_16x16x32_bf16 v[180:183], v[124:127], v[72:75], 0
    v_mfma_f32_16x16x32_bf16 v[184:187], v[124:127], v[76:79], 0
    v_mfma_f32_16x16x32_bf16 v[188:191], v[124:127], v[98:101], 0
    v_mfma_f32_16x16x32_bf16 v[144:147], v[128:131], v[80:83], v[144:147]
    v_mfma_f32_16x16x32_bf16 v[148:151], v[128:131], v[84:87], v[148:151]
    v_mfma_f32_16x16x32_bf16 v[152:155], v[128:131], v[98:101], v[152:155]
    v_mfma_f32_16x16x32_bf16 v[156:159], v[132:135], v[80:83], v[156:159]
    v_mfma_f32_16x16x32_bf16 v[160:163], v[132:135], v[84:87], v[160:163]
    v_mfma_f32_16x16x32_bf16 v[164:167], v[132:135], v[98:101], v[164:167]
    v_mfma_f32_16x16x32_bf16 v[168:171], v[136:139], v[80:83], v[168:171]
    v_mfma_f32_16x16x32_bf16 v[172:175], v[136:139], v[84:87], v[172:175]
    v_mfma_f32_16x16x32_bf16 v[176:179], v[136:139], v[98:101], v[176:179]
    v_mfma_f32_16x16x32_bf16 v[180:183], v[140:143], v[80:83], v[180:183]
    v_mfma_f32_16x16x32_bf16 v[184:187], v[140:143], v[84:87], v[184:187]
    v_mfma_f32_16x16x32_bf16 v[188:191], v[140:143], v[98:101], v[188:191]
    s_mul_i32 s68, s49, 12288
    s_add_u32 s68, s68, 32768
    v_add_u32 v2, s68, v22
    ds_write_b128 v2, v[144:147] offset:0
    ds_write_b128 v2, v[148:151] offset:1024
    ds_write_b128 v2, v[152:155] offset:2048
    ds_write_b128 v2, v[156:159] offset:3072
    ds_write_b128 v2, v[160:163] offset:4096
    ds_write_b128 v2, v[164:167] offset:5120
    ds_write_b128 v2, v[168:171] offset:6144
    ds_write_b128 v2, v[172:175] offset:7168
    ds_write_b128 v2, v[176:179] offset:8192
    ds_write_b128 v2, v[180:183] offset:9216
    ds_write_b128 v2, v[184:187] offset:10240
    ds_write_b128 v2, v[188:191] offset:11264
    s_waitcnt lgkmcnt(0)
    v_mov_b32 v3, 158720
    v_mov_b32 v4, 1
    s_mov_b64 s[70:71], exec
    s_mov_b64 exec, 1
    ds_add_u32 v3, v4
    s_mov_b64 exec, s[70:71]
    s_mov_b32 s69, 0
L_s1_kernel_kvspin:
    ds_read_b32 v4, v3
    s_waitcnt lgkmcnt(0)
    v_readfirstlane_b32 s68, v4
    s_add_u32 s69, s69, 1
    s_cmp_ge_u32 s69, 400000
    s_cbranch_scc1 L_s1_kernel_kvgo
    s_cmp_lt_u32 s68, 4
    s_cbranch_scc1 L_s1_kernel_kvspin
L_s1_kernel_kvgo:
    s_mul_i32 s68, s49, 3072
    s_add_u32 s68, s68, 32768
    v_add_u32 v2, s68, v22
    ds_read_b128 v[32:35], v2 offset:0
    ds_read_b128 v[36:39], v2 offset:1024
    ds_read_b128 v[40:43], v2 offset:2048
    ds_read_b128 v[44:47], v2 offset:12288
    ds_read_b128 v[48:51], v2 offset:13312
    ds_read_b128 v[52:55], v2 offset:14336
    ds_read_b128 v[56:59], v2 offset:24576
    ds_read_b128 v[60:63], v2 offset:25600
    ds_read_b128 v[64:67], v2 offset:26624
    ds_read_b128 v[68:71], v2 offset:36864
    ds_read_b128 v[72:75], v2 offset:37888
    ds_read_b128 v[76:79], v2 offset:38912
    s_waitcnt lgkmcnt(0)
    v_pk_add_f32 v[32:33], v[32:33], v[44:45]
    v_pk_add_f32 v[56:57], v[56:57], v[68:69]
    v_pk_add_f32 v[32:33], v[32:33], v[56:57]
    v_pk_add_f32 v[34:35], v[34:35], v[46:47]
    v_pk_add_f32 v[58:59], v[58:59], v[70:71]
    v_pk_add_f32 v[34:35], v[34:35], v[58:59]
    v_pk_add_f32 v[36:37], v[36:37], v[48:49]
    v_pk_add_f32 v[60:61], v[60:61], v[72:73]
    v_pk_add_f32 v[36:37], v[36:37], v[60:61]
    v_pk_add_f32 v[38:39], v[38:39], v[50:51]
    v_pk_add_f32 v[62:63], v[62:63], v[74:75]
    v_pk_add_f32 v[38:39], v[38:39], v[62:63]
    v_pk_add_f32 v[40:41], v[40:41], v[52:53]
    v_pk_add_f32 v[64:65], v[64:65], v[76:77]
    v_pk_add_f32 v[40:41], v[40:41], v[64:65]
    v_pk_add_f32 v[42:43], v[42:43], v[54:55]
    v_pk_add_f32 v[66:67], v[66:67], v[78:79]
    v_pk_add_f32 v[42:43], v[42:43], v[66:67]
    s_lshl_b32 s68, s50, 5
    s_add_u32 s68, s68, s74
    s_mul_i32 s68, s68, 12288
    s_mul_i32 s69, s49, 3072
    s_add_u32 s68, s68, s69
    s_add_u32 s68, s68, 30408704
    buffer_store_dwordx4 v[32:35], v22, s[36:39], s68 offen offset:0 sc1
    buffer_store_dwordx4 v[36:39], v22, s[36:39], s68 offen offset:1024 sc1
    buffer_store_dwordx4 v[40:43], v22, s[36:39], s68 offen offset:2048 sc1
    s_branch L_s1_kernel_fin
L_s1_kernel_gmain:
    v_mov_b32 v120, 0
    v_mov_b32 v121, 0
    v_mov_b32 v122, 0
    v_mov_b32 v123, 0
    v_mov_b32 v124, 0
    v_mov_b32 v125, 0
    v_mov_b32 v126, 0
    v_mov_b32 v127, 0
    v_mov_b32 v128, 0
    v_mov_b32 v129, 0
    v_mov_b32 v130, 0
    v_mov_b32 v131, 0
    v_mov_b32 v132, 0
    v_mov_b32 v133, 0
    v_mov_b32 v134, 0
    v_mov_b32 v135, 0
    v_mov_b32 v136, 0
    v_mov_b32 v137, 0
    v_mov_b32 v138, 0
    v_mov_b32 v139, 0
    v_mov_b32 v140, 0
    v_mov_b32 v141, 0
    v_mov_b32 v142, 0
    v_mov_b32 v143, 0
    v_mov_b32 v144, 0
    v_mov_b32 v145, 0
    v_mov_b32 v146, 0
    v_mov_b32 v147, 0
    v_mov_b32 v148, 0
    v_mov_b32 v149, 0
    v_mov_b32 v150, 0
    v_mov_b32 v151, 0
    v_mov_b32 v152, 0
    v_mov_b32 v153, 0
    v_mov_b32 v154, 0
    v_mov_b32 v155, 0
    v_mov_b32 v156, 0
    v_mov_b32 v157, 0
    v_mov_b32 v158, 0
    v_mov_b32 v159, 0
    v_mov_b32 v160, 0
    v_mov_b32 v161, 0
    v_mov_b32 v162, 0
    v_mov_b32 v163, 0
    v_mov_b32 v164, 0
    v_mov_b32 v165, 0
    v_mov_b32 v166, 0
    v_mov_b32 v167, 0
    v_mov_b32 v168, 0
    v_mov_b32 v169, 0
    v_mov_b32 v170, 0
    v_mov_b32 v171, 0
    v_mov_b32 v172, 0
    v_mov_b32 v173, 0
    v_mov_b32 v174, 0
    v_mov_b32 v175, 0
    v_mov_b32 v176, 0
    v_mov_b32 v177, 0
    v_mov_b32 v178, 0
    v_mov_b32 v179, 0
    v_mov_b32 v180, 0
    v_mov_b32 v181, 0
    v_mov_b32 v182, 0
    v_mov_b32 v183, 0
    v_mov_b32 v184, 0
    v_mov_b32 v185, 0
    v_mov_b32 v186, 0
    v_mov_b32 v187, 0
    v_mov_b32 v188, 0
    v_mov_b32 v189, 0
    v_mov_b32 v190, 0
    v_mov_b32 v191, 0
    v_mov_b32 v192, 0
    v_mov_b32 v193, 0
    v_mov_b32 v194, 0
    v_mov_b32 v195, 0
    v_mov_b32 v196, 0
    v_mov_b32 v197, 0
    v_mov_b32 v198, 0
    v_mov_b32 v199, 0
    v_mov_b32 v200, 0
    v_mov_b32 v201, 0
    v_mov_b32 v202, 0
    v_mov_b32 v203, 0
    v_mov_b32 v204, 0
    v_mov_b32 v205, 0
    v_mov_b32 v206, 0
    v_mov_b32 v207, 0
    v_mov_b32 v208, 0
    v_mov_b32 v209, 0
    v_mov_b32 v210, 0
    v_mov_b32 v211, 0
    v_mov_b32 v212, 0
    v_mov_b32 v213, 0
    v_mov_b32 v214, 0
    v_mov_b32 v215, 0
    v_mov_b32 v216, 0
    v_mov_b32 v217, 0
    v_mov_b32 v218, 0
    v_mov_b32 v219, 0
    v_mov_b32 v220, 0
    v_mov_b32 v221, 0
    v_mov_b32 v222, 0
    v_mov_b32 v223, 0
    v_mov_b32 v224, 0
    v_mov_b32 v225, 0
    v_mov_b32 v226, 0
    v_mov_b32 v227, 0
    v_mov_b32 v228, 0
    v_mov_b32 v229, 0
    v_mov_b32 v230, 0
    v_mov_b32 v231, 0
    s_add_u32 m0, s59, 14336
    s_nop 0
    buffer_load_dwordx4 v10, s[28:31], s54 offen  lds
    s_add_u32 m0, s60, 14336
    s_nop 0
    buffer_load_dwordx4 v11, s[28:31], s54 offen  lds
    s_add_u32 m0, s61, 14336
    s_nop 0
    buffer_load_dwordx4 v12, s[28:31], s54 offen  lds
    s_mul_i32 s68, s58, 1
    s_add_u32 m0, s62, s68
    s_nop 0
    buffer_load_dwordx4 v13, s[32:35], s55 offen  lds
    s_add_u32 s54, s54, s56
    s_add_u32 s55, s55, 229376
    s_waitcnt vmcnt(4) lgkmcnt(0)
    s_barrier
    ds_read_b128 v[32:35], v6 offset:0
    ds_read_b128 v[36:39], v6 offset:2048
    ds_read_b128 v[40:43], v6 offset:4096
    ds_read_b128 v[44:47], v6 offset:6144
    ds_read_b64_tr_b16 v[64:65], v18 offset:0
    ds_read_b64_tr_b16 v[66:67], v18 offset:1024
    ds_read_b64_tr_b16 v[68:69], v19 offset:0
    ds_read_b64_tr_b16 v[70:71], v19 offset:1024
    ds_read_b64_tr_b16 v[72:73], v18 offset:256
    ds_read_b64_tr_b16 v[74:75], v18 offset:1280
    ds_read_b64_tr_b16 v[76:77], v19 offset:256
    ds_read_b64_tr_b16 v[78:79], v19 offset:1280
    ds_read_b64_tr_b16 v[80:81], v18 offset:512
    ds_read_b64_tr_b16 v[82:83], v18 offset:1536
    ds_read_b64_tr_b16 v[84:85], v19 offset:512
    ds_read_b64_tr_b16 v[86:87], v19 offset:1536
    ds_read_b64_tr_b16 v[88:89], v18 offset:768
    ds_read_b64_tr_b16 v[90:91], v18 offset:1792
    s_add_u32 m0, s59, 28672
    s_nop 0
    buffer_load_dwordx4 v10, s[28:31], s54 offen  lds
    s_add_u32 m0, s60, 28672
    s_nop 0
    buffer_load_dwordx4 v11, s[28:31], s54 offen  lds
    s_add_u32 m0, s61, 28672
    s_nop 0
    buffer_load_dwordx4 v12, s[28:31], s54 offen  lds
    s_mul_i32 s68, s58, 2
    s_add_u32 m0, s62, s68
    s_nop 0
    buffer_load_dwordx4 v13, s[32:35], s55 offen  lds
    s_add_u32 s54, s54, s56
    s_add_u32 s55, s55, 229376
    s_waitcnt vmcnt(4) lgkmcnt(0)
    s_barrier
    v_mfma_f32_16x16x32_bf16 v[120:123], v[64:67], v[32:35], v[120:123]
    ds_read_b128 v[48:51], v7 offset:0
    s_add_u32 m0, s59, 43008
    v_mfma_f32_16x16x32_bf16 v[124:127], v[64:67], v[36:39], v[124:127]
    buffer_load_dwordx4 v10, s[28:31], s54 offen  lds
    ds_read_b128 v[52:55], v7 offset:2048
    v_mfma_f32_16x16x32_bf16 v[128:131], v[64:67], v[40:43], v[128:131]
    ds_read_b128 v[56:59], v7 offset:4096
    v_mfma_f32_16x16x32_bf16 v[132:135], v[64:67], v[44:47], v[132:135]
    ds_read_b128 v[60:63], v7 offset:6144
    s_add_u32 m0, s60, 43008
    v_mfma_f32_16x16x32_bf16 v[148:151], v[68:71], v[44:47], v[148:151]
    buffer_load_dwordx4 v11, s[28:31], s54 offen  lds
    v_mfma_f32_16x16x32_bf16 v[144:147], v[68:71], v[40:43], v[144:147]
    ds_read_b64_tr_b16 v[92:93], v18 offset:14336
    v_mfma_f32_16x16x32_bf16 v[140:143], v[68:71], v[36:39], v[140:143]
    ds_read_b64_tr_b16 v[94:95], v18 offset:15360
    s_add_u32 m0, s61, 43008
    v_mfma_f32_16x16x32_bf16 v[136:139], v[68:71], v[32:35], v[136:139]
    buffer_load_dwordx4 v12, s[28:31], s54 offen  lds
    ds_read_b64_tr_b16 v[96:97], v19 offset:14336
    v_mfma_f32_16x16x32_bf16 v[152:155], v[72:75], v[32:35], v[152:155]
    ds_read_b64_tr_b16 v[98:99], v19 offset:15360
    v_mfma_f32_16x16x32_bf16 v[156:159], v[72:75], v[36:39], v[156:159]
    s_mul_i32 s68, s58, 3
    s_add_u32 m0, s62, s68
    v_mfma_f32_16x16x32_bf16 v[160:163], v[72:75], v[40:43], v[160:163]
    buffer_load_dwordx4 v13, s[32:35], s55 offen  lds
    s_add_u32 s54, s54, s56
    s_add_u32 s55, s55, 229376
    ds_read_b64_tr_b16 v[100:101], v18 offset:14592
    v_mfma_f32_16x16x32_bf16 v[164:167], v[72:75], v[44:47], v[164:167]
    ds_read_b64_tr_b16 v[102:103], v18 offset:15616
    v_mfma_f32_16x16x32_bf16 v[180:183], v[76:79], v[44:47], v[180:183]
    ds_read_b64_tr_b16 v[104:105], v19 offset:14592
    s_add_u32 m0, s59, 0
    v_mfma_f32_16x16x32_bf16 v[176:179], v[76:79], v[40:43], v[176:179]
    buffer_load_dwordx4 v10, s[28:31], s54 offen  lds
    v_mfma_f32_16x16x32_bf16 v[172:175], v[76:79], v[36:39], v[172:175]
    ds_read_b64_tr_b16 v[106:107], v19 offset:15616
    v_mfma_f32_16x16x32_bf16 v[168:171], v[76:79], v[32:35], v[168:171]
    ds_read_b64_tr_b16 v[108:109], v18 offset:14848
    s_add_u32 m0, s60, 0
    v_mfma_f32_16x16x32_bf16 v[184:187], v[80:83], v[32:35], v[184:187]
    buffer_load_dwordx4 v11, s[28:31], s54 offen  lds
    ds_read_b64_tr_b16 v[110:111], v18 offset:15872
    v_mfma_f32_16x16x32_bf16 v[188:191], v[80:83], v[36:39], v[188:191]
    ds_read_b64_tr_b16 v[112:113], v19 offset:14848
    v_mfma_f32_16x16x32_bf16 v[192:195], v[80:83], v[40:43], v[192:195]
    s_add_u32 m0, s61, 0
    v_mfma_f32_16x16x32_bf16 v[196:199], v[80:83], v[44:47], v[196:199]
    buffer_load_dwordx4 v12, s[28:31], s54 offen  lds
    ds_read_b64_tr_b16 v[114:115], v19 offset:15872
    v_mfma_f32_16x16x32_bf16 v[212:215], v[84:87], v[44:47], v[212:215]
    ds_read_b64_tr_b16 v[116:117], v18 offset:15104
    v_mfma_f32_16x16x32_bf16 v[208:211], v[84:87], v[40:43], v[208:211]
    ds_read_b64_tr_b16 v[118:119], v18 offset:16128
    s_mul_i32 s68, s58, 0
    s_add_u32 m0, s62, s68
    v_mfma_f32_16x16x32_bf16 v[204:207], v[84:87], v[36:39], v[204:207]
    buffer_load_dwordx4 v13, s[32:35], s55 offen  lds
    s_add_u32 s54, s54, s56
    s_add_u32 s55, s55, 229376
    v_mfma_f32_16x16x32_bf16 v[200:203], v[84:87], v[32:35], v[200:203]
    v_mfma_f32_16x16x32_bf16 v[216:219], v[88:91], v[32:35], v[216:219]
    v_mfma_f32_16x16x32_bf16 v[220:223], v[88:91], v[36:39], v[220:223]
    v_mfma_f32_16x16x32_bf16 v[224:227], v[88:91], v[40:43], v[224:227]
    v_mfma_f32_16x16x32_bf16 v[228:231], v[88:91], v[44:47], v[228:231]
    s_waitcnt vmcnt(8) lgkmcnt(0)
    s_barrier
    v_mfma_f32_16x16x32_bf16 v[120:123], v[92:95], v[48:51], v[120:123]
    ds_read_b128 v[32:35], v6 offset:32768
    s_add_u32 m0, s59, 14336
    v_mfma_f32_16x16x32_bf16 v[124:127], v[92:95], v[52:55], v[124:127]
    buffer_load_dwordx4 v10, s[28:31], s54 offen  lds
    ds_read_b128 v[36:39], v6 offset:34816
    v_mfma_f32_16x16x32_bf16 v[128:131], v[92:95], v[56:59], v[128:131]
    ds_read_b128 v[40:43], v6 offset:36864
    v_mfma_f32_16x16x32_bf16 v[132:135], v[92:95], v[60:63], v[132:135]
    ds_read_b128 v[44:47], v6 offset:38912
    v_mfma_f32_16x16x32_bf16 v[148:151], v[96:99], v[60:63], v[148:151]
    v_mfma_f32_16x16x32_bf16 v[144:147], v[96:99], v[56:59], v[144:147]
    ds_read_b64_tr_b16 v[64:65], v18 offset:28672
    v_mfma_f32_16x16x32_bf16 v[140:143], v[96:99], v[52:55], v[140:143]
    ds_read_b64_tr_b16 v[66:67], v18 offset:29696
    s_add_u32 m0, s60, 14336
    v_mfma_f32_16x16x32_bf16 v[136:139], v[96:99], v[48:51], v[136:139]
    buffer_load_dwordx4 v11, s[28:31], s54 offen  lds
    ds_read_b64_tr_b16 v[68:69], v19 offset:28672
    v_mfma_f32_16x16x32_bf16 v[152:155], v[100:103], v[48:51], v[152:155]
    ds_read_b64_tr_b16 v[70:71], v19 offset:29696
    v_mfma_f32_16x16x32_bf16 v[156:159], v[100:103], v[52:55], v[156:159]
    v_mfma_f32_16x16x32_bf16 v[160:163], v[100:103], v[56:59], v[160:163]
    ds_read_b64_tr_b16 v[72:73], v18 offset:28928
    v_mfma_f32_16x16x32_bf16 v[164:167], v[100:103], v[60:63], v[164:167]
    ds_read_b64_tr_b16 v[74:75], v18 offset:29952
    v_mfma_f32_16x16x32_bf16 v[180:183], v[104:107], v[60:63], v[180:183]
    ds_read_b64_tr_b16 v[76:77], v19 offset:28928
    s_add_u32 m0, s61, 14336
    v_mfma_f32_16x16x32_bf16 v[176:179], v[104:107], v[56:59], v[176:179]
    buffer_load_dwordx4 v12, s[28:31], s54 offen  lds
    v_mfma_f32_16x16x32_bf16 v[172:175], v[104:107], v[52:55], v[172:175]
    ds_read_b64_tr_b16 v[78:79], v19 offset:29952
    v_mfma_f32_16x16x32_bf16 v[168:171], v[104:107], v[48:51], v[168:171]
    ds_read_b64_tr_b16 v[80:81], v18 offset:29184
    v_mfma_f32_16x16x32_bf16 v[184:187], v[108:111], v[48:51], v[184:187]
    ds_read_b64_tr_b16 v[82:83], v18 offset:30208
    v_mfma_f32_16x16x32_bf16 v[188:191], v[108:111], v[52:55], v[188:191]
    ds_read_b64_tr_b16 v[84:85], v19 offset:29184
    v_mfma_f32_16x16x32_bf16 v[192:195], v[108:111], v[56:59], v[192:195]
    s_mul_i32 s68, s58, 1
    s_add_u32 m0, s62, s68
    v_mfma_f32_16x16x32_bf16 v[196:199], v[108:111], v[60:63], v[196:199]
    buffer_load_dwordx4 v13, s[32:35], s55 offen  lds
    s_add_u32 s54, s54, s56
    s_add_u32 s55, s55, 229376
    ds_read_b64_tr_b16 v[86:87], v19 offset:30208
    v_mfma_f32_16x16x32_bf16 v[212:215], v[112:115], v[60:63], v[212:215]
    ds_read_b64_tr_b16 v[88:89], v18 offset:29440
    v_mfma_f32_16x16x32_bf16 v[208:211], v[112:115], v[56:59], v[208:211]
    ds_read_b64_tr_b16 v[90:91], v18 offset:30464
    v_mfma_f32_16x16x32_bf16 v[204:207], v[112:115], v[52:55], v[204:207]
    v_mfma_f32_16x16x32_bf16 v[200:203], v[112:115], v[48:51], v[200:203]
    v_mfma_f32_16x16x32_bf16 v[216:219], v[116:119], v[48:51], v[216:219]
    v_mfma_f32_16x16x32_bf16 v[220:223], v[116:119], v[52:55], v[220:223]
    v_mfma_f32_16x16x32_bf16 v[224:227], v[116:119], v[56:59], v[224:227]
    v_mfma_f32_16x16x32_bf16 v[228:231], v[116:119], v[60:63], v[228:231]
    s_waitcnt vmcnt(8) lgkmcnt(0)
    s_barrier
    s_mov_b32 s67, 0
.p2align 6
L_s1_kernel_loopG:
    v_mfma_f32_16x16x32_bf16 v[120:123], v[64:67], v[32:35], v[120:123]
    ds_read_b128 v[48:51], v7 offset:32768
    s_add_u32 m0, s59, 28672
    v_mfma_f32_16x16x32_bf16 v[124:127], v[64:67], v[36:39], v[124:127]
    buffer_load_dwordx4 v10, s[28:31], s54 offen  lds
    ds_read_b128 v[52:55], v7 offset:34816
    v_mfma_f32_16x16x32_bf16 v[128:131], v[64:67], v[40:43], v[128:131]
    ds_read_b128 v[56:59], v7 offset:36864
    v_mfma_f32_16x16x32_bf16 v[132:135], v[64:67], v[44:47], v[132:135]
    ds_read_b128 v[60:63], v7 offset:38912
    v_mfma_f32_16x16x32_bf16 v[148:151], v[68:71], v[44:47], v[148:151]
    v_mfma_f32_16x16x32_bf16 v[144:147], v[68:71], v[40:43], v[144:147]
    ds_read_b64_tr_b16 v[92:93], v18 offset:43008
    v_mfma_f32_16x16x32_bf16 v[140:143], v[68:71], v[36:39], v[140:143]
    ds_read_b64_tr_b16 v[94:95], v18 offset:44032
    s_add_u32 m0, s60, 28672
    v_mfma_f32_16x16x32_bf16 v[136:139], v[68:71], v[32:35], v[136:139]
    buffer_load_dwordx4 v11, s[28:31], s54 offen  lds
    ds_read_b64_tr_b16 v[96:97], v19 offset:43008
    v_mfma_f32_16x16x32_bf16 v[152:155], v[72:75], v[32:35], v[152:155]
    ds_read_b64_tr_b16 v[98:99], v19 offset:44032
    v_mfma_f32_16x16x32_bf16 v[156:159], v[72:75], v[36:39], v[156:159]
    v_mfma_f32_16x16x32_bf16 v[160:163], v[72:75], v[40:43], v[160:163]
    ds_read_b64_tr_b16 v[100:101], v18 offset:43264
    v_mfma_f32_16x16x32_bf16 v[164:167], v[72:75], v[44:47], v[164:167]
    ds_read_b64_tr_b16 v[102:103], v18 offset:44288
    v_mfma_f32_16x16x32_bf16 v[180:183], v[76:79], v[44:47], v[180:183]
    ds_read_b64_tr_b16 v[104:105], v19 offset:43264
    s_add_u32 m0, s61, 28672
    v_mfma_f32_16x16x32_bf16 v[176:179], v[76:79], v[40:43], v[176:179]
    buffer_load_dwordx4 v12, s[28:31], s54 offen  lds
    v_mfma_f32_16x16x32_bf16 v[172:175], v[76:79], v[36:39], v[172:175]
    ds_read_b64_tr_b16 v[106:107], v19 offset:44288
    v_mfma_f32_16x16x32_bf16 v[168:171], v[76:79], v[32:35], v[168:171]
    ds_read_b64_tr_b16 v[108:109], v18 offset:43520
    v_mfma_f32_16x16x32_bf16 v[184:187], v[80:83], v[32:35], v[184:187]
    ds_read_b64_tr_b16 v[110:111], v18 offset:44544
    v_mfma_f32_16x16x32_bf16 v[188:191], v[80:83], v[36:39], v[188:191]
    ds_read_b64_tr_b16 v[112:113], v19 offset:43520
    v_mfma_f32_16x16x32_bf16 v[192:195], v[80:83], v[40:43], v[192:195]
    s_mul_i32 s68, s58, 2
    s_add_u32 m0, s62, s68
    v_mfma_f32_16x16x32_bf16 v[196:199], v[80:83], v[44:47], v[196:199]
    buffer_load_dwordx4 v13, s[32:35], s55 offen  lds
    s_add_u32 s54, s54, s56
    s_add_u32 s55, s55, 229376
    ds_read_b64_tr_b16 v[114:115], v19 offset:44544
    v_mfma_f32_16x16x32_bf16 v[212:215], v[84:87], v[44:47], v[212:215]
    ds_read_b64_tr_b16 v[116:117], v18 offset:43776
    v_mfma_f32_16x16x32_bf16 v[208:211], v[84:87], v[40:43], v[208:211]
    ds_read_b64_tr_b16 v[118:119], v18 offset:44800
    v_mfma_f32_16x16x32_bf16 v[204:207], v[84:87], v[36:39], v[204:207]
    v_mfma_f32_16x16x32_bf16 v[200:203], v[84:87], v[32:35], v[200:203]
    v_mfma_f32_16x16x32_bf16 v[216:219], v[88:91], v[32:35], v[216:219]
    v_mfma_f32_16x16x32_bf16 v[220:223], v[88:91], v[36:39], v[220:223]
    v_mfma_f32_16x16x32_bf16 v[224:227], v[88:91], v[40:43], v[224:227]
    v_mfma_f32_16x16x32_bf16 v[228:231], v[88:91], v[44:47], v[228:231]
    s_waitcnt vmcnt(8) lgkmcnt(0)
    s_barrier
    v_mfma_f32_16x16x32_bf16 v[120:123], v[92:95], v[48:51], v[120:123]
    ds_read_b128 v[32:35], v8 offset:0
    s_add_u32 m0, s59, 43008
    v_mfma_f32_16x16x32_bf16 v[124:127], v[92:95], v[52:55], v[124:127]
    buffer_load_dwordx4 v10, s[28:31], s54 offen  lds
    ds_read_b128 v[36:39], v8 offset:2048
    v_mfma_f32_16x16x32_bf16 v[128:131], v[92:95], v[56:59], v[128:131]
    ds_read_b128 v[40:43], v8 offset:4096
    v_mfma_f32_16x16x32_bf16 v[132:135], v[92:95], v[60:63], v[132:135]
    ds_read_b128 v[44:47], v8 offset:6144
    v_mfma_f32_16x16x32_bf16 v[148:151], v[96:99], v[60:63], v[148:151]
    v_mfma_f32_16x16x32_bf16 v[144:147], v[96:99], v[56:59], v[144:147]
    ds_read_b64_tr_b16 v[64:65], v18 offset:0
    v_mfma_f32_16x16x32_bf16 v[140:143], v[96:99], v[52:55], v[140:143]
    ds_read_b64_tr_b16 v[66:67], v18 offset:1024
    s_add_u32 m0, s60, 43008
    v_mfma_f32_16x16x32_bf16 v[136:139], v[96:99], v[48:51], v[136:139]
    buffer_load_dwordx4 v11, s[28:31], s54 offen  lds
    ds_read_b64_tr_b16 v[68:69], v19 offset:0
    v_mfma_f32_16x16x32_bf16 v[152:155], v[100:103], v[48:51], v[152:155]
    ds_read_b64_tr_b16 v[70:71], v19 offset:1024
    v_mfma_f32_16x16x32_bf16 v[156:159], v[100:103], v[52:55], v[156:159]
    v_mfma_f32_16x16x32_bf16 v[160:163], v[100:103], v[56:59], v[160:163]
    ds_read_b64_tr_b16 v[72:73], v18 offset:256
    v_mfma_f32_16x16x32_bf16 v[164:167], v[100:103], v[60:63], v[164:167]
    ds_read_b64_tr_b16 v[74:75], v18 offset:1280
    v_mfma_f32_16x16x32_bf16 v[180:183], v[104:107], v[60:63], v[180:183]
    ds_read_b64_tr_b16 v[76:77], v19 offset:256
    s_add_u32 m0, s61, 43008
    v_mfma_f32_16x16x32_bf16 v[176:179], v[104:107], v[56:59], v[176:179]
    buffer_load_dwordx4 v12, s[28:31], s54 offen  lds
    v_mfma_f32_16x16x32_bf16 v[172:175], v[104:107], v[52:55], v[172:175]
    ds_read_b64_tr_b16 v[78:79], v19 offset:1280
    v_mfma_f32_16x16x32_bf16 v[168:171], v[104:107], v[48:51], v[168:171]
    ds_read_b64_tr_b16 v[80:81], v18 offset:512
    v_mfma_f32_16x16x32_bf16 v[184:187], v[108:111], v[48:51], v[184:187]
    ds_read_b64_tr_b16 v[82:83], v18 offset:1536
    v_mfma_f32_16x16x32_bf16 v[188:191], v[108:111], v[52:55], v[188:191]
    ds_read_b64_tr_b16 v[84:85], v19 offset:512
    v_mfma_f32_16x16x32_bf16 v[192:195], v[108:111], v[56:59], v[192:195]
    s_mul_i32 s68, s58, 3
    s_add_u32 m0, s62, s68
    v_mfma_f32_16x16x32_bf16 v[196:199], v[108:111], v[60:63], v[196:199]
    buffer_load_dwordx4 v13, s[32:35], s55 offen  lds
    s_add_u32 s54, s54, s56
    s_add_u32 s55, s55, 229376
    ds_read_b64_tr_b16 v[86:87], v19 offset:1536
    v_mfma_f32_16x16x32_bf16 v[212:215], v[112:115], v[60:63], v[212:215]
    ds_read_b64_tr_b16 v[88:89], v18 offset:768
    v_mfma_f32_16x16x32_bf16 v[208:211], v[112:115], v[56:59], v[208:211]
    ds_read_b64_tr_b16 v[90:91], v18 offset:1792
    v_mfma_f32_16x16x32_bf16 v[204:207], v[112:115], v[52:55], v[204:207]
    v_mfma_f32_16x16x32_bf16 v[200:203], v[112:115], v[48:51], v[200:203]
    v_mfma_f32_16x16x32_bf16 v[216:219], v[116:119], v[48:51], v[216:219]
    v_mfma_f32_16x16x32_bf16 v[220:223], v[116:119], v[52:55], v[220:223]
    v_mfma_f32_16x16x32_bf16 v[224:227], v[116:119], v[56:59], v[224:227]
    v_mfma_f32_16x16x32_bf16 v[228:231], v[116:119], v[60:63], v[228:231]
    s_waitcnt vmcnt(8) lgkmcnt(0)
    s_barrier
    v_mfma_f32_16x16x32_bf16 v[120:123], v[64:67], v[32:35], v[120:123]
    ds_read_b128 v[48:51], v9 offset:0
    s_add_u32 m0, s59, 0
    v_mfma_f32_16x16x32_bf16 v[124:127], v[64:67], v[36:39], v[124:127]
    buffer_load_dwordx4 v10, s[28:31], s54 offen  lds
    ds_read_b128 v[52:55], v9 offset:2048
    v_mfma_f32_16x16x32_bf16 v[128:131], v[64:67], v[40:43], v[128:131]
    ds_read_b128 v[56:59], v9 offset:4096
    v_mfma_f32_16x16x32_bf16 v[132:135], v[64:67], v[44:47], v[132:135]
    ds_read_b128 v[60:63], v9 offset:6144
    v_mfma_f32_16x16x32_bf16 v[148:151], v[68:71], v[44:47], v[148:151]
    v_mfma_f32_16x16x32_bf16 v[144:147], v[68:71], v[40:43], v[144:147]
    ds_read_b64_tr_b16 v[92:93], v18 offset:14336
    v_mfma_f32_16x16x32_bf16 v[140:143], v[68:71], v[36:39], v[140:143]
    ds_read_b64_tr_b16 v[94:95], v18 offset:15360
    s_add_u32 m0, s60, 0
    v_mfma_f32_16x16x32_bf16 v[136:139], v[68:71], v[32:35], v[136:139]
    buffer_load_dwordx4 v11, s[28:31], s54 offen  lds
    ds_read_b64_tr_b16 v[96:97], v19 offset:14336
    v_mfma_f32_16x16x32_bf16 v[152:155], v[72:75], v[32:35], v[152:155]
    ds_read_b64_tr_b16 v[98:99], v19 offset:15360
    v_mfma_f32_16x16x32_bf16 v[156:159], v[72:75], v[36:39], v[156:159]
    v_mfma_f32_16x16x32_bf16 v[160:163], v[72:75], v[40:43], v[160:163]
    ds_read_b64_tr_b16 v[100:101], v18 offset:14592
    v_mfma_f32_16x16x32_bf16 v[164:167], v[72:75], v[44:47], v[164:167]
    ds_read_b64_tr_b16 v[102:103], v18 offset:15616
    v_mfma_f32_16x16x32_bf16 v[180:183], v[76:79], v[44:47], v[180:183]
    ds_read_b64_tr_b16 v[104:105], v19 offset:14592
    s_add_u32 m0, s61, 0
    v_mfma_f32_16x16x32_bf16 v[176:179], v[76:79], v[40:43], v[176:179]
    buffer_load_dwordx4 v12, s[28:31], s54 offen  lds
    v_mfma_f32_16x16x32_bf16 v[172:175], v[76:79], v[36:39], v[172:175]
    ds_read_b64_tr_b16 v[106:107], v19 offset:15616
    v_mfma_f32_16x16x32_bf16 v[168:171], v[76:79], v[32:35], v[168:171]
    ds_read_b64_tr_b16 v[108:109], v18 offset:14848
    v_mfma_f32_16x16x32_bf16 v[184:187], v[80:83], v[32:35], v[184:187]
    ds_read_b64_tr_b16 v[110:111], v18 offset:15872
    v_mfma_f32_16x16x32_bf16 v[188:191], v[80:83], v[36:39], v[188:191]
    ds_read_b64_tr_b16 v[112:113], v19 offset:14848
    v_mfma_f32_16x16x32_bf16 v[192:195], v[80:83], v[40:43], v[192:195]
    s_mul_i32 s68, s58, 0
    s_add_u32 m0, s62, s68
    v_mfma_f32_16x16x32_bf16 v[196:199], v[80:83], v[44:47], v[196:199]
    buffer_load_dwordx4 v13, s[32:35], s55 offen  lds
    s_add_u32 s54, s54, s56
    s_add_u32 s55, s55, 229376
    ds_read_b64_tr_b16 v[114:115], v19 offset:15872
    v_mfma_f32_16x16x32_bf16 v[212:215], v[84:87], v[44:47], v[212:215]
    ds_read_b64_tr_b16 v[116:117], v18 offset:15104
    v_mfma_f32_16x16x32_bf16 v[208:211], v[84:87], v[40:43], v[208:211]
    ds_read_b64_tr_b16 v[118:119], v18 offset:16128
    v_mfma_f32_16x16x32_bf16 v[204:207], v[84:87], v[36:39], v[204:207]
    v_mfma_f32_16x16x32_bf16 v[200:203], v[84:87], v[32:35], v[200:203]
    v_mfma_f32_16x16x32_bf16 v[216:219], v[88:91], v[32:35], v[216:219]
    v_mfma_f32_16x16x32_bf16 v[220:223], v[88:91], v[36:39], v[220:223]
    v_mfma_f32_16x16x32_bf16 v[224:227], v[88:91], v[40:43], v[224:227]
    v_mfma_f32_16x16x32_bf16 v[228:231], v[88:91], v[44:47], v[228:231]
    s_waitcnt vmcnt(8) lgkmcnt(0)
    s_barrier
    v_mfma_f32_16x16x32_bf16 v[120:123], v[92:95], v[48:51], v[120:123]
    ds_read_b128 v[32:35], v6 offset:0
    s_add_u32 m0, s59, 14336
    v_mfma_f32_16x16x32_bf16 v[124:127], v[92:95], v[52:55], v[124:127]
    buffer_load_dwordx4 v10, s[28:31], s54 offen  lds
    ds_read_b128 v[36:39], v6 offset:2048
    v_mfma_f32_16x16x32_bf16 v[128:131], v[92:95], v[56:59], v[128:131]
    ds_read_b128 v[40:43], v6 offset:4096
    v_mfma_f32_16x16x32_bf16 v[132:135], v[92:95], v[60:63], v[132:135]
    ds_read_b128 v[44:47], v6 offset:6144
    v_mfma_f32_16x16x32_bf16 v[148:151], v[96:99], v[60:63], v[148:151]
    v_mfma_f32_16x16x32_bf16 v[144:147], v[96:99], v[56:59], v[144:147]
    ds_read_b64_tr_b16 v[64:65], v18 offset:28672
    v_mfma_f32_16x16x32_bf16 v[140:143], v[96:99], v[52:55], v[140:143]
    ds_read_b64_tr_b16 v[66:67], v18 offset:29696
    s_add_u32 m0, s60, 14336
    v_mfma_f32_16x16x32_bf16 v[136:139], v[96:99], v[48:51], v[136:139]
    buffer_load_dwordx4 v11, s[28:31], s54 offen  lds
    ds_read_b64_tr_b16 v[68:69], v19 offset:28672
    v_mfma_f32_16x16x32_bf16 v[152:155], v[100:103], v[48:51], v[152:155]
    ds_read_b64_tr_b16 v[70:71], v19 offset:29696
    v_mfma_f32_16x16x32_bf16 v[156:159], v[100:103], v[52:55], v[156:159]
    v_mfma_f32_16x16x32_bf16 v[160:163], v[100:103], v[56:59], v[160:163]
    ds_read_b64_tr_b16 v[72:73], v18 offset:28928
    v_mfma_f32_16x16x32_bf16 v[164:167], v[100:103], v[60:63], v[164:167]
    ds_read_b64_tr_b16 v[74:75], v18 offset:29952
    v_mfma_f32_16x16x32_bf16 v[180:183], v[104:107], v[60:63], v[180:183]
    ds_read_b64_tr_b16 v[76:77], v19 offset:28928
    s_add_u32 m0, s61, 14336
    v_mfma_f32_16x16x32_bf16 v[176:179], v[104:107], v[56:59], v[176:179]
    buffer_load_dwordx4 v12, s[28:31], s54 offen  lds
    v_mfma_f32_16x16x32_bf16 v[172:175], v[104:107], v[52:55], v[172:175]
    ds_read_b64_tr_b16 v[78:79], v19 offset:29952
    v_mfma_f32_16x16x32_bf16 v[168:171], v[104:107], v[48:51], v[168:171]
    ds_read_b64_tr_b16 v[80:81], v18 offset:29184
    v_mfma_f32_16x16x32_bf16 v[184:187], v[108:111], v[48:51], v[184:187]
    ds_read_b64_tr_b16 v[82:83], v18 offset:30208
    v_mfma_f32_16x16x32_bf16 v[188:191], v[108:111], v[52:55], v[188:191]
    ds_read_b64_tr_b16 v[84:85], v19 offset:29184
    v_mfma_f32_16x16x32_bf16 v[192:195], v[108:111], v[56:59], v[192:195]
    s_mul_i32 s68, s58, 1
    s_add_u32 m0, s62, s68
    v_mfma_f32_16x16x32_bf16 v[196:199], v[108:111], v[60:63], v[196:199]
    buffer_load_dwordx4 v13, s[32:35], s55 offen  lds
    s_add_u32 s54, s54, s56
    s_add_u32 s55, s55, 229376
    ds_read_b64_tr_b16 v[86:87], v19 offset:30208
    v_mfma_f32_16x16x32_bf16 v[212:215], v[112:115], v[60:63], v[212:215]
    ds_read_b64_tr_b16 v[88:89], v18 offset:29440
    v_mfma_f32_16x16x32_bf16 v[208:211], v[112:115], v[56:59], v[208:211]
    ds_read_b64_tr_b16 v[90:91], v18 offset:30464
    v_mfma_f32_16x16x32_bf16 v[204:207], v[112:115], v[52:55], v[204:207]
    v_mfma_f32_16x16x32_bf16 v[200:203], v[112:115], v[48:51], v[200:203]
    v_mfma_f32_16x16x32_bf16 v[216:219], v[116:119], v[48:51], v[216:219]
    v_mfma_f32_16x16x32_bf16 v[220:223], v[116:119], v[52:55], v[220:223]
    v_mfma_f32_16x16x32_bf16 v[224:227], v[116:119], v[56:59], v[224:227]
    v_mfma_f32_16x16x32_bf16 v[228:231], v[116:119], v[60:63], v[228:231]
    s_waitcnt vmcnt(8) lgkmcnt(0)
    s_barrier
    v_mfma_f32_16x16x32_bf16 v[120:123], v[64:67], v[32:35], v[120:123]
    ds_read_b128 v[48:51], v7 offset:0
    s_add_u32 m0, s59, 28672
    v_mfma_f32_16x16x32_bf16 v[124:127], v[64:67], v[36:39], v[124:127]
    buffer_load_dwordx4 v10, s[28:31], s54 offen  lds
    ds_read_b128 v[52:55], v7 offset:2048
    v_mfma_f32_16x16x32_bf16 v[128:131], v[64:67], v[40:43], v[128:131]
    ds_read_b128 v[56:59], v7 offset:4096
    v_mfma_f32_16x16x32_bf16 v[132:135], v[64:67], v[44:47], v[132:135]
    ds_read_b128 v[60:63], v7 offset:6144
    v_mfma_f32_16x16x32_bf16 v[148:151], v[68:71], v[44:47], v[148:151]
    v_mfma_f32_16x16x32_bf16 v[144:147], v[68:71], v[40:43], v[144:147]
    ds_read_b64_tr_b16 v[92:93], v18 offset:43008
    v_mfma_f32_16x16x32_bf16 v[140:143], v[68:71], v[36:39], v[140:143]
    ds_read_b64_tr_b16 v[94:95], v18 offset:44032
    s_add_u32 m0, s60, 28672
    v_mfma_f32_16x16x32_bf16 v[136:139], v[68:71], v[32:35], v[136:139]
    buffer_load_dwordx4 v11, s[28:31], s54 offen  lds
    ds_read_b64_tr_b16 v[96:97], v19 offset:43008
    v_mfma_f32_16x16x32_bf16 v[152:155], v[72:75], v[32:35], v[152:155]
    ds_read_b64_tr_b16 v[98:99], v19 offset:44032
    v_mfma_f32_16x16x32_bf16 v[156:159], v[72:75], v[36:39], v[156:159]
    v_mfma_f32_16x16x32_bf16 v[160:163], v[72:75], v[40:43], v[160:163]
    ds_read_b64_tr_b16 v[100:101], v18 offset:43264
    v_mfma_f32_16x16x32_bf16 v[164:167], v[72:75], v[44:47], v[164:167]
    ds_read_b64_tr_b16 v[102:103], v18 offset:44288
    v_mfma_f32_16x16x32_bf16 v[180:183], v[76:79], v[44:47], v[180:183]
    ds_read_b64_tr_b16 v[104:105], v19 offset:43264
    s_add_u32 m0, s61, 28672
    v_mfma_f32_16x16x32_bf16 v[176:179], v[76:79], v[40:43], v[176:179]
    buffer_load_dwordx4 v12, s[28:31], s54 offen  lds
    v_mfma_f32_16x16x32_bf16 v[172:175], v[76:79], v[36:39], v[172:175]
    ds_read_b64_tr_b16 v[106:107], v19 offset:44288
    v_mfma_f32_16x16x32_bf16 v[168:171], v[76:79], v[32:35], v[168:171]
    ds_read_b64_tr_b16 v[108:109], v18 offset:43520
    v_mfma_f32_16x16x32_bf16 v[184:187], v[80:83], v[32:35], v[184:187]
    ds_read_b64_tr_b16 v[110:111], v18 offset:44544
    v_mfma_f32_16x16x32_bf16 v[188:191], v[80:83], v[36:39], v[188:191]
    ds_read_b64_tr_b16 v[112:113], v19 offset:43520
    v_mfma_f32_16x16x32_bf16 v[192:195], v[80:83], v[40:43], v[192:195]
    s_mul_i32 s68, s58, 2
    s_add_u32 m0, s62, s68
    v_mfma_f32_16x16x32_bf16 v[196:199], v[80:83], v[44:47], v[196:199]
    buffer_load_dwordx4 v13, s[32:35], s55 offen  lds
    s_add_u32 s54, s54, s56
    s_add_u32 s55, s55, 229376
    ds_read_b64_tr_b16 v[114:115], v19 offset:44544
    v_mfma_f32_16x16x32_bf16 v[212:215], v[84:87], v[44:47], v[212:215]
    ds_read_b64_tr_b16 v[116:117], v18 offset:43776
    v_mfma_f32_16x16x32_bf16 v[208:211], v[84:87], v[40:43], v[208:211]
    ds_read_b64_tr_b16 v[118:119], v18 offset:44800
    v_mfma_f32_16x16x32_bf16 v[204:207], v[84:87], v[36:39], v[204:207]
    v_mfma_f32_16x16x32_bf16 v[200:203], v[84:87], v[32:35], v[200:203]
    v_mfma_f32_16x16x32_bf16 v[216:219], v[88:91], v[32:35], v[216:219]
    v_mfma_f32_16x16x32_bf16 v[220:223], v[88:91], v[36:39], v[220:223]
    v_mfma_f32_16x16x32_bf16 v[224:227], v[88:91], v[40:43], v[224:227]
    v_mfma_f32_16x16x32_bf16 v[228:231], v[88:91], v[44:47], v[228:231]
    s_waitcnt vmcnt(8) lgkmcnt(0)
    s_barrier
    v_mfma_f32_16x16x32_bf16 v[120:123], v[92:95], v[48:51], v[120:123]
    ds_read_b128 v[32:35], v6 offset:32768
    s_add_u32 m0, s59, 43008
    v_mfma_f32_16x16x32_bf16 v[124:127], v[92:95], v[52:55], v[124:127]
    buffer_load_dwordx4 v10, s[28:31], s54 offen  lds
    ds_read_b128 v[36:39], v6 offset:34816
    v_mfma_f32_16x16x32_bf16 v[128:131], v[92:95], v[56:59], v[128:131]
    ds_read_b128 v[40:43], v6 offset:36864
    v_mfma_f32_16x16x32_bf16 v[132:135], v[92:95], v[60:63], v[132:135]
    ds_read_b128 v[44:47], v6 offset:38912
    v_mfma_f32_16x16x32_bf16 v[148:151], v[96:99], v[60:63], v[148:151]
    v_mfma_f32_16x16x32_bf16 v[144:147], v[96:99], v[56:59], v[144:147]
    ds_read_b64_tr_b16 v[64:65], v18 offset:0
    v_mfma_f32_16x16x32_bf16 v[140:143], v[96:99], v[52:55], v[140:143]
    ds_read_b64_tr_b16 v[66:67], v18 offset:1024
    s_add_u32 m0, s60, 43008
    v_mfma_f32_16x16x32_bf16 v[136:139], v[96:99], v[48:51], v[136:139]
    buffer_load_dwordx4 v11, s[28:31], s54 offen  lds
    ds_read_b64_tr_b16 v[68:69], v19 offset:0
    v_mfma_f32_16x16x32_bf16 v[152:155], v[100:103], v[48:51], v[152:155]
    ds_read_b64_tr_b16 v[70:71], v19 offset:1024
    v_mfma_f32_16x16x32_bf16 v[156:159], v[100:103], v[52:55], v[156:159]
    v_mfma_f32_16x16x32_bf16 v[160:163], v[100:103], v[56:59], v[160:163]
    ds_read_b64_tr_b16 v[72:73], v18 offset:256
    v_mfma_f32_16x16x32_bf16 v[164:167], v[100:103], v[60:63], v[164:167]
    ds_read_b64_tr_b16 v[74:75], v18 offset:1280
    v_mfma_f32_16x16x32_bf16 v[180:183], v[104:107], v[60:63], v[180:183]
    ds_read_b64_tr_b16 v[76:77], v19 offset:256
    s_add_u32 m0, s61, 43008
    v_mfma_f32_16x16x32_bf16 v[176:179], v[104:107], v[56:59], v[176:179]
    buffer_load_dwordx4 v12, s[28:31], s54 offen  lds
    v_mfma_f32_16x16x32_bf16 v[172:175], v[104:107], v[52:55], v[172:175]
    ds_read_b64_tr_b16 v[78:79], v19 offset:1280
    v_mfma_f32_16x16x32_bf16 v[168:171], v[104:107], v[48:51], v[168:171]
    ds_read_b64_tr_b16 v[80:81], v18 offset:512
    v_mfma_f32_16x16x32_bf16 v[184:187], v[108:111], v[48:51], v[184:187]
    ds_read_b64_tr_b16 v[82:83], v18 offset:1536
    v_mfma_f32_16x16x32_bf16 v[188:191], v[108:111], v[52:55], v[188:191]
    ds_read_b64_tr_b16 v[84:85], v19 offset:512
    v_mfma_f32_16x16x32_bf16 v[192:195], v[108:111], v[56:59], v[192:195]
    s_mul_i32 s68, s58, 3
    s_add_u32 m0, s62, s68
    v_mfma_f32_16x16x32_bf16 v[196:199], v[108:111], v[60:63], v[196:199]
    buffer_load_dwordx4 v13, s[32:35], s55 offen  lds
    s_add_u32 s54, s54, s56
    s_add_u32 s55, s55, 229376
    ds_read_b64_tr_b16 v[86:87], v19 offset:1536
    v_mfma_f32_16x16x32_bf16 v[212:215], v[112:115], v[60:63], v[212:215]
    ds_read_b64_tr_b16 v[88:89], v18 offset:768
    v_mfma_f32_16x16x32_bf16 v[208:211], v[112:115], v[56:59], v[208:211]
    ds_read_b64_tr_b16 v[90:91], v18 offset:1792
    v_mfma_f32_16x16x32_bf16 v[204:207], v[112:115], v[52:55], v[204:207]
    v_mfma_f32_16x16x32_bf16 v[200:203], v[112:115], v[48:51], v[200:203]
    v_mfma_f32_16x16x32_bf16 v[216:219], v[116:119], v[48:51], v[216:219]
    v_mfma_f32_16x16x32_bf16 v[220:223], v[116:119], v[52:55], v[220:223]
    v_mfma_f32_16x16x32_bf16 v[224:227], v[116:119], v[56:59], v[224:227]
    v_mfma_f32_16x16x32_bf16 v[228:231], v[116:119], v[60:63], v[228:231]
    s_waitcnt vmcnt(8) lgkmcnt(0)
    s_barrier
    v_mfma_f32_16x16x32_bf16 v[120:123], v[64:67], v[32:35], v[120:123]
    ds_read_b128 v[48:51], v7 offset:32768
    s_add_u32 m0, s59, 0
    v_mfma_f32_16x16x32_bf16 v[124:127], v[64:67], v[36:39], v[124:127]
    buffer_load_dwordx4 v10, s[28:31], s54 offen  lds
    ds_read_b128 v[52:55], v7 offset:34816
    v_mfma_f32_16x16x32_bf16 v[128:131], v[64:67], v[40:43], v[128:131]
    ds_read_b128 v[56:59], v7 offset:36864
    v_mfma_f32_16x16x32_bf16 v[132:135], v[64:67], v[44:47], v[132:135]
    ds_read_b128 v[60:63], v7 offset:38912
    v_mfma_f32_16x16x32_bf16 v[148:151], v[68:71], v[44:47], v[148:151]
    v_mfma_f32_16x16x32_bf16 v[144:147], v[68:71], v[40:43], v[144:147]
    ds_read_b64_tr_b16 v[92:93], v18 offset:14336
    v_mfma_f32_16x16x32_bf16 v[140:143], v[68:71], v[36:39], v[140:143]
    ds_read_b64_tr_b16 v[94:95], v18 offset:15360
    s_add_u32 m0, s60, 0
    v_mfma_f32_16x16x32_bf16 v[136:139], v[68:71], v[32:35], v[136:139]
    buffer_load_dwordx4 v11, s[28:31], s54 offen  lds
    ds_read_b64_tr_b16 v[96:97], v19 offset:14336
    v_mfma_f32_16x16x32_bf16 v[152:155], v[72:75], v[32:35], v[152:155]
    ds_read_b64_tr_b16 v[98:99], v19 offset:15360
    v_mfma_f32_16x16x32_bf16 v[156:159], v[72:75], v[36:39], v[156:159]
    v_mfma_f32_16x16x32_bf16 v[160:163], v[72:75], v[40:43], v[160:163]
    ds_read_b64_tr_b16 v[100:101], v18 offset:14592
    v_mfma_f32_16x16x32_bf16 v[164:167], v[72:75], v[44:47], v[164:167]
    ds_read_b64_tr_b16 v[102:103], v18 offset:15616
    v_mfma_f32_16x16x32_bf16 v[180:183], v[76:79], v[44:47], v[180:183]
    ds_read_b64_tr_b16 v[104:105], v19 offset:14592
    s_add_u32 m0, s61, 0
    v_mfma_f32_16x16x32_bf16 v[176:179], v[76:79], v[40:43], v[176:179]
    buffer_load_dwordx4 v12, s[28:31], s54 offen  lds
    v_mfma_f32_16x16x32_bf16 v[172:175], v[76:79], v[36:39], v[172:175]
    ds_read_b64_tr_b16 v[106:107], v19 offset:15616
    v_mfma_f32_16x16x32_bf16 v[168:171], v[76:79], v[32:35], v[168:171]
    ds_read_b64_tr_b16 v[108:109], v18 offset:14848
    v_mfma_f32_16x16x32_bf16 v[184:187], v[80:83], v[32:35], v[184:187]
    ds_read_b64_tr_b16 v[110:111], v18 offset:15872
    v_mfma_f32_16x16x32_bf16 v[188:191], v[80:83], v[36:39], v[188:191]
    ds_read_b64_tr_b16 v[112:113], v19 offset:14848
    v_mfma_f32_16x16x32_bf16 v[192:195], v[80:83], v[40:43], v[192:195]
    s_mul_i32 s68, s58, 0
    s_add_u32 m0, s62, s68
    v_mfma_f32_16x16x32_bf16 v[196:199], v[80:83], v[44:47], v[196:199]
    buffer_load_dwordx4 v13, s[32:35], s55 offen  lds
    s_add_u32 s54, s54, s56
    s_add_u32 s55, s55, 229376
    ds_read_b64_tr_b16 v[114:115], v19 offset:15872
    v_mfma_f32_16x16x32_bf16 v[212:215], v[84:87], v[44:47], v[212:215]
    ds_read_b64_tr_b16 v[116:117], v18 offset:15104
    v_mfma_f32_16x16x32_bf16 v[208:211], v[84:87], v[40:43], v[208:211]
    ds_read_b64_tr_b16 v[118:119], v18 offset:16128
    v_mfma_f32_16x16x32_bf16 v[204:207], v[84:87], v[36:39], v[204:207]
    v_mfma_f32_16x16x32_bf16 v[200:203], v[84:87], v[32:35], v[200:203]
    v_mfma_f32_16x16x32_bf16 v[216:219], v[88:91], v[32:35], v[216:219]
    v_mfma_f32_16x16x32_bf16 v[220:223], v[88:91], v[36:39], v[220:223]
    v_mfma_f32_16x16x32_bf16 v[224:227], v[88:91], v[40:43], v[224:227]
    v_mfma_f32_16x16x32_bf16 v[228:231], v[88:91], v[44:47], v[228:231]
    s_waitcnt vmcnt(8) lgkmcnt(0)
    s_barrier
    v_mfma_f32_16x16x32_bf16 v[120:123], v[92:95], v[48:51], v[120:123]
    ds_read_b128 v[32:35], v8 offset:0
    s_add_u32 m0, s59, 14336
    v_mfma_f32_16x16x32_bf16 v[124:127], v[92:95], v[52:55], v[124:127]
    buffer_load_dwordx4 v10, s[28:31], s54 offen  lds
    ds_read_b128 v[36:39], v8 offset:2048
    v_mfma_f32_16x16x32_bf16 v[128:131], v[92:95], v[56:59], v[128:131]
    ds_read_b128 v[40:43], v8 offset:4096
    v_mfma_f32_16x16x32_bf16 v[132:135], v[92:95], v[60:63], v[132:135]
    ds_read_b128 v[44:47], v8 offset:6144
    v_mfma_f32_16x16x32_bf16 v[148:151], v[96:99], v[60:63], v[148:151]
    v_mfma_f32_16x16x32_bf16 v[144:147], v[96:99], v[56:59], v[144:147]
    ds_read_b64_tr_b16 v[64:65], v18 offset:28672
    v_mfma_f32_16x16x32_bf16 v[140:143], v[96:99], v[52:55], v[140:143]
    ds_read_b64_tr_b16 v[66:67], v18 offset:29696
    s_add_u32 m0, s60, 14336
    v_mfma_f32_16x16x32_bf16 v[136:139], v[96:99], v[48:51], v[136:139]
    buffer_load_dwordx4 v11, s[28:31], s54 offen  lds
    ds_read_b64_tr_b16 v[68:69], v19 offset:28672
    v_mfma_f32_16x16x32_bf16 v[152:155], v[100:103], v[48:51], v[152:155]
    ds_read_b64_tr_b16 v[70:71], v19 offset:29696
    v_mfma_f32_16x16x32_bf16 v[156:159], v[100:103], v[52:55], v[156:159]
    v_mfma_f32_16x16x32_bf16 v[160:163], v[100:103], v[56:59], v[160:163]
    ds_read_b64_tr_b16 v[72:73], v18 offset:28928
    v_mfma_f32_16x16x32_bf16 v[164:167], v[100:103], v[60:63], v[164:167]
    ds_read_b64_tr_b16 v[74:75], v18 offset:29952
    v_mfma_f32_16x16x32_bf16 v[180:183], v[104:107], v[60:63], v[180:183]
    ds_read_b64_tr_b16 v[76:77], v19 offset:28928
    s_add_u32 m0, s61, 14336
    v_mfma_f32_16x16x32_bf16 v[176:179], v[104:107], v[56:59], v[176:179]
    buffer_load_dwordx4 v12, s[28:31], s54 offen  lds
    v_mfma_f32_16x16x32_bf16 v[172:175], v[104:107], v[52:55], v[172:175]
    ds_read_b64_tr_b16 v[78:79], v19 offset:29952
    v_mfma_f32_16x16x32_bf16 v[168:171], v[104:107], v[48:51], v[168:171]
    ds_read_b64_tr_b16 v[80:81], v18 offset:29184
    v_mfma_f32_16x16x32_bf16 v[184:187], v[108:111], v[48:51], v[184:187]
    ds_read_b64_tr_b16 v[82:83], v18 offset:30208
    v_mfma_f32_16x16x32_bf16 v[188:191], v[108:111], v[52:55], v[188:191]
    ds_read_b64_tr_b16 v[84:85], v19 offset:29184
    v_mfma_f32_16x16x32_bf16 v[192:195], v[108:111], v[56:59], v[192:195]
    s_mul_i32 s68, s58, 1
    s_add_u32 m0, s62, s68
    v_mfma_f32_16x16x32_bf16 v[196:199], v[108:111], v[60:63], v[196:199]
    buffer_load_dwordx4 v13, s[32:35], s55 offen  lds
    s_add_u32 s54, s54, s56
    s_add_u32 s55, s55, 229376
    ds_read_b64_tr_b16 v[86:87], v19 offset:30208
    v_mfma_f32_16x16x32_bf16 v[212:215], v[112:115], v[60:63], v[212:215]
    ds_read_b64_tr_b16 v[88:89], v18 offset:29440
    v_mfma_f32_16x16x32_bf16 v[208:211], v[112:115], v[56:59], v[208:211]
    ds_read_b64_tr_b16 v[90:91], v18 offset:30464
    v_mfma_f32_16x16x32_bf16 v[204:207], v[112:115], v[52:55], v[204:207]
    v_mfma_f32_16x16x32_bf16 v[200:203], v[112:115], v[48:51], v[200:203]
    v_mfma_f32_16x16x32_bf16 v[216:219], v[116:119], v[48:51], v[216:219]
    v_mfma_f32_16x16x32_bf16 v[220:223], v[116:119], v[52:55], v[220:223]
    v_mfma_f32_16x16x32_bf16 v[224:227], v[116:119], v[56:59], v[224:227]
    v_mfma_f32_16x16x32_bf16 v[228:231], v[116:119], v[60:63], v[228:231]
    s_waitcnt vmcnt(8) lgkmcnt(0)
    s_barrier
    v_mfma_f32_16x16x32_bf16 v[120:123], v[64:67], v[32:35], v[120:123]
    ds_read_b128 v[48:51], v9 offset:0
    s_add_u32 m0, s59, 28672
    v_mfma_f32_16x16x32_bf16 v[124:127], v[64:67], v[36:39], v[124:127]
    buffer_load_dwordx4 v10, s[28:31], s54 offen  lds
    ds_read_b128 v[52:55], v9 offset:2048
    v_mfma_f32_16x16x32_bf16 v[128:131], v[64:67], v[40:43], v[128:131]
    ds_read_b128 v[56:59], v9 offset:4096
    v_mfma_f32_16x16x32_bf16 v[132:135], v[64:67], v[44:47], v[132:135]
    ds_read_b128 v[60:63], v9 offset:6144
    v_mfma_f32_16x16x32_bf16 v[148:151], v[68:71], v[44:47], v[148:151]
    v_mfma_f32_16x16x32_bf16 v[144:147], v[68:71], v[40:43], v[144:147]
    ds_read_b64_tr_b16 v[92:93], v18 offset:43008
    v_mfma_f32_16x16x32_bf16 v[140:143], v[68:71], v[36:39], v[140:143]
    ds_read_b64_tr_b16 v[94:95], v18 offset:44032
    s_add_u32 m0, s60, 28672
    v_mfma_f32_16x16x32_bf16 v[136:139], v[68:71], v[32:35], v[136:139]
    buffer_load_dwordx4 v11, s[28:31], s54 offen  lds
    ds_read_b64_tr_b16 v[96:97], v19 offset:43008
    v_mfma_f32_16x16x32_bf16 v[152:155], v[72:75], v[32:35], v[152:155]
    ds_read_b64_tr_b16 v[98:99], v19 offset:44032
    v_mfma_f32_16x16x32_bf16 v[156:159], v[72:75], v[36:39], v[156:159]
    v_mfma_f32_16x16x32_bf16 v[160:163], v[72:75], v[40:43], v[160:163]
    ds_read_b64_tr_b16 v[100:101], v18 offset:43264
    v_mfma_f32_16x16x32_bf16 v[164:167], v[72:75], v[44:47], v[164:167]
    ds_read_b64_tr_b16 v[102:103], v18 offset:44288
    v_mfma_f32_16x16x32_bf16 v[180:183], v[76:79], v[44:47], v[180:183]
    ds_read_b64_tr_b16 v[104:105], v19 offset:43264
    s_add_u32 m0, s61, 28672
    v_mfma_f32_16x16x32_bf16 v[176:179], v[76:79], v[40:43], v[176:179]
    buffer_load_dwordx4 v12, s[28:31], s54 offen  lds
    v_mfma_f32_16x16x32_bf16 v[172:175], v[76:79], v[36:39], v[172:175]
    ds_read_b64_tr_b16 v[106:107], v19 offset:44288
    v_mfma_f32_16x16x32_bf16 v[168:171], v[76:79], v[32:35], v[168:171]
    ds_read_b64_tr_b16 v[108:109], v18 offset:43520
    v_mfma_f32_16x16x32_bf16 v[184:187], v[80:83], v[32:35], v[184:187]
    ds_read_b64_tr_b16 v[110:111], v18 offset:44544
    v_mfma_f32_16x16x32_bf16 v[188:191], v[80:83], v[36:39], v[188:191]
    ds_read_b64_tr_b16 v[112:113], v19 offset:43520
    v_mfma_f32_16x16x32_bf16 v[192:195], v[80:83], v[40:43], v[192:195]
    s_mul_i32 s68, s58, 2
    s_add_u32 m0, s62, s68
    v_mfma_f32_16x16x32_bf16 v[196:199], v[80:83], v[44:47], v[196:199]
    buffer_load_dwordx4 v13, s[32:35], s55 offen  lds
    s_add_u32 s54, s54, s56
    s_add_u32 s55, s55, 229376
    ds_read_b64_tr_b16 v[114:115], v19 offset:44544
    v_mfma_f32_16x16x32_bf16 v[212:215], v[84:87], v[44:47], v[212:215]
    ds_read_b64_tr_b16 v[116:117], v18 offset:43776
    v_mfma_f32_16x16x32_bf16 v[208:211], v[84:87], v[40:43], v[208:211]
    ds_read_b64_tr_b16 v[118:119], v18 offset:44800
    v_mfma_f32_16x16x32_bf16 v[204:207], v[84:87], v[36:39], v[204:207]
    v_mfma_f32_16x16x32_bf16 v[200:203], v[84:87], v[32:35], v[200:203]
    v_mfma_f32_16x16x32_bf16 v[216:219], v[88:91], v[32:35], v[216:219]
    v_mfma_f32_16x16x32_bf16 v[220:223], v[88:91], v[36:39], v[220:223]
    v_mfma_f32_16x16x32_bf16 v[224:227], v[88:91], v[40:43], v[224:227]
    v_mfma_f32_16x16x32_bf16 v[228:231], v[88:91], v[44:47], v[228:231]
    s_waitcnt vmcnt(8) lgkmcnt(0)
    s_barrier
    v_mfma_f32_16x16x32_bf16 v[120:123], v[92:95], v[48:51], v[120:123]
    ds_read_b128 v[32:35], v6 offset:0
    s_add_u32 m0, s59, 43008
    v_mfma_f32_16x16x32_bf16 v[124:127], v[92:95], v[52:55], v[124:127]
    buffer_load_dwordx4 v10, s[28:31], s54 offen  lds
    ds_read_b128 v[36:39], v6 offset:2048
    v_mfma_f32_16x16x32_bf16 v[128:131], v[92:95], v[56:59], v[128:131]
    ds_read_b128 v[40:43], v6 offset:4096
    v_mfma_f32_16x16x32_bf16 v[132:135], v[92:95], v[60:63], v[132:135]
    ds_read_b128 v[44:47], v6 offset:6144
    v_mfma_f32_16x16x32_bf16 v[148:151], v[96:99], v[60:63], v[148:151]
    v_mfma_f32_16x16x32_bf16 v[144:147], v[96:99], v[56:59], v[144:147]
    ds_read_b64_tr_b16 v[64:65], v18 offset:0
    v_mfma_f32_16x16x32_bf16 v[140:143], v[96:99], v[52:55], v[140:143]
    ds_read_b64_tr_b16 v[66:67], v18 offset:1024
    s_add_u32 m0, s60, 43008
    v_mfma_f32_16x16x32_bf16 v[136:139], v[96:99], v[48:51], v[136:139]
    buffer_load_dwordx4 v11, s[28:31], s54 offen  lds
    ds_read_b64_tr_b16 v[68:69], v19 offset:0
    v_mfma_f32_16x16x32_bf16 v[152:155], v[100:103], v[48:51], v[152:155]
    ds_read_b64_tr_b16 v[70:71], v19 offset:1024
    v_mfma_f32_16x16x32_bf16 v[156:159], v[100:103], v[52:55], v[156:159]
    v_mfma_f32_16x16x32_bf16 v[160:163], v[100:103], v[56:59], v[160:163]
    ds_read_b64_tr_b16 v[72:73], v18 offset:256
    v_mfma_f32_16x16x32_bf16 v[164:167], v[100:103], v[60:63], v[164:167]
    ds_read_b64_tr_b16 v[74:75], v18 offset:1280
    v_mfma_f32_16x16x32_bf16 v[180:183], v[104:107], v[60:63], v[180:183]
    ds_read_b64_tr_b16 v[76:77], v19 offset:256
    s_add_u32 m0, s61, 43008
    v_mfma_f32_16x16x32_bf16 v[176:179], v[104:107], v[56:59], v[176:179]
    buffer_load_dwordx4 v12, s[28:31], s54 offen  lds
    v_mfma_f32_16x16x32_bf16 v[172:175], v[104:107], v[52:55], v[172:175]
    ds_read_b64_tr_b16 v[78:79], v19 offset:1280
    v_mfma_f32_16x16x32_bf16 v[168:171], v[104:107], v[48:51], v[168:171]
    ds_read_b64_tr_b16 v[80:81], v18 offset:512
    v_mfma_f32_16x16x32_bf16 v[184:187], v[108:111], v[48:51], v[184:187]
    ds_read_b64_tr_b16 v[82:83], v18 offset:1536
    v_mfma_f32_16x16x32_bf16 v[188:191], v[108:111], v[52:55], v[188:191]
    ds_read_b64_tr_b16 v[84:85], v19 offset:512
    v_mfma_f32_16x16x32_bf16 v[192:195], v[108:111], v[56:59], v[192:195]
    s_mul_i32 s68, s58, 3
    s_add_u32 m0, s62, s68
    v_mfma_f32_16x16x32_bf16 v[196:199], v[108:111], v[60:63], v[196:199]
    buffer_load_dwordx4 v13, s[32:35], s55 offen  lds
    s_add_u32 s54, s54, s56
    s_add_u32 s55, s55, 229376
    ds_read_b64_tr_b16 v[86:87], v19 offset:1536
    v_mfma_f32_16x16x32_bf16 v[212:215], v[112:115], v[60:63], v[212:215]
    ds_read_b64_tr_b16 v[88:89], v18 offset:768
    v_mfma_f32_16x16x32_bf16 v[208:211], v[112:115], v[56:59], v[208:211]
    ds_read_b64_tr_b16 v[90:91], v18 offset:1792
    v_mfma_f32_16x16x32_bf16 v[204:207], v[112:115], v[52:55], v[204:207]
    v_mfma_f32_16x16x32_bf16 v[200:203], v[112:115], v[48:51], v[200:203]
    v_mfma_f32_16x16x32_bf16 v[216:219], v[116:119], v[48:51], v[216:219]
    v_mfma_f32_16x16x32_bf16 v[220:223], v[116:119], v[52:55], v[220:223]
    v_mfma_f32_16x16x32_bf16 v[224:227], v[116:119], v[56:59], v[224:227]
    v_mfma_f32_16x16x32_bf16 v[228:231], v[116:119], v[60:63], v[228:231]
    s_waitcnt vmcnt(8) lgkmcnt(0)
    s_barrier
    v_mfma_f32_16x16x32_bf16 v[120:123], v[64:67], v[32:35], v[120:123]
    ds_read_b128 v[48:51], v7 offset:0
    s_add_u32 m0, s59, 0
    v_mfma_f32_16x16x32_bf16 v[124:127], v[64:67], v[36:39], v[124:127]
    buffer_load_dwordx4 v10, s[28:31], s54 offen  lds
    ds_read_b128 v[52:55], v7 offset:2048
    v_mfma_f32_16x16x32_bf16 v[128:131], v[64:67], v[40:43], v[128:131]
    ds_read_b128 v[56:59], v7 offset:4096
    v_mfma_f32_16x16x32_bf16 v[132:135], v[64:67], v[44:47], v[132:135]
    ds_read_b128 v[60:63], v7 offset:6144
    v_mfma_f32_16x16x32_bf16 v[148:151], v[68:71], v[44:47], v[148:151]
    v_mfma_f32_16x16x32_bf16 v[144:147], v[68:71], v[40:43], v[144:147]
    ds_read_b64_tr_b16 v[92:93], v18 offset:14336
    v_mfma_f32_16x16x32_bf16 v[140:143], v[68:71], v[36:39], v[140:143]
    ds_read_b64_tr_b16 v[94:95], v18 offset:15360
    s_add_u32 m0, s60, 0
    v_mfma_f32_16x16x32_bf16 v[136:139], v[68:71], v[32:35], v[136:139]
    buffer_load_dwordx4 v11, s[28:31], s54 offen  lds
    ds_read_b64_tr_b16 v[96:97], v19 offset:14336
    v_mfma_f32_16x16x32_bf16 v[152:155], v[72:75], v[32:35], v[152:155]
    ds_read_b64_tr_b16 v[98:99], v19 offset:15360
    v_mfma_f32_16x16x32_bf16 v[156:159], v[72:75], v[36:39], v[156:159]
    v_mfma_f32_16x16x32_bf16 v[160:163], v[72:75], v[40:43], v[160:163]
    ds_read_b64_tr_b16 v[100:101], v18 offset:14592
    v_mfma_f32_16x16x32_bf16 v[164:167], v[72:75], v[44:47], v[164:167]
    ds_read_b64_tr_b16 v[102:103], v18 offset:15616
    v_mfma_f32_16x16x32_bf16 v[180:183], v[76:79], v[44:47], v[180:183]
    ds_read_b64_tr_b16 v[104:105], v19 offset:14592
    s_add_u32 m0, s61, 0
    v_mfma_f32_16x16x32_bf16 v[176:179], v[76:79], v[40:43], v[176:179]
    buffer_load_dwordx4 v12, s[28:31], s54 offen  lds
    v_mfma_f32_16x16x32_bf16 v[172:175], v[76:79], v[36:39], v[172:175]
    ds_read_b64_tr_b16 v[106:107], v19 offset:15616
    v_mfma_f32_16x16x32_bf16 v[168:171], v[76:79], v[32:35], v[168:171]
    ds_read_b64_tr_b16 v[108:109], v18 offset:14848
    v_mfma_f32_16x16x32_bf16 v[184:187], v[80:83], v[32:35], v[184:187]
    ds_read_b64_tr_b16 v[110:111], v18 offset:15872
    v_mfma_f32_16x16x32_bf16 v[188:191], v[80:83], v[36:39], v[188:191]
    ds_read_b64_tr_b16 v[112:113], v19 offset:14848
    v_mfma_f32_16x16x32_bf16 v[192:195], v[80:83], v[40:43], v[192:195]
    s_mul_i32 s68, s58, 0
    s_add_u32 m0, s62, s68
    v_mfma_f32_16x16x32_bf16 v[196:199], v[80:83], v[44:47], v[196:199]
    buffer_load_dwordx4 v13, s[32:35], s55 offen  lds
    s_add_u32 s54, s54, s56
    s_add_u32 s55, s55, 229376
    ds_read_b64_tr_b16 v[114:115], v19 offset:15872
    v_mfma_f32_16x16x32_bf16 v[212:215], v[84:87], v[44:47], v[212:215]
    ds_read_b64_tr_b16 v[116:117], v18 offset:15104
    v_mfma_f32_16x16x32_bf16 v[208:211], v[84:87], v[40:43], v[208:211]
    ds_read_b64_tr_b16 v[118:119], v18 offset:16128
    v_mfma_f32_16x16x32_bf16 v[204:207], v[84:87], v[36:39], v[204:207]
    v_mfma_f32_16x16x32_bf16 v[200:203], v[84:87], v[32:35], v[200:203]
    v_mfma_f32_16x16x32_bf16 v[216:219], v[88:91], v[32:35], v[216:219]
    v_mfma_f32_16x16x32_bf16 v[220:223], v[88:91], v[36:39], v[220:223]
    v_mfma_f32_16x16x32_bf16 v[224:227], v[88:91], v[40:43], v[224:227]
    v_mfma_f32_16x16x32_bf16 v[228:231], v[88:91], v[44:47], v[228:231]
    s_waitcnt vmcnt(8) lgkmcnt(0)
    s_barrier
    v_mfma_f32_16x16x32_bf16 v[120:123], v[92:95], v[48:51], v[120:123]
    ds_read_b128 v[32:35], v6 offset:32768
    s_add_u32 m0, s59, 14336
    v_mfma_f32_16x16x32_bf16 v[124:127], v[92:95], v[52:55], v[124:127]
    buffer_load_dwordx4 v10, s[28:31], s54 offen  lds
    ds_read_b128 v[36:39], v6 offset:34816
    v_mfma_f32_16x16x32_bf16 v[128:131], v[92:95], v[56:59], v[128:131]
    ds_read_b128 v[40:43], v6 offset:36864
    v_mfma_f32_16x16x32_bf16 v[132:135], v[92:95], v[60:63], v[132:135]
    ds_read_b128 v[44:47], v6 offset:38912
    v_mfma_f32_16x16x32_bf16 v[148:151], v[96:99], v[60:63], v[148:151]
    v_mfma_f32_16x16x32_bf16 v[144:147], v[96:99], v[56:59], v[144:147]
    ds_read_b64_tr_b16 v[64:65], v18 offset:28672
    v_mfma_f32_16x16x32_bf16 v[140:143], v[96:99], v[52:55], v[140:143]
    ds_read_b64_tr_b16 v[66:67], v18 offset:29696
    s_add_u32 m0, s60, 14336
    v_mfma_f32_16x16x32_bf16 v[136:139], v[96:99], v[48:51], v[136:139]
    buffer_load_dwordx4 v11, s[28:31], s54 offen  lds
    ds_read_b64_tr_b16 v[68:69], v19 offset:28672
    v_mfma_f32_16x16x32_bf16 v[152:155], v[100:103], v[48:51], v[152:155]
    ds_read_b64_tr_b16 v[70:71], v19 offset:29696
    v_mfma_f32_16x16x32_bf16 v[156:159], v[100:103], v[52:55], v[156:159]
    v_mfma_f32_16x16x32_bf16 v[160:163], v[100:103], v[56:59], v[160:163]
    ds_read_b64_tr_b16 v[72:73], v18 offset:28928
    v_mfma_f32_16x16x32_bf16 v[164:167], v[100:103], v[60:63], v[164:167]
    ds_read_b64_tr_b16 v[74:75], v18 offset:29952
    v_mfma_f32_16x16x32_bf16 v[180:183], v[104:107], v[60:63], v[180:183]
    ds_read_b64_tr_b16 v[76:77], v19 offset:28928
    s_add_u32 m0, s61, 14336
    v_mfma_f32_16x16x32_bf16 v[176:179], v[104:107], v[56:59], v[176:179]
    buffer_load_dwordx4 v12, s[28:31], s54 offen  lds
    v_mfma_f32_16x16x32_bf16 v[172:175], v[104:107], v[52:55], v[172:175]
    ds_read_b64_tr_b16 v[78:79], v19 offset:29952
    v_mfma_f32_16x16x32_bf16 v[168:171], v[104:107], v[48:51], v[168:171]
    ds_read_b64_tr_b16 v[80:81], v18 offset:29184
    v_mfma_f32_16x16x32_bf16 v[184:187], v[108:111], v[48:51], v[184:187]
    ds_read_b64_tr_b16 v[82:83], v18 offset:30208
    v_mfma_f32_16x16x32_bf16 v[188:191], v[108:111], v[52:55], v[188:191]
    ds_read_b64_tr_b16 v[84:85], v19 offset:29184
    v_mfma_f32_16x16x32_bf16 v[192:195], v[108:111], v[56:59], v[192:195]
    s_mul_i32 s68, s58, 1
    s_add_u32 m0, s62, s68
    v_mfma_f32_16x16x32_bf16 v[196:199], v[108:111], v[60:63], v[196:199]
    buffer_load_dwordx4 v13, s[32:35], s55 offen  lds
    s_add_u32 s54, s54, s56
    s_add_u32 s55, s55, 229376
    ds_read_b64_tr_b16 v[86:87], v19 offset:30208
    v_mfma_f32_16x16x32_bf16 v[212:215], v[112:115], v[60:63], v[212:215]
    ds_read_b64_tr_b16 v[88:89], v18 offset:29440
    v_mfma_f32_16x16x32_bf16 v[208:211], v[112:115], v[56:59], v[208:211]
    ds_read_b64_tr_b16 v[90:91], v18 offset:30464
    v_mfma_f32_16x16x32_bf16 v[204:207], v[112:115], v[52:55], v[204:207]
    v_mfma_f32_16x16x32_bf16 v[200:203], v[112:115], v[48:51], v[200:203]
    v_mfma_f32_16x16x32_bf16 v[216:219], v[116:119], v[48:51], v[216:219]
    v_mfma_f32_16x16x32_bf16 v[220:223], v[116:119], v[52:55], v[220:223]
    v_mfma_f32_16x16x32_bf16 v[224:227], v[116:119], v[56:59], v[224:227]
    v_mfma_f32_16x16x32_bf16 v[228:231], v[116:119], v[60:63], v[228:231]
    s_waitcnt vmcnt(8) lgkmcnt(0)
    s_barrier
    s_add_u32 s67, s67, 1
    s_cmp_lt_u32 s67, 2
    s_cbranch_scc1 L_s1_kernel_loopG
    v_mfma_f32_16x16x32_bf16 v[120:123], v[64:67], v[32:35], v[120:123]
    ds_read_b128 v[48:51], v7 offset:32768
    s_add_u32 m0, s59, 28672
    v_mfma_f32_16x16x32_bf16 v[124:127], v[64:67], v[36:39], v[124:127]
    buffer_load_dwordx4 v10, s[28:31], s54 offen  lds
    ds_read_b128 v[52:55], v7 offset:34816
    v_mfma_f32_16x16x32_bf16 v[128:131], v[64:67], v[40:43], v[128:131]
    ds_read_b128 v[56:59], v7 offset:36864
    v_mfma_f32_16x16x32_bf16 v[132:135], v[64:67], v[44:47], v[132:135]
    ds_read_b128 v[60:63], v7 offset:38912
    v_mfma_f32_16x16x32_bf16 v[148:151], v[68:71], v[44:47], v[148:151]
    v_mfma_f32_16x16x32_bf16 v[144:147], v[68:71], v[40:43], v[144:147]
    ds_read_b64_tr_b16 v[92:93], v18 offset:43008
    s_add_u32 m0, s60, 28672
    v_mfma_f32_16x16x32_bf16 v[140:143], v[68:71], v[36:39], v[140:143]
    buffer_load_dwordx4 v11, s[28:31], s54 offen  lds
    ds_read_b64_tr_b16 v[94:95], v18 offset:44032
    v_mfma_f32_16x16x32_bf16 v[136:139], v[68:71], v[32:35], v[136:139]
    ds_read_b64_tr_b16 v[96:97], v19 offset:43008
    v_mfma_f32_16x16x32_bf16 v[152:155], v[72:75], v[32:35], v[152:155]
    ds_read_b64_tr_b16 v[98:99], v19 offset:44032
    v_mfma_f32_16x16x32_bf16 v[156:159], v[72:75], v[36:39], v[156:159]
    v_mfma_f32_16x16x32_bf16 v[160:163], v[72:75], v[40:43], v[160:163]
    ds_read_b64_tr_b16 v[100:101], v18 offset:43264
    s_add_u32 m0, s61, 28672
    v_mfma_f32_16x16x32_bf16 v[164:167], v[72:75], v[44:47], v[164:167]
    buffer_load_dwordx4 v12, s[28:31], s54 offen  lds
    ds_read_b64_tr_b16 v[102:103], v18 offset:44288
    v_mfma_f32_16x16x32_bf16 v[180:183], v[76:79], v[44:47], v[180:183]
    ds_read_b64_tr_b16 v[104:105], v19 offset:43264
    v_mfma_f32_16x16x32_bf16 v[176:179], v[76:79], v[40:43], v[176:179]
    v_mfma_f32_16x16x32_bf16 v[172:175], v[76:79], v[36:39], v[172:175]
    ds_read_b64_tr_b16 v[106:107], v19 offset:44288
    v_mfma_f32_16x16x32_bf16 v[168:171], v[76:79], v[32:35], v[168:171]
    ds_read_b64_tr_b16 v[108:109], v18 offset:43520
    s_mul_i32 s68, s58, 2
    s_add_u32 m0, s62, s68
    v_mfma_f32_16x16x32_bf16 v[184:187], v[80:83], v[32:35], v[184:187]
    buffer_load_dwordx4 v13, s[32:35], s55 offen  lds
    s_add_u32 s54, s54, s56
    s_add_u32 s55, s55, 229376
    ds_read_b64_tr_b16 v[110:111], v18 offset:44544
    v_mfma_f32_16x16x32_bf16 v[188:191], v[80:83], v[36:39], v[188:191]
    ds_read_b64_tr_b16 v[112:113], v19 offset:43520
    v_mfma_f32_16x16x32_bf16 v[192:195], v[80:83], v[40:43], v[192:195]
    v_mfma_f32_16x16x32_bf16 v[196:199], v[80:83], v[44:47], v[196:199]
    ds_read_b64_tr_b16 v[114:115], v19 offset:44544
    v_mfma_f32_16x16x32_bf16 v[212:215], v[84:87], v[44:47], v[212:215]
    ds_read_b64_tr_b16 v[116:117], v18 offset:43776
    v_mfma_f32_16x16x32_bf16 v[208:211], v[84:87], v[40:43], v[208:211]
    ds_read_b64_tr_b16 v[118:119], v18 offset:44800
    s_lshl_b32 s68, s50, 8
    s_lshl_b32 s69, s51, 3
    s_add_u32 s68, s68, s69
    s_add_u32 s68, s68, s48
    s_lshl_b32 s63, s68, 2
    s_add_u32 s63, s63, 33816576
    s_lshl_b32 s68, s68, 11
    s_mov_b32 s40, s18
    s_mov_b32 s41, s19
    s_mov_b32 s42, 2048
    s_mov_b32 s43, 0x20000
    buffer_load_dwordx4 v[232:235], v22, s[24:27], s68 offen
    buffer_load_dwordx4 v[236:239], v22, s[24:27], s68 offen offset:1024
    buffer_load_dwordx4 v[240:243], v22, s[40:43], 0 offen
    buffer_load_dwordx4 v[244:247], v22, s[40:43], 0 offen offset:1024
    v_mfma_f32_16x16x32_bf16 v[204:207], v[84:87], v[36:39], v[204:207]
    v_mfma_f32_16x16x32_bf16 v[200:203], v[84:87], v[32:35], v[200:203]
    v_mfma_f32_16x16x32_bf16 v[216:219], v[88:91], v[32:35], v[216:219]
    v_mfma_f32_16x16x32_bf16 v[220:223], v[88:91], v[36:39], v[220:223]
    v_mfma_f32_16x16x32_bf16 v[224:227], v[88:91], v[40:43], v[224:227]
    v_mfma_f32_16x16x32_bf16 v[228:231], v[88:91], v[44:47], v[228:231]
    s_waitcnt vmcnt(12) lgkmcnt(0)
    s_barrier
    v_mfma_f32_16x16x32_bf16 v[120:123], v[92:95], v[48:51], v[120:123]
    ds_read_b128 v[32:35], v8 offset:0
    s_add_u32 m0, s59, 43008
    v_mfma_f32_16x16x32_bf16 v[124:127], v[92:95], v[52:55], v[124:127]
    buffer_load_dwordx4 v10, s[28:31], s54 offen  lds
    ds_read_b128 v[36:39], v8 offset:2048
    v_mfma_f32_16x16x32_bf16 v[128:131], v[92:95], v[56:59], v[128:131]
    ds_read_b128 v[40:43], v8 offset:4096
    v_mfma_f32_16x16x32_bf16 v[132:135], v[92:95], v[60:63], v[132:135]
    ds_read_b128 v[44:47], v8 offset:6144
    v_mfma_f32_16x16x32_bf16 v[148:151], v[96:99], v[60:63], v[148:151]
    v_mfma_f32_16x16x32_bf16 v[144:147], v[96:99], v[56:59], v[144:147]
    ds_read_b64_tr_b16 v[64:65], v18 offset:0
    v_mfma_f32_16x16x32_bf16 v[140:143], v[96:99], v[52:55], v[140:143]
    ds_read_b64_tr_b16 v[66:67], v18 offset:1024
    s_add_u32 m0, s60, 43008
    v_mfma_f32_16x16x32_bf16 v[136:139], v[96:99], v[48:51], v[136:139]
    buffer_load_dwordx4 v11, s[28:31], s54 offen  lds
    ds_read_b64_tr_b16 v[68:69], v19 offset:0
    v_mfma_f32_16x16x32_bf16 v[152:155], v[100:103], v[48:51], v[152:155]
    ds_read_b64_tr_b16 v[70:71], v19 offset:1024
    v_mfma_f32_16x16x32_bf16 v[156:159], v[100:103], v[52:55], v[156:159]
    v_mfma_f32_16x16x32_bf16 v[160:163], v[100:103], v[56:59], v[160:163]
    ds_read_b64_tr_b16 v[72:73], v18 offset:256
    v_mfma_f32_16x16x32_bf16 v[164:167], v[100:103], v[60:63], v[164:167]
    ds_read_b64_tr_b16 v[74:75], v18 offset:1280
    v_mfma_f32_16x16x32_bf16 v[180:183], v[104:107], v[60:63], v[180:183]
    ds_read_b64_tr_b16 v[76:77], v19 offset:256
    s_add_u32 m0, s61, 43008
    v_mfma_f32_16x16x32_bf16 v[176:179], v[104:107], v[56:59], v[176:179]
    buffer_load_dwordx4 v12, s[28:31], s54 offen  lds
    v_mfma_f32_16x16x32_bf16 v[172:175], v[104:107], v[52:55], v[172:175]
    ds_read_b64_tr_b16 v[78:79], v19 offset:1280
    v_mfma_f32_16x16x32_bf16 v[168:171], v[104:107], v[48:51], v[168:171]
    ds_read_b64_tr_b16 v[80:81], v18 offset:512
    v_mfma_f32_16x16x32_bf16 v[184:187], v[108:111], v[48:51], v[184:187]
    ds_read_b64_tr_b16 v[82:83], v18 offset:1536
    v_mfma_f32_16x16x32_bf16 v[188:191], v[108:111], v[52:55], v[188:191]
    ds_read_b64_tr_b16 v[84:85], v19 offset:512
    v_mfma_f32_16x16x32_bf16 v[192:195], v[108:111], v[56:59], v[192:195]
    s_mul_i32 s68, s58, 3
    s_add_u32 m0, s62, s68
    v_mfma_f32_16x16x32_bf16 v[196:199], v[108:111], v[60:63], v[196:199]
    buffer_load_dwordx4 v13, s[32:35], s55 offen  lds
    s_add_u32 s54, s54, s56
    s_add_u32 s55, s55, 229376
    ds_read_b64_tr_b16 v[86:87], v19 offset:1536
    v_mfma_f32_16x16x32_bf16 v[212:215], v[112:115], v[60:63], v[212:215]
    ds_read_b64_tr_b16 v[88:89], v18 offset:768
    v_mfma_f32_16x16x32_bf16 v[208:211], v[112:115], v[56:59], v[208:211]
    ds_read_b64_tr_b16 v[90:91], v18 offset:1792
    v_mfma_f32_16x16x32_bf16 v[204:207], v[112:115], v[52:55], v[204:207]
    v_mfma_f32_16x16x32_bf16 v[200:203], v[112:115], v[48:51], v[200:203]
    v_mfma_f32_16x16x32_bf16 v[216:219], v[116:119], v[48:51], v[216:219]
    v_mfma_f32_16x16x32_bf16 v[220:223], v[116:119], v[52:55], v[220:223]
    v_mfma_f32_16x16x32_bf16 v[224:227], v[116:119], v[56:59], v[224:227]
    v_mfma_f32_16x16x32_bf16 v[228:231], v[116:119], v[60:63], v[228:231]
    s_waitcnt vmcnt(12) lgkmcnt(0)
    s_barrier
    v_mfma_f32_16x16x32_bf16 v[120:123], v[64:67], v[32:35], v[120:123]
    ds_read_b128 v[48:51], v9 offset:0
    s_waitcnt vmcnt(4)
    v_mfma_f32_16x16x32_bf16 v[124:127], v[64:67], v[36:39], v[124:127]
    ds_read_b128 v[52:55], v9 offset:2048
    v_mov_b32 v250, 0
    v_mfma_f32_16x16x32_bf16 v[128:131], v[64:67], v[40:43], v[128:131]
    ds_read_b128 v[56:59], v9 offset:4096
    v_mov_b32 v251, 0
    v_mfma_f32_16x16x32_bf16 v[132:135], v[64:67], v[44:47], v[132:135]
    ds_read_b128 v[60:63], v9 offset:6144
    v_lshlrev_b32 v248, 16, v232
    v_mfma_f32_16x16x32_bf16 v[148:151], v[68:71], v[44:47], v[148:151]
    v_and_b32 v249, 0xffff0000, v232
    v_mfma_f32_16x16x32_bf16 v[144:147], v[68:71], v[40:43], v[144:147]
    ds_read_b64_tr_b16 v[92:93], v18 offset:14336
    v_lshlrev_b32 v252, 16, v240
    v_mfma_f32_16x16x32_bf16 v[140:143], v[68:71], v[36:39], v[140:143]
    ds_read_b64_tr_b16 v[94:95], v18 offset:15360
    v_and_b32 v253, 0xffff0000, v240
    v_mfma_f32_16x16x32_bf16 v[136:139], v[68:71], v[32:35], v[136:139]
    ds_read_b64_tr_b16 v[96:97], v19 offset:14336
    v_fma_f32 v250, v248, v252, v250
    v_mfma_f32_16x16x32_bf16 v[152:155], v[72:75], v[32:35], v[152:155]
    ds_read_b64_tr_b16 v[98:99], v19 offset:15360
    v_fma_f32 v251, v249, v253, v251
    v_mfma_f32_16x16x32_bf16 v[156:159], v[72:75], v[36:39], v[156:159]
    v_mfma_f32_16x16x32_bf16 v[160:163], v[72:75], v[40:43], v[160:163]
    ds_read_b64_tr_b16 v[100:101], v18 offset:14592
    v_lshlrev_b32 v248, 16, v233
    v_mfma_f32_16x16x32_bf16 v[164:167], v[72:75], v[44:47], v[164:167]
    ds_read_b64_tr_b16 v[102:103], v18 offset:15616
    v_and_b32 v249, 0xffff0000, v233
    v_mfma_f32_16x16x32_bf16 v[180:183], v[76:79], v[44:47], v[180:183]
    ds_read_b64_tr_b16 v[104:105], v19 offset:14592
    v_lshlrev_b32 v252, 16, v241
    v_mfma_f32_16x16x32_bf16 v[176:179], v[76:79], v[40:43], v[176:179]
    v_and_b32 v253, 0xffff0000, v241
    v_mfma_f32_16x16x32_bf16 v[172:175], v[76:79], v[36:39], v[172:175]
    ds_read_b64_tr_b16 v[106:107], v19 offset:15616
    v_fma_f32 v250, v248, v252, v250
    v_mfma_f32_16x16x32_bf16 v[168:171], v[76:79], v[32:35], v[168:171]
    ds_read_b64_tr_b16 v[108:109], v18 offset:14848
    v_fma_f32 v251, v249, v253, v251
    v_mfma_f32_16x16x32_bf16 v[184:187], v[80:83], v[32:35], v[184:187]
    ds_read_b64_tr_b16 v[110:111], v18 offset:15872
    v_lshlrev_b32 v248, 16, v234
    v_mfma_f32_16x16x32_bf16 v[188:191], v[80:83], v[36:39], v[188:191]
    ds_read_b64_tr_b16 v[112:113], v19 offset:14848
    v_and_b32 v249, 0xffff0000, v234
    v_mfma_f32_16x16x32_bf16 v[192:195], v[80:83], v[40:43], v[192:195]
    v_mfma_f32_16x16x32_bf16 v[196:199], v[80:83], v[44:47], v[196:199]
    ds_read_b64_tr_b16 v[114:115], v19 offset:15872
    v_lshlrev_b32 v252, 16, v242
    v_mfma_f32_16x16x32_bf16 v[212:215], v[84:87], v[44:47], v[212:215]
    ds_read_b64_tr_b16 v[116:117], v18 offset:15104
    v_and_b32 v253, 0xffff0000, v242
    v_mfma_f32_16x16x32_bf16 v[208:211], v[84:87], v[40:43], v[208:211]
    ds_read_b64_tr_b16 v[118:119], v18 offset:16128
    v_fma_f32 v250, v248, v252, v250
    v_mfma_f32_16x16x32_bf16 v[204:207], v[84:87], v[36:39], v[204:207]
    v_fma_f32 v251, v249, v253, v251
    v_mfma_f32_16x16x32_bf16 v[200:203], v[84:87], v[32:35], v[200:203]
    v_lshlrev_b32 v248, 16, v235
    v_mfma_f32_16x16x32_bf16 v[216:219], v[88:91], v[32:35], v[216:219]
    v_and_b32 v249, 0xffff0000, v235
    v_mfma_f32_16x16x32_bf16 v[220:223], v[88:91], v[36:39], v[220:223]
    v_lshlrev_b32 v252, 16, v243
    v_mfma_f32_16x16x32_bf16 v[224:227], v[88:91], v[40:43], v[224:227]
    v_mfma_f32_16x16x32_bf16 v[228:231], v[88:91], v[44:47], v[228:231]
    s_waitcnt vmcnt(8) lgkmcnt(0)
    s_barrier
    v_mfma_f32_16x16x32_bf16 v[120:123], v[92:95], v[48:51], v[120:123]
    ds_read_b128 v[32:35], v6 offset:0
    v_mfma_f32_16x16x32_bf16 v[124:127], v[92:95], v[52:55], v[124:127]
    ds_read_b128 v[36:39], v6 offset:2048
    v_and_b32 v253, 0xffff0000, v243
    v_mfma_f32_16x16x32_bf16 v[128:131], v[92:95], v[56:59], v[128:131]
    ds_read_b128 v[40:43], v6 offset:4096
    v_fma_f32 v250, v248, v252, v250
    v_mfma_f32_16x16x32_bf16 v[132:135], v[92:95], v[60:63], v[132:135]
    ds_read_b128 v[44:47], v6 offset:6144
    v_fma_f32 v251, v249, v253, v251
    v_mfma_f32_16x16x32_bf16 v[148:151], v[96:99], v[60:63], v[148:151]
    v_lshlrev_b32 v248, 16, v236
    v_mfma_f32_16x16x32_bf16 v[144:147], v[96:99], v[56:59], v[144:147]
    ds_read_b64_tr_b16 v[64:65], v18 offset:28672
    v_and_b32 v249, 0xffff0000, v236
    v_mfma_f32_16x16x32_bf16 v[140:143], v[96:99], v[52:55], v[140:143]
    ds_read_b64_tr_b16 v[66:67], v18 offset:29696
    v_lshlrev_b32 v252, 16, v244
    v_mfma_f32_16x16x32_bf16 v[136:139], v[96:99], v[48:51], v[136:139]
    ds_read_b64_tr_b16 v[68:69], v19 offset:28672
    v_and_b32 v253, 0xffff0000, v244
    v_mfma_f32_16x16x32_bf16 v[152:155], v[100:103], v[48:51], v[152:155]
    ds_read_b64_tr_b16 v[70:71], v19 offset:29696
    v_fma_f32 v250, v248, v252, v250
    v_mfma_f32_16x16x32_bf16 v[156:159], v[100:103], v[52:55], v[156:159]
    v_mfma_f32_16x16x32_bf16 v[160:163], v[100:103], v[56:59], v[160:163]
    ds_read_b64_tr_b16 v[72:73], v18 offset:28928
    v_fma_f32 v251, v249, v253, v251
    v_mfma_f32_16x16x32_bf16 v[164:167], v[100:103], v[60:63], v[164:167]
    ds_read_b64_tr_b16 v[74:75], v18 offset:29952
    v_lshlrev_b32 v248, 16, v237
    v_mfma_f32_16x16x32_bf16 v[180:183], v[104:107], v[60:63], v[180:183]
    ds_read_b64_tr_b16 v[76:77], v19 offset:28928
    v_and_b32 v249, 0xffff0000, v237
    v_mfma_f32_16x16x32_bf16 v[176:179], v[104:107], v[56:59], v[176:179]
    v_lshlrev_b32 v252, 16, v245
    v_mfma_f32_16x16x32_bf16 v[172:175], v[104:107], v[52:55], v[172:175]
    ds_read_b64_tr_b16 v[78:79], v19 offset:29952
    v_and_b32 v253, 0xffff0000, v245
    v_mfma_f32_16x16x32_bf16 v[168:171], v[104:107], v[48:51], v[168:171]
    ds_read_b64_tr_b16 v[80:81], v18 offset:29184
    v_fma_f32 v250, v248, v252, v250
    v_mfma_f32_16x16x32_bf16 v[184:187], v[108:111], v[48:51], v[184:187]
    ds_read_b64_tr_b16 v[82:83], v18 offset:30208
    v_fma_f32 v251, v249, v253, v251
    v_mfma_f32_16x16x32_bf16 v[188:191], v[108:111], v[52:55], v[188:191]
    ds_read_b64_tr_b16 v[84:85], v19 offset:29184
    v_lshlrev_b32 v248, 16, v238
    v_mfma_f32_16x16x32_bf16 v[192:195], v[108:111], v[56:59], v[192:195]
    v_mfma_f32_16x16x32_bf16 v[196:199], v[108:111], v[60:63], v[196:199]
    ds_read_b64_tr_b16 v[86:87], v19 offset:30208
    v_and_b32 v249, 0xffff0000, v238
    v_mfma_f32_16x16x32_bf16 v[212:215], v[112:115], v[60:63], v[212:215]
    ds_read_b64_tr_b16 v[88:89], v18 offset:29440
    v_lshlrev_b32 v252, 16, v246
    v_mfma_f32_16x16x32_bf16 v[208:211], v[112:115], v[56:59], v[208:211]
    ds_read_b64_tr_b16 v[90:91], v18 offset:30464
    v_and_b32 v253, 0xffff0000, v246
    v_mfma_f32_16x16x32_bf16 v[204:207], v[112:115], v[52:55], v[204:207]
    v_fma_f32 v250, v248, v252, v250
    v_mfma_f32_16x16x32_bf16 v[200:203], v[112:115], v[48:51], v[200:203]
    v_fma_f32 v251, v249, v253, v251
    v_mfma_f32_16x16x32_bf16 v[216:219], v[116:119], v[48:51], v[216:219]
    v_lshlrev_b32 v248, 16, v239
    v_mfma_f32_16x16x32_bf16 v[220:223], v[116:119], v[52:55], v[220:223]
    v_and_b32 v249, 0xffff0000, v239
    v_mfma_f32_16x16x32_bf16 v[224:227], v[116:119], v[56:59], v[224:227]
    v_mfma_f32_16x16x32_bf16 v[228:231], v[116:119], v[60:63], v[228:231]
    s_waitcnt vmcnt(0) lgkmcnt(0)
    s_barrier
    v_mfma_f32_16x16x32_bf16 v[120:123], v[64:67], v[32:35], v[120:123]
    ds_read_b128 v[48:51], v7 offset:0
    s_cmp_eq_u32 s49, 0
    s_cselect_b32 s68, s51, 0
    s_cmp_ge_u32 s68, 16
    s_cbranch_scc0 L_s1_kernel_noc1
    s_mov_b32 s40, s20
    s_mov_b32 s41, s21
    s_mov_b32 s42, 256
    s_mov_b32 s43, 0x20000
    s_lshl_b32 s69, s50, 5
    v_mov_b32 v2, 0
    v_mov_b32 v3, 1
    s_mov_b64 s[70:71], exec
    s_mov_b64 exec, 1
    buffer_atomic_add v3, v2, s[40:43], s69 offen sc1
    s_mov_b64 exec, s[70:71]
L_s1_kernel_noc1:
    v_mfma_f32_16x16x32_bf16 v[124:127], v[64:67], v[36:39], v[124:127]
    ds_read_b128 v[52:55], v7 offset:2048
    v_lshlrev_b32 v252, 16, v247
    v_mfma_f32_16x16x32_bf16 v[128:131], v[64:67], v[40:43], v[128:131]
    ds_read_b128 v[56:59], v7 offset:4096
    v_and_b32 v253, 0xffff0000, v247
    v_mfma_f32_16x16x32_bf16 v[132:135], v[64:67], v[44:47], v[132:135]
    ds_read_b128 v[60:63], v7 offset:6144
    v_fma_f32 v250, v248, v252, v250
    v_mfma_f32_16x16x32_bf16 v[148:151], v[68:71], v[44:47], v[148:151]
    v_fma_f32 v251, v249, v253, v251
    v_mfma_f32_16x16x32_bf16 v[144:147], v[68:71], v[40:43], v[144:147]
    ds_read_b64_tr_b16 v[92:93], v18 offset:43008
    v_add_f32 v248, v250, v251
    v_mfma_f32_16x16x32_bf16 v[140:143], v[68:71], v[36:39], v[140:143]
    ds_read_b64_tr_b16 v[94:95], v18 offset:44032
    v_add_f32_dpp v248, v248, v248 row_ror:8 row_mask:0xf bank_mask:0xf
    v_mfma_f32_16x16x32_bf16 v[136:139], v[68:71], v[32:35], v[136:139]
    ds_read_b64_tr_b16 v[96:97], v19 offset:43008
    v_add_f32_dpp v248, v248, v248 row_ror:4 row_mask:0xf bank_mask:0xf
    v_mfma_f32_16x16x32_bf16 v[152:155], v[72:75], v[32:35], v[152:155]
    ds_read_b64_tr_b16 v[98:99], v19 offset:44032
    v_add_f32_dpp v248, v248, v248 row_ror:2 row_mask:0xf bank_mask:0xf
    v_mfma_f32_16x16x32_bf16 v[156:159], v[72:75], v[36:39], v[156:159]
    v_mfma_f32_16x16x32_bf16 v[160:163], v[72:75], v[40:43], v[160:163]
    ds_read_b64_tr_b16 v[100:101], v18 offset:43264
    v_add_f32_dpp v248, v248, v248 row_ror:1 row_mask:0xf bank_mask:0xf
    v_mfma_f32_16x16x32_bf16 v[164:167], v[72:75], v[44:47], v[164:167]
    ds_read_b64_tr_b16 v[102:103], v18 offset:44288
    v_mov_b32 v249, v248
    v_mfma_f32_16x16x32_bf16 v[180:183], v[76:79], v[44:47], v[180:183]
    ds_read_b64_tr_b16 v[104:105], v19 offset:43264
    v_permlane16_swap_b32 v248, v249
    v_mfma_f32_16x16x32_bf16 v[176:179], v[76:79], v[40:43], v[176:179]
    v_add_f32 v248, v248, v249
    v_mfma_f32_16x16x32_bf16 v[172:175], v[76:79], v[36:39], v[172:175]
    ds_read_b64_tr_b16 v[106:107], v19 offset:44288
    v_mov_b32 v249, v248
    v_mfma_f32_16x16x32_bf16 v[168:171], v[76:79], v[32:35], v[168:171]
    ds_read_b64_tr_b16 v[108:109], v18 offset:43520
    v_permlane32_swap_b32 v248, v249
    v_mfma_f32_16x16x32_bf16 v[184:187], v[80:83], v[32:35], v[184:187]
    ds_read_b64_tr_b16 v[110:111], v18 offset:44544
    v_add_f32 v248, v248, v249
    v_mfma_f32_16x16x32_bf16 v[188:191], v[80:83], v[36:39], v[188:191]
    ds_read_b64_tr_b16 v[112:113], v19 offset:43520
    v_mul_f32 v248, 0xbfb8aa3b, v248
    v_mfma_f32_16x16x32_bf16 v[192:195], v[80:83], v[40:43], v[192:195]
    v_mfma_f32_16x16x32_bf16 v[196:199], v[80:83], v[44:47], v[196:199]
    ds_read_b64_tr_b16 v[114:115], v19 offset:44544
    v_exp_f32 v248, v248
    v_mfma_f32_16x16x32_bf16 v[212:215], v[84:87], v[44:47], v[212:215]
    ds_read_b64_tr_b16 v[116:117], v18 offset:43776
    v_add_f32 v248, 1.0, v248
    v_mfma_f32_16x16x32_bf16 v[208:211], v[84:87], v[40:43], v[208:211]
    ds_read_b64_tr_b16 v[118:119], v18 offset:44800
    v_rcp_f32 v248, v248
    v_mfma_f32_16x16x32_bf16 v[204:207], v[84:87], v[36:39], v[204:207]
    v_lshlrev_b32 v249, 2, v1
    v_mfma_f32_16x16x32_bf16 v[200:203], v[84:87], v[32:35], v[200:203]
    v_cmp_eq_u32 vcc, 0, v1
    v_mfma_f32_16x16x32_bf16 v[216:219], v[88:91], v[32:35], v[216:219]
    v_mov_b32 v250, 0x40000000
    v_mfma_f32_16x16x32_bf16 v[220:223], v[88:91], v[36:39], v[220:223]
    v_cndmask_b32 v249, v250, v249, vcc
    v_mfma_f32_16x16x32_bf16 v[224:227], v[88:91], v[40:43], v[224:227]
    v_mfma_f32_16x16x32_bf16 v[228:231], v[88:91], v[44:47], v[228:231]
    s_waitcnt lgkmcnt(0)
    s_barrier
    v_mfma_f32_16x16x32_bf16 v[120:123], v[92:95], v[48:51], v[120:123]
    v_mfma_f32_16x16x32_bf16 v[124:127], v[92:95], v[52:55], v[124:127]
    v_mfma_f32_16x16x32_bf16 v[128:131], v[92:95], v[56:59], v[128:131]
    buffer_store_dword v248, v249, s[36:39], s63 offen
    v_mfma_f32_16x16x32_bf16 v[132:135], v[92:95], v[60:63], v[132:135]
    v_mfma_f32_16x16x32_bf16 v[148:151], v[96:99], v[60:63], v[148:151]
    v_mfma_f32_16x16x32_bf16 v[144:147], v[96:99], v[56:59], v[144:147]
    v_mfma_f32_16x16x32_bf16 v[140:143], v[96:99], v[52:55], v[140:143]
    v_mfma_f32_16x16x32_bf16 v[136:139], v[96:99], v[48:51], v[136:139]
    v_mfma_f32_16x16x32_bf16 v[152:155], v[100:103], v[48:51], v[152:155]
    v_mfma_f32_16x16x32_bf16 v[156:159], v[100:103], v[52:55], v[156:159]
    v_mfma_f32_16x16x32_bf16 v[160:163], v[100:103], v[56:59], v[160:163]
    v_mfma_f32_16x16x32_bf16 v[164:167], v[100:103], v[60:63], v[164:167]
    v_mfma_f32_16x16x32_bf16 v[180:183], v[104:107], v[60:63], v[180:183]
    v_mfma_f32_16x16x32_bf16 v[176:179], v[104:107], v[56:59], v[176:179]
    v_mfma_f32_16x16x32_bf16 v[172:175], v[104:107], v[52:55], v[172:175]
    v_mfma_f32_16x16x32_bf16 v[168:171], v[104:107], v[48:51], v[168:171]
    v_mfma_f32_16x16x32_bf16 v[184:187], v[108:111], v[48:51], v[184:187]
    v_mfma_f32_16x16x32_bf16 v[188:191], v[108:111], v[52:55], v[188:191]
    v_mfma_f32_16x16x32_bf16 v[192:195], v[108:111], v[56:59], v[192:195]
    v_mfma_f32_16x16x32_bf16 v[196:199], v[108:111], v[60:63], v[196:199]
    v_mfma_f32_16x16x32_bf16 v[212:215], v[112:115], v[60:63], v[212:215]
    v_mfma_f32_16x16x32_bf16 v[208:211], v[112:115], v[56:59], v[208:211]
    v_mfma_f32_16x16x32_bf16 v[204:207], v[112:115], v[52:55], v[204:207]
    v_mfma_f32_16x16x32_bf16 v[200:203], v[112:115], v[48:51], v[200:203]
    v_mfma_f32_16x16x32_bf16 v[216:219], v[116:119], v[48:51], v[216:219]
    v_mfma_f32_16x16x32_bf16 v[220:223], v[116:119], v[52:55], v[220:223]
    v_mfma_f32_16x16x32_bf16 v[224:227], v[116:119], v[56:59], v[224:227]
    v_mfma_f32_16x16x32_bf16 v[228:231], v[116:119], v[60:63], v[228:231]
    s_cmp_lt_u32 s51, 16
    s_cbranch_scc1 L_s1_kernel_noprio
    s_setprio 2
L_s1_kernel_noprio:
    s_mov_b32 s40, s20
    s_mov_b32 s41, s21
    s_mov_b32 s42, 256
    s_mov_b32 s43, 0x20000
    v_mov_b32 v24, 0
    s_lshl_b32 s69, s50, 5
    buffer_load_dword v28, v24, s[40:43], s69 offen sc1
    v_mov_b32 v44, 0xbdd2d3e8
    v_mov_b32 v45, 0xbdd2d3e8
    v_mov_b32 v46, 0xc0135761
    v_mov_b32 v47, 0xc0135761
    v_pk_mul_f32 v[34:35], v[120:121], v[120:121]
    v_pk_mul_f32 v[36:37], v[122:123], v[122:123]
    v_pk_mul_f32 v[38:39], v[124:125], v[124:125]
    v_pk_mul_f32 v[40:41], v[126:127], v[126:127]
    v_pk_fma_f32 v[34:35], v[34:35], v[44:45], v[46:47]
    v_pk_fma_f32 v[36:37], v[36:37], v[44:45], v[46:47]
    v_pk_fma_f32 v[38:39], v[38:39], v[44:45], v[46:47]
    v_pk_fma_f32 v[40:41], v[40:41], v[44:45], v[46:47]
    v_pk_mul_f32 v[34:35], v[34:35], v[120:121]
    v_pk_mul_f32 v[36:37], v[36:37], v[122:123]
    v_pk_mul_f32 v[38:39], v[38:39], v[124:125]
    v_pk_mul_f32 v[40:41], v[40:41], v[126:127]
    v_exp_f32 v34, v34
    v_exp_f32 v35, v35
    v_exp_f32 v36, v36
    v_exp_f32 v37, v37
    v_exp_f32 v38, v38
    v_exp_f32 v39, v39
    v_exp_f32 v40, v40
    v_exp_f32 v41, v41
    v_pk_add_f32 v[34:35], v[34:35], s[72:73]
    v_pk_add_f32 v[36:37], v[36:37], s[72:73]
    v_pk_add_f32 v[38:39], v[38:39], s[72:73]
    v_pk_add_f32 v[40:41], v[40:41], s[72:73]
    v_rcp_f32 v34, v34
    v_rcp_f32 v35, v35
    v_rcp_f32 v36, v36
    v_rcp_f32 v37, v37
    v_rcp_f32 v38, v38
    v_rcp_f32 v39, v39
    v_rcp_f32 v40, v40
    v_rcp_f32 v41, v41
    v_pk_mul_f32 v[120:121], v[120:121], v[34:35]
    v_pk_mul_f32 v[122:123], v[122:123], v[36:37]
    v_pk_mul_f32 v[124:125], v[124:125], v[38:39]
    v_pk_mul_f32 v[126:127], v[126:127], v[40:41]
    v_pk_mul_f32 v[34:35], v[128:129], v[128:129]
    v_pk_mul_f32 v[36:37], v[130:131], v[130:131]
    v_pk_mul_f32 v[38:39], v[132:133], v[132:133]
    v_pk_mul_f32 v[40:41], v[134:135], v[134:135]
    v_pk_fma_f32 v[34:35], v[34:35], v[44:45], v[46:47]
    v_pk_fma_f32 v[36:37], v[36:37], v[44:45], v[46:47]
    v_pk_fma_f32 v[38:39], v[38:39], v[44:45], v[46:47]
    v_pk_fma_f32 v[40:41], v[40:41], v[44:45], v[46:47]
    v_pk_mul_f32 v[34:35], v[34:35], v[128:129]
    v_pk_mul_f32 v[36:37], v[36:37], v[130:131]
    v_pk_mul_f32 v[38:39], v[38:39], v[132:133]
    v_pk_mul_f32 v[40:41], v[40:41], v[134:135]
    v_exp_f32 v34, v34
    v_exp_f32 v35, v35
    v_exp_f32 v36, v36
    v_exp_f32 v37, v37
    v_exp_f32 v38, v38
    v_exp_f32 v39, v39
    v_exp_f32 v40, v40
    v_exp_f32 v41, v41
    v_pk_add_f32 v[34:35], v[34:35], s[72:73]
    v_pk_add_f32 v[36:37], v[36:37], s[72:73]
    v_pk_add_f32 v[38:39], v[38:39], s[72:73]
    v_pk_add_f32 v[40:41], v[40:41], s[72:73]
    v_rcp_f32 v34, v34
    v_rcp_f32 v35, v35
    v_rcp_f32 v36, v36
    v_rcp_f32 v37, v37
    v_rcp_f32 v38, v38
    v_rcp_f32 v39, v39
    v_rcp_f32 v40, v40
    v_rcp_f32 v41, v41
    v_pk_mul_f32 v[128:129], v[128:129], v[34:35]
    v_pk_mul_f32 v[130:131], v[130:131], v[36:37]
    v_pk_mul_f32 v[132:133], v[132:133], v[38:39]
    v_pk_mul_f32 v[134:135], v[134:135], v[40:41]
    v_pk_mul_f32 v[34:35], v[136:137], v[136:137]
    v_pk_mul_f32 v[36:37], v[138:139], v[138:139]
    v_pk_mul_f32 v[38:39], v[140:141], v[140:141]
    v_pk_mul_f32 v[40:41], v[142:143], v[142:143]
    v_pk_fma_f32 v[34:35], v[34:35], v[44:45], v[46:47]
    v_pk_fma_f32 v[36:37], v[36:37], v[44:45], v[46:47]
    v_pk_fma_f32 v[38:39], v[38:39], v[44:45], v[46:47]
    v_pk_fma_f32 v[40:41], v[40:41], v[44:45], v[46:47]
    v_pk_mul_f32 v[34:35], v[34:35], v[136:137]
    v_pk_mul_f32 v[36:37], v[36:37], v[138:139]
    v_pk_mul_f32 v[38:39], v[38:39], v[140:141]
    v_pk_mul_f32 v[40:41], v[40:41], v[142:143]
    v_exp_f32 v34, v34
    v_exp_f32 v35, v35
    v_exp_f32 v36, v36
    v_exp_f32 v37, v37
    v_exp_f32 v38, v38
    v_exp_f32 v39, v39
    v_exp_f32 v40, v40
    v_exp_f32 v41, v41
    v_pk_add_f32 v[34:35], v[34:35], s[72:73]
    v_pk_add_f32 v[36:37], v[36:37], s[72:73]
    v_pk_add_f32 v[38:39], v[38:39], s[72:73]
    v_pk_add_f32 v[40:41], v[40:41], s[72:73]
    v_rcp_f32 v34, v34
    v_rcp_f32 v35, v35
    v_rcp_f32 v36, v36
    v_rcp_f32 v37, v37
    v_rcp_f32 v38, v38
    v_rcp_f32 v39, v39
    v_rcp_f32 v40, v40
    v_rcp_f32 v41, v41
    v_pk_mul_f32 v[136:137], v[136:137], v[34:35]
    v_pk_mul_f32 v[138:139], v[138:139], v[36:37]
    v_pk_mul_f32 v[140:141], v[140:141], v[38:39]
    v_pk_mul_f32 v[142:143], v[142:143], v[40:41]
    v_pk_mul_f32 v[34:35], v[144:145], v[144:145]
    v_pk_mul_f32 v[36:37], v[146:147], v[146:147]
    v_pk_mul_f32 v[38:39], v[148:149], v[148:149]
    v_pk_mul_f32 v[40:41], v[150:151], v[150:151]
    v_pk_fma_f32 v[34:35], v[34:35], v[44:45], v[46:47]
    v_pk_fma_f32 v[36:37], v[36:37], v[44:45], v[46:47]
    v_pk_fma_f32 v[38:39], v[38:39], v[44:45], v[46:47]
    v_pk_fma_f32 v[40:41], v[40:41], v[44:45], v[46:47]
    v_pk_mul_f32 v[34:35], v[34:35], v[144:145]
    v_pk_mul_f32 v[36:37], v[36:37], v[146:147]
    v_pk_mul_f32 v[38:39], v[38:39], v[148:149]
    v_pk_mul_f32 v[40:41], v[40:41], v[150:151]
    v_exp_f32 v34, v34
    v_exp_f32 v35, v35
    v_exp_f32 v36, v36
    v_exp_f32 v37, v37
    v_exp_f32 v38, v38
    v_exp_f32 v39, v39
    v_exp_f32 v40, v40
    v_exp_f32 v41, v41
    v_pk_add_f32 v[34:35], v[34:35], s[72:73]
    v_pk_add_f32 v[36:37], v[36:37], s[72:73]
    v_pk_add_f32 v[38:39], v[38:39], s[72:73]
    v_pk_add_f32 v[40:41], v[40:41], s[72:73]
    v_rcp_f32 v34, v34
    v_rcp_f32 v35, v35
    v_rcp_f32 v36, v36
    v_rcp_f32 v37, v37
    v_rcp_f32 v38, v38
    v_rcp_f32 v39, v39
    v_rcp_f32 v40, v40
    v_rcp_f32 v41, v41
    v_pk_mul_f32 v[144:145], v[144:145], v[34:35]
    v_pk_mul_f32 v[146:147], v[146:147], v[36:37]
    v_pk_mul_f32 v[148:149], v[148:149], v[38:39]
    v_pk_mul_f32 v[150:151], v[150:151], v[40:41]
    v_pk_mul_f32 v[34:35], v[152:153], v[152:153]
    v_pk_mul_f32 v[36:37], v[154:155], v[154:155]
    v_pk_mul_f32 v[38:39], v[156:157], v[156:157]
    v_pk_mul_f32 v[40:41], v[158:159], v[158:159]
    v_pk_fma_f32 v[34:35], v[34:35], v[44:45], v[46:47]
    v_pk_fma_f32 v[36:37], v[36:37], v[44:45], v[46:47]
    v_pk_fma_f32 v[38:39], v[38:39], v[44:45], v[46:47]
    v_pk_fma_f32 v[40:41], v[40:41], v[44:45], v[46:47]
    v_pk_mul_f32 v[34:35], v[34:35], v[152:153]
    v_pk_mul_f32 v[36:37], v[36:37], v[154:155]
    v_pk_mul_f32 v[38:39], v[38:39], v[156:157]
    v_pk_mul_f32 v[40:41], v[40:41], v[158:159]
    v_exp_f32 v34, v34
    v_exp_f32 v35, v35
    v_exp_f32 v36, v36
    v_exp_f32 v37, v37
    v_exp_f32 v38, v38
    v_exp_f32 v39, v39
    v_exp_f32 v40, v40
    v_exp_f32 v41, v41
    v_pk_add_f32 v[34:35], v[34:35], s[72:73]
    v_pk_add_f32 v[36:37], v[36:37], s[72:73]
    v_pk_add_f32 v[38:39], v[38:39], s[72:73]
    v_pk_add_f32 v[40:41], v[40:41], s[72:73]
    v_rcp_f32 v34, v34
    v_rcp_f32 v35, v35
    v_rcp_f32 v36, v36
    v_rcp_f32 v37, v37
    v_rcp_f32 v38, v38
    v_rcp_f32 v39, v39
    v_rcp_f32 v40, v40
    v_rcp_f32 v41, v41
    v_pk_mul_f32 v[152:153], v[152:153], v[34:35]
    v_pk_mul_f32 v[154:155], v[154:155], v[36:37]
    v_pk_mul_f32 v[156:157], v[156:157], v[38:39]
    v_pk_mul_f32 v[158:159], v[158:159], v[40:41]
    v_pk_mul_f32 v[34:35], v[160:161], v[160:161]
    v_pk_mul_f32 v[36:37], v[162:163], v[162:163]
    v_pk_mul_f32 v[38:39], v[164:165], v[164:165]
    v_pk_mul_f32 v[40:41], v[166:167], v[166:167]
    v_pk_fma_f32 v[34:35], v[34:35], v[44:45], v[46:47]
    v_pk_fma_f32 v[36:37], v[36:37], v[44:45], v[46:47]
    v_pk_fma_f32 v[38:39], v[38:39], v[44:45], v[46:47]
    v_pk_fma_f32 v[40:41], v[40:41], v[44:45], v[46:47]
    v_pk_mul_f32 v[34:35], v[34:35], v[160:161]
    v_pk_mul_f32 v[36:37], v[36:37], v[162:163]
    v_pk_mul_f32 v[38:39], v[38:39], v[164:165]
    v_pk_mul_f32 v[40:41], v[40:41], v[166:167]
    v_exp_f32 v34, v34
    v_exp_f32 v35, v35
    v_exp_f32 v36, v36
    v_exp_f32 v37, v37
    v_exp_f32 v38, v38
    v_exp_f32 v39, v39
    v_exp_f32 v40, v40
    v_exp_f32 v41, v41
    v_pk_add_f32 v[34:35], v[34:35], s[72:73]
    v_pk_add_f32 v[36:37], v[36:37], s[72:73]
    v_pk_add_f32 v[38:39], v[38:39], s[72:73]
    v_pk_add_f32 v[40:41], v[40:41], s[72:73]
    v_rcp_f32 v34, v34
    v_rcp_f32 v35, v35
    v_rcp_f32 v36, v36
    v_rcp_f32 v37, v37
    v_rcp_f32 v38, v38
    v_rcp_f32 v39, v39
    v_rcp_f32 v40, v40
    v_rcp_f32 v41, v41
    v_pk_mul_f32 v[160:161], v[160:161], v[34:35]
    v_pk_mul_f32 v[162:163], v[162:163], v[36:37]
    v_pk_mul_f32 v[164:165], v[164:165], v[38:39]
    v_pk_mul_f32 v[166:167], v[166:167], v[40:41]
    v_pk_mul_f32 v[34:35], v[168:169], v[168:169]
    v_pk_mul_f32 v[36:37], v[170:171], v[170:171]
    v_pk_mul_f32 v[38:39], v[172:173], v[172:173]
    v_pk_mul_f32 v[40:41], v[174:175], v[174:175]
    v_pk_fma_f32 v[34:35], v[34:35], v[44:45], v[46:47]
    v_pk_fma_f32 v[36:37], v[36:37], v[44:45], v[46:47]
    v_pk_fma_f32 v[38:39], v[38:39], v[44:45], v[46:47]
    v_pk_fma_f32 v[40:41], v[40:41], v[44:45], v[46:47]
    v_pk_mul_f32 v[34:35], v[34:35], v[168:169]
    v_pk_mul_f32 v[36:37], v[36:37], v[170:171]
    v_pk_mul_f32 v[38:39], v[38:39], v[172:173]
    v_pk_mul_f32 v[40:41], v[40:41], v[174:175]
    v_exp_f32 v34, v34
    v_exp_f32 v35, v35
    v_exp_f32 v36, v36
    v_exp_f32 v37, v37
    v_exp_f32 v38, v38
    v_exp_f32 v39, v39
    v_exp_f32 v40, v40
    v_exp_f32 v41, v41
    v_pk_add_f32 v[34:35], v[34:35], s[72:73]
    v_pk_add_f32 v[36:37], v[36:37], s[72:73]
    v_pk_add_f32 v[38:39], v[38:39], s[72:73]
    v_pk_add_f32 v[40:41], v[40:41], s[72:73]
    v_rcp_f32 v34, v34
    v_rcp_f32 v35, v35
    v_rcp_f32 v36, v36
    v_rcp_f32 v37, v37
    v_rcp_f32 v38, v38
    v_rcp_f32 v39, v39
    v_rcp_f32 v40, v40
    v_rcp_f32 v41, v41
    v_pk_mul_f32 v[168:169], v[168:169], v[34:35]
    v_pk_mul_f32 v[170:171], v[170:171], v[36:37]
    v_pk_mul_f32 v[172:173], v[172:173], v[38:39]
    v_pk_mul_f32 v[174:175], v[174:175], v[40:41]
    v_pk_mul_f32 v[34:35], v[176:177], v[176:177]
    v_pk_mul_f32 v[36:37], v[178:179], v[178:179]
    v_pk_mul_f32 v[38:39], v[180:181], v[180:181]
    v_pk_mul_f32 v[40:41], v[182:183], v[182:183]
    v_pk_fma_f32 v[34:35], v[34:35], v[44:45], v[46:47]
    v_pk_fma_f32 v[36:37], v[36:37], v[44:45], v[46:47]
    v_pk_fma_f32 v[38:39], v[38:39], v[44:45], v[46:47]
    v_pk_fma_f32 v[40:41], v[40:41], v[44:45], v[46:47]
    v_pk_mul_f32 v[34:35], v[34:35], v[176:177]
    v_pk_mul_f32 v[36:37], v[36:37], v[178:179]
    v_pk_mul_f32 v[38:39], v[38:39], v[180:181]
    v_pk_mul_f32 v[40:41], v[40:41], v[182:183]
    v_exp_f32 v34, v34
    v_exp_f32 v35, v35
    v_exp_f32 v36, v36
    v_exp_f32 v37, v37
    v_exp_f32 v38, v38
    v_exp_f32 v39, v39
    v_exp_f32 v40, v40
    v_exp_f32 v41, v41
    v_pk_add_f32 v[34:35], v[34:35], s[72:73]
    v_pk_add_f32 v[36:37], v[36:37], s[72:73]
    v_pk_add_f32 v[38:39], v[38:39], s[72:73]
    v_pk_add_f32 v[40:41], v[40:41], s[72:73]
    v_rcp_f32 v34, v34
    v_rcp_f32 v35, v35
    v_rcp_f32 v36, v36
    v_rcp_f32 v37, v37
    v_rcp_f32 v38, v38
    v_rcp_f32 v39, v39
    v_rcp_f32 v40, v40
    v_rcp_f32 v41, v41
    v_pk_mul_f32 v[176:177], v[176:177], v[34:35]
    v_pk_mul_f32 v[178:179], v[178:179], v[36:37]
    v_pk_mul_f32 v[180:181], v[180:181], v[38:39]
    v_pk_mul_f32 v[182:183], v[182:183], v[40:41]
    v_pk_mul_f32 v[34:35], v[184:185], v[184:185]
    v_pk_mul_f32 v[36:37], v[186:187], v[186:187]
    v_pk_mul_f32 v[38:39], v[188:189], v[188:189]
    v_pk_mul_f32 v[40:41], v[190:191], v[190:191]
    v_pk_fma_f32 v[34:35], v[34:35], v[44:45], v[46:47]
    v_pk_fma_f32 v[36:37], v[36:37], v[44:45], v[46:47]
    v_pk_fma_f32 v[38:39], v[38:39], v[44:45], v[46:47]
    v_pk_fma_f32 v[40:41], v[40:41], v[44:45], v[46:47]
    v_pk_mul_f32 v[34:35], v[34:35], v[184:185]
    v_pk_mul_f32 v[36:37], v[36:37], v[186:187]
    v_pk_mul_f32 v[38:39], v[38:39], v[188:189]
    v_pk_mul_f32 v[40:41], v[40:41], v[190:191]
    v_exp_f32 v34, v34
    v_exp_f32 v35, v35
    v_exp_f32 v36, v36
    v_exp_f32 v37, v37
    v_exp_f32 v38, v38
    v_exp_f32 v39, v39
    v_exp_f32 v40, v40
    v_exp_f32 v41, v41
    v_pk_add_f32 v[34:35], v[34:35], s[72:73]
    v_pk_add_f32 v[36:37], v[36:37], s[72:73]
    v_pk_add_f32 v[38:39], v[38:39], s[72:73]
    v_pk_add_f32 v[40:41], v[40:41], s[72:73]
    v_rcp_f32 v34, v34
    v_rcp_f32 v35, v35
    v_rcp_f32 v36, v36
    v_rcp_f32 v37, v37
    v_rcp_f32 v38, v38
    v_rcp_f32 v39, v39
    v_rcp_f32 v40, v40
    v_rcp_f32 v41, v41
    v_pk_mul_f32 v[184:185], v[184:185], v[34:35]
    v_pk_mul_f32 v[186:187], v[186:187], v[36:37]
    v_pk_mul_f32 v[188:189], v[188:189], v[38:39]
    v_pk_mul_f32 v[190:191], v[190:191], v[40:41]
    v_pk_mul_f32 v[34:35], v[192:193], v[192:193]
    v_pk_mul_f32 v[36:37], v[194:195], v[194:195]
    v_pk_mul_f32 v[38:39], v[196:197], v[196:197]
    v_pk_mul_f32 v[40:41], v[198:199], v[198:199]
    v_pk_fma_f32 v[34:35], v[34:35], v[44:45], v[46:47]
    v_pk_fma_f32 v[36:37], v[36:37], v[44:45], v[46:47]
    v_pk_fma_f32 v[38:39], v[38:39], v[44:45], v[46:47]
    v_pk_fma_f32 v[40:41], v[40:41], v[44:45], v[46:47]
    v_pk_mul_f32 v[34:35], v[34:35], v[192:193]
    v_pk_mul_f32 v[36:37], v[36:37], v[194:195]
    v_pk_mul_f32 v[38:39], v[38:39], v[196:197]
    v_pk_mul_f32 v[40:41], v[40:41], v[198:199]
    v_exp_f32 v34, v34
    v_exp_f32 v35, v35
    v_exp_f32 v36, v36
    v_exp_f32 v37, v37
    v_exp_f32 v38, v38
    v_exp_f32 v39, v39
    v_exp_f32 v40, v40
    v_exp_f32 v41, v41
    v_pk_add_f32 v[34:35], v[34:35], s[72:73]
    v_pk_add_f32 v[36:37], v[36:37], s[72:73]
    v_pk_add_f32 v[38:39], v[38:39], s[72:73]
    v_pk_add_f32 v[40:41], v[40:41], s[72:73]
    v_rcp_f32 v34, v34
    v_rcp_f32 v35, v35
    v_rcp_f32 v36, v36
    v_rcp_f32 v37, v37
    v_rcp_f32 v38, v38
    v_rcp_f32 v39, v39
    v_rcp_f32 v40, v40
    v_rcp_f32 v41, v41
    v_pk_mul_f32 v[192:193], v[192:193], v[34:35]
    v_pk_mul_f32 v[194:195], v[194:195], v[36:37]
    v_pk_mul_f32 v[196:197], v[196:197], v[38:39]
    v_pk_mul_f32 v[198:199], v[198:199], v[40:41]
    v_pk_mul_f32 v[34:35], v[200:201], v[200:201]
    v_pk_mul_f32 v[36:37], v[202:203], v[202:203]
    v_pk_mul_f32 v[38:39], v[204:205], v[204:205]
    v_pk_mul_f32 v[40:41], v[206:207], v[206:207]
    v_pk_fma_f32 v[34:35], v[34:35], v[44:45], v[46:47]
    v_pk_fma_f32 v[36:37], v[36:37], v[44:45], v[46:47]
    v_pk_fma_f32 v[38:39], v[38:39], v[44:45], v[46:47]
    v_pk_fma_f32 v[40:41], v[40:41], v[44:45], v[46:47]
    v_pk_mul_f32 v[34:35], v[34:35], v[200:201]
    v_pk_mul_f32 v[36:37], v[36:37], v[202:203]
    v_pk_mul_f32 v[38:39], v[38:39], v[204:205]
    v_pk_mul_f32 v[40:41], v[40:41], v[206:207]
    v_exp_f32 v34, v34
    v_exp_f32 v35, v35
    v_exp_f32 v36, v36
    v_exp_f32 v37, v37
    v_exp_f32 v38, v38
    v_exp_f32 v39, v39
    v_exp_f32 v40, v40
    v_exp_f32 v41, v41
    v_pk_add_f32 v[34:35], v[34:35], s[72:73]
    v_pk_add_f32 v[36:37], v[36:37], s[72:73]
    v_pk_add_f32 v[38:39], v[38:39], s[72:73]
    v_pk_add_f32 v[40:41], v[40:41], s[72:73]
    v_rcp_f32 v34, v34
    v_rcp_f32 v35, v35
    v_rcp_f32 v36, v36
    v_rcp_f32 v37, v37
    v_rcp_f32 v38, v38
    v_rcp_f32 v39, v39
    v_rcp_f32 v40, v40
    v_rcp_f32 v41, v41
    v_pk_mul_f32 v[200:201], v[200:201], v[34:35]
    v_pk_mul_f32 v[202:203], v[202:203], v[36:37]
    v_pk_mul_f32 v[204:205], v[204:205], v[38:39]
    v_pk_mul_f32 v[206:207], v[206:207], v[40:41]
    v_pk_mul_f32 v[34:35], v[208:209], v[208:209]
    v_pk_mul_f32 v[36:37], v[210:211], v[210:211]
    v_pk_mul_f32 v[38:39], v[212:213], v[212:213]
    v_pk_mul_f32 v[40:41], v[214:215], v[214:215]
    v_pk_fma_f32 v[34:35], v[34:35], v[44:45], v[46:47]
    v_pk_fma_f32 v[36:37], v[36:37], v[44:45], v[46:47]
    v_pk_fma_f32 v[38:39], v[38:39], v[44:45], v[46:47]
    v_pk_fma_f32 v[40:41], v[40:41], v[44:45], v[46:47]
    v_pk_mul_f32 v[34:35], v[34:35], v[208:209]
    v_pk_mul_f32 v[36:37], v[36:37], v[210:211]
    v_pk_mul_f32 v[38:39], v[38:39], v[212:213]
    v_pk_mul_f32 v[40:41], v[40:41], v[214:215]
    v_exp_f32 v34, v34
    v_exp_f32 v35, v35
    v_exp_f32 v36, v36
    v_exp_f32 v37, v37
    v_exp_f32 v38, v38
    v_exp_f32 v39, v39
    v_exp_f32 v40, v40
    v_exp_f32 v41, v41
    v_pk_add_f32 v[34:35], v[34:35], s[72:73]
    v_pk_add_f32 v[36:37], v[36:37], s[72:73]
    v_pk_add_f32 v[38:39], v[38:39], s[72:73]
    v_pk_add_f32 v[40:41], v[40:41], s[72:73]
    v_rcp_f32 v34, v34
    v_rcp_f32 v35, v35
    v_rcp_f32 v36, v36
    v_rcp_f32 v37, v37
    v_rcp_f32 v38, v38
    v_rcp_f32 v39, v39
    v_rcp_f32 v40, v40
    v_rcp_f32 v41, v41
    v_pk_mul_f32 v[208:209], v[208:209], v[34:35]
    v_pk_mul_f32 v[210:211], v[210:211], v[36:37]
    v_pk_mul_f32 v[212:213], v[212:213], v[38:39]
    v_pk_mul_f32 v[214:215], v[214:215], v[40:41]
    v_pk_mul_f32 v[34:35], v[216:217], v[216:217]
    v_pk_mul_f32 v[36:37], v[218:219], v[218:219]
    v_pk_mul_f32 v[38:39], v[220:221], v[220:221]
    v_pk_mul_f32 v[40:41], v[222:223], v[222:223]
    v_pk_fma_f32 v[34:35], v[34:35], v[44:45], v[46:47]
    v_pk_fma_f32 v[36:37], v[36:37], v[44:45], v[46:47]
    v_pk_fma_f32 v[38:39], v[38:39], v[44:45], v[46:47]
    v_pk_fma_f32 v[40:41], v[40:41], v[44:45], v[46:47]
    v_pk_mul_f32 v[34:35], v[34:35], v[216:217]
    v_pk_mul_f32 v[36:37], v[36:37], v[218:219]
    v_pk_mul_f32 v[38:39], v[38:39], v[220:221]
    v_pk_mul_f32 v[40:41], v[40:41], v[222:223]
    v_exp_f32 v34, v34
    v_exp_f32 v35, v35
    v_exp_f32 v36, v36
    v_exp_f32 v37, v37
    v_exp_f32 v38, v38
    v_exp_f32 v39, v39
    v_exp_f32 v40, v40
    v_exp_f32 v41, v41
    v_pk_add_f32 v[34:35], v[34:35], s[72:73]
    v_pk_add_f32 v[36:37], v[36:37], s[72:73]
    v_pk_add_f32 v[38:39], v[38:39], s[72:73]
    v_pk_add_f32 v[40:41], v[40:41], s[72:73]
    v_rcp_f32 v34, v34
    v_rcp_f32 v35, v35
    v_rcp_f32 v36, v36
    v_rcp_f32 v37, v37
    v_rcp_f32 v38, v38
    v_rcp_f32 v39, v39
    v_rcp_f32 v40, v40
    v_rcp_f32 v41, v41
    v_pk_mul_f32 v[216:217], v[216:217], v[34:35]
    v_pk_mul_f32 v[218:219], v[218:219], v[36:37]
    v_pk_mul_f32 v[220:221], v[220:221], v[38:39]
    v_pk_mul_f32 v[222:223], v[222:223], v[40:41]
    v_pk_mul_f32 v[34:35], v[224:225], v[224:225]
    v_pk_mul_f32 v[36:37], v[226:227], v[226:227]
    v_pk_mul_f32 v[38:39], v[228:229], v[228:229]
    v_pk_mul_f32 v[40:41], v[230:231], v[230:231]
    v_pk_fma_f32 v[34:35], v[34:35], v[44:45], v[46:47]
    v_pk_fma_f32 v[36:37], v[36:37], v[44:45], v[46:47]
    v_pk_fma_f32 v[38:39], v[38:39], v[44:45], v[46:47]
    v_pk_fma_f32 v[40:41], v[40:41], v[44:45], v[46:47]
    v_pk_mul_f32 v[34:35], v[34:35], v[224:225]
    v_pk_mul_f32 v[36:37], v[36:37], v[226:227]
    v_pk_mul_f32 v[38:39], v[38:39], v[228:229]
    v_pk_mul_f32 v[40:41], v[40:41], v[230:231]
    v_exp_f32 v34, v34
    v_exp_f32 v35, v35
    v_exp_f32 v36, v36
    v_exp_f32 v37, v37
    v_exp_f32 v38, v38
    v_exp_f32 v39, v39
    v_exp_f32 v40, v40
    v_exp_f32 v41, v41
    v_pk_add_f32 v[34:35], v[34:35], s[72:73]
    v_pk_add_f32 v[36:37], v[36:37], s[72:73]
    v_pk_add_f32 v[38:39], v[38:39], s[72:73]
    v_pk_add_f32 v[40:41], v[40:41], s[72:73]
    v_rcp_f32 v34, v34
    v_rcp_f32 v35, v35
    v_rcp_f32 v36, v36
    v_rcp_f32 v37, v37
    v_rcp_f32 v38, v38
    v_rcp_f32 v39, v39
    v_rcp_f32 v40, v40
    v_rcp_f32 v41, v41
    v_pk_mul_f32 v[224:225], v[224:225], v[34:35]
    v_pk_mul_f32 v[226:227], v[226:227], v[36:37]
    v_pk_mul_f32 v[228:229], v[228:229], v[38:39]
    v_pk_mul_f32 v[230:231], v[230:231], v[40:41]
    s_cmp_lt_u32 s51, 16
    s_cbranch_scc1 L_s1_kernel_gstore
    v_pk_add_f32 v[34:35], v[120:121], v[122:123]
    v_pk_mul_f32 v[42:43], v[120:121], v[120:121]
    v_pk_add_f32 v[36:37], v[124:125], v[126:127]
    v_pk_mul_f32 v[44:45], v[124:125], v[124:125]
    v_pk_add_f32 v[38:39], v[128:129], v[130:131]
    v_pk_mul_f32 v[46:47], v[128:129], v[128:129]
    v_pk_add_f32 v[40:41], v[132:133], v[134:135]
    v_pk_mul_f32 v[48:49], v[132:133], v[132:133]
    v_pk_fma_f32 v[42:43], v[122:123], v[122:123], v[42:43]
    v_pk_fma_f32 v[44:45], v[126:127], v[126:127], v[44:45]
    v_pk_fma_f32 v[46:47], v[130:131], v[130:131], v[46:47]
    v_pk_fma_f32 v[48:49], v[134:135], v[134:135], v[48:49]
    v_pk_add_f32 v[34:35], v[34:35], v[136:137]
    v_pk_fma_f32 v[42:43], v[136:137], v[136:137], v[42:43]
    v_pk_add_f32 v[36:37], v[36:37], v[140:141]
    v_pk_fma_f32 v[44:45], v[140:141], v[140:141], v[44:45]
    v_pk_add_f32 v[38:39], v[38:39], v[144:145]
    v_pk_fma_f32 v[46:47], v[144:145], v[144:145], v[46:47]
    v_pk_add_f32 v[40:41], v[40:41], v[148:149]
    v_pk_fma_f32 v[48:49], v[148:149], v[148:149], v[48:49]
    v_pk_add_f32 v[34:35], v[34:35], v[138:139]
    v_pk_fma_f32 v[42:43], v[138:139], v[138:139], v[42:43]
    v_pk_add_f32 v[36:37], v[36:37], v[142:143]
    v_pk_fma_f32 v[44:45], v[142:143], v[142:143], v[44:45]
    v_pk_add_f32 v[38:39], v[38:39], v[146:147]
    v_pk_fma_f32 v[46:47], v[146:147], v[146:147], v[46:47]
    v_pk_add_f32 v[40:41], v[40:41], v[150:151]
    v_pk_fma_f32 v[48:49], v[150:151], v[150:151], v[48:49]
    v_pk_add_f32 v[34:35], v[34:35], v[152:153]
    v_pk_fma_f32 v[42:43], v[152:153], v[152:153], v[42:43]
    v_pk_add_f32 v[36:37], v[36:37], v[156:157]
    v_pk_fma_f32 v[44:45], v[156:157], v[156:157], v[44:45]
    v_pk_add_f32 v[38:39], v[38:39], v[160:161]
    v_pk_fma_f32 v[46:47], v[160:161], v[160:161], v[46:47]
    v_pk_add_f32 v[40:41], v[40:41], v[164:165]
    v_pk_fma_f32 v[48:49], v[164:165], v[164:165], v[48:49]
    v_pk_add_f32 v[34:35], v[34:35], v[154:155]
    v_pk_fma_f32 v[42:43], v[154:155], v[154:155], v[42:43]
    v_pk_add_f32 v[36:37], v[36:37], v[158:159]
    v_pk_fma_f32 v[44:45], v[158:159], v[158:159], v[44:45]
    v_pk_add_f32 v[38:39], v[38:39], v[162:163]
    v_pk_fma_f32 v[46:47], v[162:163], v[162:163], v[46:47]
    v_pk_add_f32 v[40:41], v[40:41], v[166:167]
    v_pk_fma_f32 v[48:49], v[166:167], v[166:167], v[48:49]
    v_pk_add_f32 v[34:35], v[34:35], v[168:169]
    v_pk_fma_f32 v[42:43], v[168:169], v[168:169], v[42:43]
    v_pk_add_f32 v[36:37], v[36:37], v[172:173]
    v_pk_fma_f32 v[44:45], v[172:173], v[172:173], v[44:45]
    v_pk_add_f32 v[38:39], v[38:39], v[176:177]
    v_pk_fma_f32 v[46:47], v[176:177], v[176:177], v[46:47]
    v_pk_add_f32 v[40:41], v[40:41], v[180:181]
    v_pk_fma_f32 v[48:49], v[180:181], v[180:181], v[48:49]
    v_pk_add_f32 v[34:35], v[34:35], v[170:171]
    v_pk_fma_f32 v[42:43], v[170:171], v[170:171], v[42:43]
    v_pk_add_f32 v[36:37], v[36:37], v[174:175]
    v_pk_fma_f32 v[44:45], v[174:175], v[174:175], v[44:45]
    v_pk_add_f32 v[38:39], v[38:39], v[178:179]
    v_pk_fma_f32 v[46:47], v[178:179], v[178:179], v[46:47]
    v_pk_add_f32 v[40:41], v[40:41], v[182:183]
    v_pk_fma_f32 v[48:49], v[182:183], v[182:183], v[48:49]
    v_pk_add_f32 v[34:35], v[34:35], v[184:185]
    v_pk_fma_f32 v[42:43], v[184:185], v[184:185], v[42:43]
    v_pk_add_f32 v[36:37], v[36:37], v[188:189]
    v_pk_fma_f32 v[44:45], v[188:189], v[188:189], v[44:45]
    v_pk_add_f32 v[38:39], v[38:39], v[192:193]
    v_pk_fma_f32 v[46:47], v[192:193], v[192:193], v[46:47]
    v_pk_add_f32 v[40:41], v[40:41], v[196:197]
    v_pk_fma_f32 v[48:49], v[196:197], v[196:197], v[48:49]
    v_pk_add_f32 v[34:35], v[34:35], v[186:187]
    v_pk_fma_f32 v[42:43], v[186:187], v[186:187], v[42:43]
    v_pk_add_f32 v[36:37], v[36:37], v[190:191]
    v_pk_fma_f32 v[44:45], v[190:191], v[190:191], v[44:45]
    v_pk_add_f32 v[38:39], v[38:39], v[194:195]
    v_pk_fma_f32 v[46:47], v[194:195], v[194:195], v[46:47]
    v_pk_add_f32 v[40:41], v[40:41], v[198:199]
    v_pk_fma_f32 v[48:49], v[198:199], v[198:199], v[48:49]
    v_pk_add_f32 v[34:35], v[34:35], v[200:201]
    v_pk_fma_f32 v[42:43], v[200:201], v[200:201], v[42:43]
    v_pk_add_f32 v[36:37], v[36:37], v[204:205]
    v_pk_fma_f32 v[44:45], v[204:205], v[204:205], v[44:45]
    v_pk_add_f32 v[38:39], v[38:39], v[208:209]
    v_pk_fma_f32 v[46:47], v[208:209], v[208:209], v[46:47]
    v_pk_add_f32 v[40:41], v[40:41], v[212:213]
    v_pk_fma_f32 v[48:49], v[212:213], v[212:213], v[48:49]
    v_pk_add_f32 v[34:35], v[34:35], v[202:203]
    v_pk_fma_f32 v[42:43], v[202:203], v[202:203], v[42:43]
    v_pk_add_f32 v[36:37], v[36:37], v[206:207]
    v_pk_fma_f32 v[44:45], v[206:207], v[206:207], v[44:45]
    v_pk_add_f32 v[38:39], v[38:39], v[210:211]
    v_pk_fma_f32 v[46:47], v[210:211], v[210:211], v[46:47]
    v_pk_add_f32 v[40:41], v[40:41], v[214:215]
    v_pk_fma_f32 v[48:49], v[214:215], v[214:215], v[48:49]
    v_pk_add_f32 v[34:35], v[34:35], v[216:217]
    v_pk_fma_f32 v[42:43], v[216:217], v[216:217], v[42:43]
    v_pk_add_f32 v[36:37], v[36:37], v[220:221]
    v_pk_fma_f32 v[44:45], v[220:221], v[220:221], v[44:45]
    v_pk_add_f32 v[38:39], v[38:39], v[224:225]
    v_pk_fma_f32 v[46:47], v[224:225], v[224:225], v[46:47]
    v_pk_add_f32 v[40:41], v[40:41], v[228:229]
    v_pk_fma_f32 v[48:49], v[228:229], v[228:229], v[48:49]
    v_pk_add_f32 v[34:35], v[34:35], v[218:219]
    v_pk_fma_f32 v[42:43], v[218:219], v[218:219], v[42:43]
    v_pk_add_f32 v[36:37], v[36:37], v[222:223]
    v_pk_fma_f32 v[44:45], v[222:223], v[222:223], v[44:45]
    v_pk_add_f32 v[38:39], v[38:39], v[226:227]
    v_pk_fma_f32 v[46:47], v[226:227], v[226:227], v[46:47]
    v_pk_add_f32 v[40:41], v[40:41], v[230:231]
    v_pk_fma_f32 v[48:49], v[230:231], v[230:231], v[48:49]
    v_add_f32 v34, v34, v35
    v_add_f32 v42, v42, v43
    v_add_f32 v36, v36, v37
    v_add_f32 v44, v44, v45
    v_add_f32 v38, v38, v39
    v_add_f32 v46, v46, v47
    v_add_f32 v40, v40, v41
    v_add_f32 v48, v48, v49
    v_permlane16_swap_b32 v34, v36
    v_permlane16_swap_b32 v38, v40
    v_add_f32 v34, v34, v36
    v_add_f32 v38, v38, v40
    s_nop 1
    v_permlane32_swap_b32 v34, v38
    v_add_f32 v34, v34, v38
    v_permlane16_swap_b32 v42, v44
    v_permlane16_swap_b32 v46, v48
    v_add_f32 v42, v42, v44
    v_add_f32 v46, v46, v48
    s_nop 1
    v_permlane32_swap_b32 v42, v46
    v_add_f32 v42, v42, v46
    v_mov_b32 v35, v42
    v_lshlrev_b32 v5, 3, v1
    s_waitcnt vmcnt(0)
    buffer_store_dwordx2 v[34:35], v5, s[36:39], s3 offen sc1
    s_setprio 0
    s_mov_b32 s67, 0
    s_lshl_b32 s69, s50, 5
L_s1_kernel_c1chk:
    v_readfirstlane_b32 s68, v28
    s_add_u32 s67, s67, 1
    s_cmp_ge_u32 s67, 400000
    s_cbranch_scc1 L_s1_kernel_c1ok
    s_cmp_ge_u32 s68, 16
    s_cbranch_scc1 L_s1_kernel_c1ok
    s_sleep 2
    buffer_load_dword v28, v24, s[40:43], s69 offen sc1
    s_waitcnt vmcnt(0)
    s_branch L_s1_kernel_c1chk
L_s1_kernel_c1ok:
    s_lshl_b32 s68, s50, 15
    s_lshl_b32 s69, s49, 9
    s_add_u32 s68, s68, s69
    s_add_u32 s69, s68, 33554432
    v_lshlrev_b32 v5, 3, v1
    s_mov_b32 s64, 0xffff
    s_mov_b32 s67, 0
L_s1_kernel_lnround:
    s_bitcmp1_b32 s64, 0
    s_cbranch_scc0 L_s1_kernel_lnl0
    s_add_u32 s68, s69, 0
    buffer_load_dwordx2 v[34:35], v5, s[36:39], s68 offen sc1
L_s1_kernel_lnl0:
    s_bitcmp1_b32 s64, 1
    s_cbranch_scc0 L_s1_kernel_lnl1
    s_add_u32 s68, s69, 2048
    buffer_load_dwordx2 v[36:37], v5, s[36:39], s68 offen sc1
L_s1_kernel_lnl1:
    s_bitcmp1_b32 s64, 2
    s_cbranch_scc0 L_s1_kernel_lnl2
    s_add_u32 s68, s69, 4096
    buffer_load_dwordx2 v[38:39], v5, s[36:39], s68 offen sc1
L_s1_kernel_lnl2:
    s_bitcmp1_b32 s64, 3
    s_cbranch_scc0 L_s1_kernel_lnl3
    s_add_u32 s68, s69, 6144
    buffer_load_dwordx2 v[40:41], v5, s[36:39], s68 offen sc1
L_s1_kernel_lnl3:
    s_bitcmp1_b32 s64, 4
    s_cbranch_scc0 L_s1_kernel_lnl4
    s_add_u32 s68, s69, 8192
    buffer_load_dwordx2 v[42:43], v5, s[36:39], s68 offen sc1
L_s1_kernel_lnl4:
    s_bitcmp1_b32 s64, 5
    s_cbranch_scc0 L_s1_kernel_lnl5
    s_add_u32 s68, s69, 10240
    buffer_load_dwordx2 v[44:45], v5, s[36:39], s68 offen sc1
L_s1_kernel_lnl5:
    s_bitcmp1_b32 s64, 6
    s_cbranch_scc0 L_s1_kernel_lnl6
    s_add_u32 s68, s69, 12288
    buffer_load_dwordx2 v[46:47], v5, s[36:39], s68 offen sc1
L_s1_kernel_lnl6:
    s_bitcmp1_b32 s64, 7
    s_cbranch_scc0 L_s1_kernel_lnl7
    s_add_u32 s68, s69, 14336
    buffer_load_dwordx2 v[48:49], v5, s[36:39], s68 offen sc1
L_s1_kernel_lnl7:
    s_bitcmp1_b32 s64, 8
    s_cbranch_scc0 L_s1_kernel_lnl8
    s_add_u32 s68, s69, 16384
    buffer_load_dwordx2 v[50:51], v5, s[36:39], s68 offen sc1
L_s1_kernel_lnl8:
    s_bitcmp1_b32 s64, 9
    s_cbranch_scc0 L_s1_kernel_lnl9
    s_add_u32 s68, s69, 18432
    buffer_load_dwordx2 v[52:53], v5, s[36:39], s68 offen sc1
L_s1_kernel_lnl9:
    s_bitcmp1_b32 s64, 10
    s_cbranch_scc0 L_s1_kernel_lnl10
    s_add_u32 s68, s69, 20480
    buffer_load_dwordx2 v[54:55], v5, s[36:39], s68 offen sc1
L_s1_kernel_lnl10:
    s_bitcmp1_b32 s64, 11
    s_cbranch_scc0 L_s1_kernel_lnl11
    s_add_u32 s68, s69, 22528
    buffer_load_dwordx2 v[56:57], v5, s[36:39], s68 offen sc1
L_s1_kernel_lnl11:
    s_bitcmp1_b32 s64, 12
    s_cbranch_scc0 L_s1_kernel_lnl12
    s_add_u32 s68, s69, 24576
    buffer_load_dwordx2 v[58:59], v5, s[36:39], s68 offen sc1
L_s1_kernel_lnl12:
    s_bitcmp1_b32 s64, 13
    s_cbranch_scc0 L_s1_kernel_lnl13
    s_add_u32 s68, s69, 26624
    buffer_load_dwordx2 v[60:61], v5, s[36:39], s68 offen sc1
L_s1_kernel_lnl13:
    s_bitcmp1_b32 s64, 14
    s_cbranch_scc0 L_s1_kernel_lnl14
    s_add_u32 s68, s69, 28672
    buffer_load_dwordx2 v[62:63], v5, s[36:39], s68 offen sc1
L_s1_kernel_lnl14:
    s_bitcmp1_b32 s64, 15
    s_cbranch_scc0 L_s1_kernel_lnl15
    s_add_u32 s68, s69, 30720
    buffer_load_dwordx2 v[64:65], v5, s[36:39], s68 offen sc1
L_s1_kernel_lnl15:
    s_waitcnt vmcnt(0)
    v_min3_f32 v2, v35, v37, v39
    v_min3_f32 v2, v2, v41, v43
    v_min3_f32 v2, v2, v45, v47
    v_min3_f32 v2, v2, v49, v51
    v_min3_f32 v2, v2, v53, v55
    v_min3_f32 v2, v2, v57, v59
    v_min3_f32 v2, v2, v61, v63
    v_min_f32 v2, v2, v65
    v_cmp_gt_f32 vcc, 0, v2
    s_add_u32 s67, s67, 1
    s_cmp_ge_u32 s67, 400000
    s_cbranch_scc1 L_s1_kernel_lngo
    s_cmp_eq_u64 vcc, 0
    s_cbranch_scc1 L_s1_kernel_lngo
    s_setprio 0
    s_mov_b32 s64, 0
    v_cmp_gt_f32 vcc, 0, v35
    s_nop 0
    s_cmp_lg_u64 vcc, 0
    s_cselect_b32 s68, 1, 0
    s_or_b32 s64, s64, s68
    v_cmp_gt_f32 vcc, 0, v37
    s_nop 0
    s_cmp_lg_u64 vcc, 0
    s_cselect_b32 s68, 2, 0
    s_or_b32 s64, s64, s68
    v_cmp_gt_f32 vcc, 0, v39
    s_nop 0
    s_cmp_lg_u64 vcc, 0
    s_cselect_b32 s68, 4, 0
    s_or_b32 s64, s64, s68
    v_cmp_gt_f32 vcc, 0, v41
    s_nop 0
    s_cmp_lg_u64 vcc, 0
    s_cselect_b32 s68, 8, 0
    s_or_b32 s64, s64, s68
    v_cmp_gt_f32 vcc, 0, v43
    s_nop 0
    s_cmp_lg_u64 vcc, 0
    s_cselect_b32 s68, 16, 0
    s_or_b32 s64, s64, s68
    v_cmp_gt_f32 vcc, 0, v45
    s_nop 0
    s_cmp_lg_u64 vcc, 0
    s_cselect_b32 s68, 32, 0
    s_or_b32 s64, s64, s68
    v_cmp_gt_f32 vcc, 0, v47
    s_nop 0
    s_cmp_lg_u64 vcc, 0
    s_cselect_b32 s68, 64, 0
    s_or_b32 s64, s64, s68
    v_cmp_gt_f32 vcc, 0, v49
    s_nop 0
    s_cmp_lg_u64 vcc, 0
    s_cselect_b32 s68, 128, 0
    s_or_b32 s64, s64, s68
    v_cmp_gt_f32 vcc, 0, v51
    s_nop 0
    s_cmp_lg_u64 vcc, 0
    s_cselect_b32 s68, 256, 0
    s_or_b32 s64, s64, s68
    v_cmp_gt_f32 vcc, 0, v53
    s_nop 0
    s_cmp_lg_u64 vcc, 0
    s_cselect_b32 s68, 512, 0
    s_or_b32 s64, s64, s68
    v_cmp_gt_f32 vcc, 0, v55
    s_nop 0
    s_cmp_lg_u64 vcc, 0
    s_cselect_b32 s68, 1024, 0
    s_or_b32 s64, s64, s68
    v_cmp_gt_f32 vcc, 0, v57
    s_nop 0
    s_cmp_lg_u64 vcc, 0
    s_cselect_b32 s68, 2048, 0
    s_or_b32 s64, s64, s68
    v_cmp_gt_f32 vcc, 0, v59
    s_nop 0
    s_cmp_lg_u64 vcc, 0
    s_cselect_b32 s68, 4096, 0
    s_or_b32 s64, s64, s68
    v_cmp_gt_f32 vcc, 0, v61
    s_nop 0
    s_cmp_lg_u64 vcc, 0
    s_cselect_b32 s68, 8192, 0
    s_or_b32 s64, s64, s68
    v_cmp_gt_f32 vcc, 0, v63
    s_nop 0
    s_cmp_lg_u64 vcc, 0
    s_cselect_b32 s68, 16384, 0
    s_or_b32 s64, s64, s68
    v_cmp_gt_f32 vcc, 0, v65
    s_nop 0
    s_cmp_lg_u64 vcc, 0
    s_cselect_b32 s68, 32768, 0
    s_or_b32 s64, s64, s68
    s_branch L_s1_kernel_lnround
L_s1_kernel_lngo:
    s_setprio 2
    v_pk_add_f32 v[34:35], v[34:35], v[50:51]
    v_pk_add_f32 v[36:37], v[36:37], v[52:53]
    v_pk_add_f32 v[38:39], v[38:39], v[54:55]
    v_pk_add_f32 v[40:41], v[40:41], v[56:57]
    v_pk_add_f32 v[42:43], v[42:43], v[58:59]
    v_pk_add_f32 v[44:45], v[44:45], v[60:61]
    v_pk_add_f32 v[46:47], v[46:47], v[62:63]
    v_pk_add_f32 v[48:49], v[48:49], v[64:65]
    v_pk_add_f32 v[34:35], v[34:35], v[42:43]
    v_pk_add_f32 v[36:37], v[36:37], v[44:45]
    v_pk_add_f32 v[38:39], v[38:39], v[46:47]
    v_pk_add_f32 v[40:41], v[40:41], v[48:49]
    v_pk_add_f32 v[34:35], v[34:35], v[38:39]
    v_pk_add_f32 v[36:37], v[36:37], v[40:41]
    v_pk_add_f32 v[34:35], v[34:35], v[36:37]
    v_mul_f32 v34, 0x3a124925, v34
    v_mul_f32 v35, 0x3a124925, v35
    v_fma_f32 v36, -v34, v34, v35
    v_max_f32 v36, 0, v36
    v_add_f32 v36, 0x3727c5ac, v36
    v_rsq_f32 v36, v36
    s_nop 0
    v_mul_f32 v37, v34, v36
    v_sub_f32 v37, 0, v37
    v_and_b32 v2, 15, v1
    v_lshlrev_b32 v2, 2, v2
    v_add_u32 v3, 0, v2
    ds_bpermute_b32 v40, v3, v36
    ds_bpermute_b32 v41, v3, v37
    v_add_u32 v3, 64, v2
    ds_bpermute_b32 v42, v3, v36
    ds_bpermute_b32 v43, v3, v37
    v_add_u32 v3, 128, v2
    ds_bpermute_b32 v44, v3, v36
    ds_bpermute_b32 v45, v3, v37
    v_add_u32 v3, 192, v2
    ds_bpermute_b32 v46, v3, v36
    ds_bpermute_b32 v47, v3, v37
    s_waitcnt lgkmcnt(0)
    v_mov_b32 v48, v40
    v_mov_b32 v49, v40
    v_mov_b32 v50, v41
    v_mov_b32 v51, v41
    v_mov_b32 v52, v42
    v_mov_b32 v53, v42
    v_mov_b32 v54, v43
    v_mov_b32 v55, v43
    v_mov_b32 v56, v44
    v_mov_b32 v57, v44
    v_mov_b32 v58, v45
    v_mov_b32 v59, v45
    v_mov_b32 v60, v46
    v_mov_b32 v61, v46
    v_mov_b32 v62, v47
    v_mov_b32 v63, v47
    s_lshl_b32 s68, s50, 3
    s_lshl_b32 s69, s49, 1
    s_add_u32 s68, s68, s69
    s_mul_i32 s68, s68, 112
    s_and_b32 s69, s51, 15
    s_mul_i32 s69, s69, 7
    s_add_u32 s68, s68, s69
    s_lshl_b32 s68, s68, 10
    s_add_u32 s68, s68, 23068672
    v_pk_fma_f32 v[120:121], v[120:121], v[48:49], v[50:51]
    v_pk_fma_f32 v[122:123], v[122:123], v[48:49], v[50:51]
    v_pk_fma_f32 v[124:125], v[124:125], v[52:53], v[54:55]
    v_pk_fma_f32 v[126:127], v[126:127], v[52:53], v[54:55]
    v_cvt_pk_bf16_f32 v64, v120, v121
    v_cvt_pk_bf16_f32 v65, v122, v123
    v_cvt_pk_bf16_f32 v66, v124, v125
    v_cvt_pk_bf16_f32 v67, v126, v127
    buffer_store_dwordx4 v[64:67], v22, s[36:39], s68 offen offset:0 sc1
    v_pk_fma_f32 v[136:137], v[136:137], v[48:49], v[50:51]
    v_pk_fma_f32 v[138:139], v[138:139], v[48:49], v[50:51]
    v_pk_fma_f32 v[140:141], v[140:141], v[52:53], v[54:55]
    v_pk_fma_f32 v[142:143], v[142:143], v[52:53], v[54:55]
    v_cvt_pk_bf16_f32 v68, v136, v137
    v_cvt_pk_bf16_f32 v69, v138, v139
    v_cvt_pk_bf16_f32 v70, v140, v141
    v_cvt_pk_bf16_f32 v71, v142, v143
    buffer_store_dwordx4 v[68:71], v22, s[36:39], s68 offen offset:1024 sc1
    v_pk_fma_f32 v[152:153], v[152:153], v[48:49], v[50:51]
    v_pk_fma_f32 v[154:155], v[154:155], v[48:49], v[50:51]
    v_pk_fma_f32 v[156:157], v[156:157], v[52:53], v[54:55]
    v_pk_fma_f32 v[158:159], v[158:159], v[52:53], v[54:55]
    v_cvt_pk_bf16_f32 v72, v152, v153
    v_cvt_pk_bf16_f32 v73, v154, v155
    v_cvt_pk_bf16_f32 v74, v156, v157
    v_cvt_pk_bf16_f32 v75, v158, v159
    buffer_store_dwordx4 v[72:75], v22, s[36:39], s68 offen offset:2048 sc1
    v_pk_fma_f32 v[168:169], v[168:169], v[48:49], v[50:51]
    v_pk_fma_f32 v[170:171], v[170:171], v[48:49], v[50:51]
    v_pk_fma_f32 v[172:173], v[172:173], v[52:53], v[54:55]
    v_pk_fma_f32 v[174:175], v[174:175], v[52:53], v[54:55]
    v_cvt_pk_bf16_f32 v76, v168, v169
    v_cvt_pk_bf16_f32 v77, v170, v171
    v_cvt_pk_bf16_f32 v78, v172, v173
    v_cvt_pk_bf16_f32 v79, v174, v175
    buffer_store_dwordx4 v[76:79], v22, s[36:39], s68 offen offset:3072 sc1
    s_add_u32 s68, s68, 4096
    v_pk_fma_f32 v[184:185], v[184:185], v[48:49], v[50:51]
    v_pk_fma_f32 v[186:187], v[186:187], v[48:49], v[50:51]
    v_pk_fma_f32 v[188:189], v[188:189], v[52:53], v[54:55]
    v_pk_fma_f32 v[190:191], v[190:191], v[52:53], v[54:55]
    v_cvt_pk_bf16_f32 v80, v184, v185
    v_cvt_pk_bf16_f32 v81, v186, v187
    v_cvt_pk_bf16_f32 v82, v188, v189
    v_cvt_pk_bf16_f32 v83, v190, v191
    buffer_store_dwordx4 v[80:83], v22, s[36:39], s68 offen offset:0 sc1
    v_pk_fma_f32 v[200:201], v[200:201], v[48:49], v[50:51]
    v_pk_fma_f32 v[202:203], v[202:203], v[48:49], v[50:51]
    v_pk_fma_f32 v[204:205], v[204:205], v[52:53], v[54:55]
    v_pk_fma_f32 v[206:207], v[206:207], v[52:53], v[54:55]
    v_cvt_pk_bf16_f32 v84, v200, v201
    v_cvt_pk_bf16_f32 v85, v202, v203
    v_cvt_pk_bf16_f32 v86, v204, v205
    v_cvt_pk_bf16_f32 v87, v206, v207
    buffer_store_dwordx4 v[84:87], v22, s[36:39], s68 offen offset:1024 sc1
    v_pk_fma_f32 v[216:217], v[216:217], v[48:49], v[50:51]
    v_pk_fma_f32 v[218:219], v[218:219], v[48:49], v[50:51]
    v_pk_fma_f32 v[220:221], v[220:221], v[52:53], v[54:55]
    v_pk_fma_f32 v[222:223], v[222:223], v[52:53], v[54:55]
    v_cvt_pk_bf16_f32 v88, v216, v217
    v_cvt_pk_bf16_f32 v89, v218, v219
    v_cvt_pk_bf16_f32 v90, v220, v221
    v_cvt_pk_bf16_f32 v91, v222, v223
    buffer_store_dwordx4 v[88:91], v22, s[36:39], s68 offen offset:2048 sc1
    s_add_u32 s68, s68, 110592
    v_pk_fma_f32 v[128:129], v[128:129], v[56:57], v[58:59]
    v_pk_fma_f32 v[130:131], v[130:131], v[56:57], v[58:59]
    v_pk_fma_f32 v[132:133], v[132:133], v[60:61], v[62:63]
    v_pk_fma_f32 v[134:135], v[134:135], v[60:61], v[62:63]
    v_cvt_pk_bf16_f32 v92, v128, v129
    v_cvt_pk_bf16_f32 v93, v130, v131
    v_cvt_pk_bf16_f32 v94, v132, v133
    v_cvt_pk_bf16_f32 v95, v134, v135
    buffer_store_dwordx4 v[92:95], v22, s[36:39], s68 offen offset:0 sc1
    v_pk_fma_f32 v[144:145], v[144:145], v[56:57], v[58:59]
    v_pk_fma_f32 v[146:147], v[146:147], v[56:57], v[58:59]
    v_pk_fma_f32 v[148:149], v[148:149], v[60:61], v[62:63]
    v_pk_fma_f32 v[150:151], v[150:151], v[60:61], v[62:63]
    v_cvt_pk_bf16_f32 v64, v144, v145
    v_cvt_pk_bf16_f32 v65, v146, v147
    v_cvt_pk_bf16_f32 v66, v148, v149
    v_cvt_pk_bf16_f32 v67, v150, v151
    buffer_store_dwordx4 v[64:67], v22, s[36:39], s68 offen offset:1024 sc1
    v_pk_fma_f32 v[160:161], v[160:161], v[56:57], v[58:59]
    v_pk_fma_f32 v[162:163], v[162:163], v[56:57], v[58:59]
    v_pk_fma_f32 v[164:165], v[164:165], v[60:61], v[62:63]
    v_pk_fma_f32 v[166:167], v[166:167], v[60:61], v[62:63]
    v_cvt_pk_bf16_f32 v68, v160, v161
    v_cvt_pk_bf16_f32 v69, v162, v163
    v_cvt_pk_bf16_f32 v70, v164, v165
    v_cvt_pk_bf16_f32 v71, v166, v167
    buffer_store_dwordx4 v[68:71], v22, s[36:39], s68 offen offset:2048 sc1
    v_pk_fma_f32 v[176:177], v[176:177], v[56:57], v[58:59]
    v_pk_fma_f32 v[178:179], v[178:179], v[56:57], v[58:59]
    v_pk_fma_f32 v[180:181], v[180:181], v[60:61], v[62:63]
    v_pk_fma_f32 v[182:183], v[182:183], v[60:61], v[62:63]
    v_cvt_pk_bf16_f32 v72, v176, v177
    v_cvt_pk_bf16_f32 v73, v178, v179
    v_cvt_pk_bf16_f32 v74, v180, v181
    v_cvt_pk_bf16_f32 v75, v182, v183
    buffer_store_dwordx4 v[72:75], v22, s[36:39], s68 offen offset:3072 sc1
    s_add_u32 s68, s68, 4096
    v_pk_fma_f32 v[192:193], v[192:193], v[56:57], v[58:59]
    v_pk_fma_f32 v[194:195], v[194:195], v[56:57], v[58:59]
    v_pk_fma_f32 v[196:197], v[196:197], v[60:61], v[62:63]
    v_pk_fma_f32 v[198:199], v[198:199], v[60:61], v[62:63]
    v_cvt_pk_bf16_f32 v76, v192, v193
    v_cvt_pk_bf16_f32 v77, v194, v195
    v_cvt_pk_bf16_f32 v78, v196, v197
    v_cvt_pk_bf16_f32 v79, v198, v199
    buffer_store_dwordx4 v[76:79], v22, s[36:39], s68 offen offset:0 sc1
    v_pk_fma_f32 v[208:209], v[208:209], v[56:57], v[58:59]
    v_pk_fma_f32 v[210:211], v[210:211], v[56:57], v[58:59]
    v_pk_fma_f32 v[212:213], v[212:213], v[60:61], v[62:63]
    v_pk_fma_f32 v[214:215], v[214:215], v[60:61], v[62:63]
    v_cvt_pk_bf16_f32 v80, v208, v209
    v_cvt_pk_bf16_f32 v81, v210, v211
    v_cvt_pk_bf16_f32 v82, v212, v213
    v_cvt_pk_bf16_f32 v83, v214, v215
    buffer_store_dwordx4 v[80:83], v22, s[36:39], s68 offen offset:1024 sc1
    v_pk_fma_f32 v[224:225], v[224:225], v[56:57], v[58:59]
    v_pk_fma_f32 v[226:227], v[226:227], v[56:57], v[58:59]
    v_pk_fma_f32 v[228:229], v[228:229], v[60:61], v[62:63]
    v_pk_fma_f32 v[230:231], v[230:231], v[60:61], v[62:63]
    v_cvt_pk_bf16_f32 v84, v224, v225
    v_cvt_pk_bf16_f32 v85, v226, v227
    v_cvt_pk_bf16_f32 v86, v228, v229
    v_cvt_pk_bf16_f32 v87, v230, v231
    buffer_store_dwordx4 v[84:87], v22, s[36:39], s68 offen offset:2048 sc1
    s_add_u32 s68, s68, 110592
    s_branch L_s1_kernel_fin
L_s1_kernel_gstore:
    s_lshl_b32 s68, s50, 3
    s_lshl_b32 s69, s49, 1
    s_add_u32 s68, s68, s69
    s_mul_i32 s68, s68, 112
    s_and_b32 s69, s51, 15
    s_mul_i32 s69, s69, 7
    s_add_u32 s68, s68, s69
    s_lshl_b32 s68, s68, 10
    s_cmp_lt_u32 s51, 16
    s_cselect_b32 s69, 0, 7340032
    s_add_u32 s68, s68, s69
    s_add_u32 s68, s68, 15728640
    v_cvt_pk_bf16_f32 v32, v120, v121
    v_cvt_pk_bf16_f32 v33, v122, v123
    v_cvt_pk_bf16_f32 v34, v124, v125
    v_cvt_pk_bf16_f32 v35, v126, v127
    buffer_store_dwordx4 v[32:35], v22, s[36:39], s68 offen offset:0 sc1
    v_cvt_pk_bf16_f32 v36, v136, v137
    v_cvt_pk_bf16_f32 v37, v138, v139
    v_cvt_pk_bf16_f32 v38, v140, v141
    v_cvt_pk_bf16_f32 v39, v142, v143
    buffer_store_dwordx4 v[36:39], v22, s[36:39], s68 offen offset:1024 sc1
    v_cvt_pk_bf16_f32 v40, v152, v153
    v_cvt_pk_bf16_f32 v41, v154, v155
    v_cvt_pk_bf16_f32 v42, v156, v157
    v_cvt_pk_bf16_f32 v43, v158, v159
    buffer_store_dwordx4 v[40:43], v22, s[36:39], s68 offen offset:2048 sc1
    v_cvt_pk_bf16_f32 v44, v168, v169
    v_cvt_pk_bf16_f32 v45, v170, v171
    v_cvt_pk_bf16_f32 v46, v172, v173
    v_cvt_pk_bf16_f32 v47, v174, v175
    buffer_store_dwordx4 v[44:47], v22, s[36:39], s68 offen offset:3072 sc1
    s_add_u32 s68, s68, 4096
    v_cvt_pk_bf16_f32 v48, v184, v185
    v_cvt_pk_bf16_f32 v49, v186, v187
    v_cvt_pk_bf16_f32 v50, v188, v189
    v_cvt_pk_bf16_f32 v51, v190, v191
    buffer_store_dwordx4 v[48:51], v22, s[36:39], s68 offen offset:0 sc1
    v_cvt_pk_bf16_f32 v52, v200, v201
    v_cvt_pk_bf16_f32 v53, v202, v203
    v_cvt_pk_bf16_f32 v54, v204, v205
    v_cvt_pk_bf16_f32 v55, v206, v207
    buffer_store_dwordx4 v[52:55], v22, s[36:39], s68 offen offset:1024 sc1
    v_cvt_pk_bf16_f32 v56, v216, v217
    v_cvt_pk_bf16_f32 v57, v218, v219
    v_cvt_pk_bf16_f32 v58, v220, v221
    v_cvt_pk_bf16_f32 v59, v222, v223
    buffer_store_dwordx4 v[56:59], v22, s[36:39], s68 offen offset:2048 sc1
    s_add_u32 s68, s68, 110592
    v_cvt_pk_bf16_f32 v60, v128, v129
    v_cvt_pk_bf16_f32 v61, v130, v131
    v_cvt_pk_bf16_f32 v62, v132, v133
    v_cvt_pk_bf16_f32 v63, v134, v135
    buffer_store_dwordx4 v[60:63], v22, s[36:39], s68 offen offset:0 sc1
    v_cvt_pk_bf16_f32 v32, v144, v145
    v_cvt_pk_bf16_f32 v33, v146, v147
    v_cvt_pk_bf16_f32 v34, v148, v149
    v_cvt_pk_bf16_f32 v35, v150, v151
    buffer_store_dwordx4 v[32:35], v22, s[36:39], s68 offen offset:1024 sc1
    v_cvt_pk_bf16_f32 v36, v160, v161
    v_cvt_pk_bf16_f32 v37, v162, v163
    v_cvt_pk_bf16_f32 v38, v164, v165
    v_cvt_pk_bf16_f32 v39, v166, v167
    buffer_store_dwordx4 v[36:39], v22, s[36:39], s68 offen offset:2048 sc1
    v_cvt_pk_bf16_f32 v40, v176, v177
    v_cvt_pk_bf16_f32 v41, v178, v179
    v_cvt_pk_bf16_f32 v42, v180, v181
    v_cvt_pk_bf16_f32 v43, v182, v183
    buffer_store_dwordx4 v[40:43], v22, s[36:39], s68 offen offset:3072 sc1
    s_add_u32 s68, s68, 4096
    v_cvt_pk_bf16_f32 v44, v192, v193
    v_cvt_pk_bf16_f32 v45, v194, v195
    v_cvt_pk_bf16_f32 v46, v196, v197
    v_cvt_pk_bf16_f32 v47, v198, v199
    buffer_store_dwordx4 v[44:47], v22, s[36:39], s68 offen offset:0 sc1
    v_cvt_pk_bf16_f32 v48, v208, v209
    v_cvt_pk_bf16_f32 v49, v210, v211
    v_cvt_pk_bf16_f32 v50, v212, v213
    v_cvt_pk_bf16_f32 v51, v214, v215
    buffer_store_dwordx4 v[48:51], v22, s[36:39], s68 offen offset:1024 sc1
    v_cvt_pk_bf16_f32 v52, v224, v225
    v_cvt_pk_bf16_f32 v53, v226, v227
    v_cvt_pk_bf16_f32 v54, v228, v229
    v_cvt_pk_bf16_f32 v55, v230, v231
    buffer_store_dwordx4 v[52:55], v22, s[36:39], s68 offen offset:2048 sc1
    s_add_u32 s68, s68, 110592
L_s1_kernel_fin:
L_s1_kernel_end:
    s_endpgm
.section .rodata,"a"
.p2align 6
.amdhsa_kernel s1_kernel
  .amdhsa_next_free_vgpr 256
  .amdhsa_next_free_sgpr 102
  .amdhsa_accum_offset 256
  .amdhsa_group_segment_fixed_size 0
  .amdhsa_kernarg_size 104
  .amdhsa_user_sgpr_count 2
  .amdhsa_user_sgpr_kernarg_segment_ptr 1
  .amdhsa_system_sgpr_workgroup_id_x 1
  .amdhsa_float_denorm_mode_32 3
.end_amdhsa_kernel
.text
.text
.globl s2_kernel
.p2align 8
.type s2_kernel,@function
s2_kernel:
    s_cmp_ge_u32 s2, 256
    s_cbranch_scc1 L_s2_kernel_end
    s_load_dwordx2 s[4:5], s[0:1], 16
    s_load_dwordx2 s[6:7], s[0:1], 48
    s_load_dwordx2 s[8:9], s[0:1], 56
    s_load_dwordx2 s[10:11], s[0:1], 96
    s_load_dwordx2 s[46:47], s[0:1], 24
    s_load_dwordx2 s[48:49], s[0:1], 64
    v_lshrrev_b32 v2, 6, v0
    v_and_b32 v1, 63, v0
    v_readfirstlane_b32 s28, v2
    v_lshlrev_b32 v14, 4, v1
    s_and_b32 s40, s2, 7
    s_lshr_b32 s41, s2, 3
    s_mov_b32 s44, 1.0
    s_mov_b32 s45, 1.0
    s_waitcnt lgkmcnt(0)
    s_mov_b32 s20, s10
    s_mov_b32 s21, s11
    s_mov_b32 s22, 48013312
    s_mov_b32 s23, 0x20000
    s_cmp_ge_u32 s41, 28
    s_cbranch_scc1 L_s2_kernel_att
    s_lshr_b32 s42, s40, 1
    s_lshl_b32 s42, s42, 2
    s_and_b32 s43, s41, 3
    s_add_u32 s32, s42, s43
    s_and_b32 s42, s40, 1
    s_mul_i32 s42, s42, 7
    s_lshr_b32 s43, s41, 2
    s_add_u32 s33, s42, s43
    s_and_b32 s29, s28, 1
    s_bfe_u32 s30, s28, 0x10001
    s_lshr_b32 s31, s28, 2
    s_mov_b32 s12, s6
    s_mov_b32 s13, s7
    s_mov_b32 s14, 8388608
    s_mov_b32 s15, 0x20000
    s_add_u32 s16, s10, 23068672
    s_addc_u32 s17, s11, 0
    s_mov_b32 s18, 7340032
    s_mov_b32 s19, 0x20000
    s_mov_b32 s24, s8
    s_mov_b32 s25, s9
    s_mov_b32 s26, 4096
    s_mov_b32 s27, 0x20000
    v_lshrrev_b32 v2, 4, v1
    v_add_u32 v2, 0, v2
    v_lshrrev_b32 v4, 1, v2
    v_lshrrev_b32 v3, 2, v2
    v_xor_b32 v4, v4, v3
    v_and_b32 v4, 1, v4
    v_and_b32 v3, 1, v2
    v_lshl_or_b32 v4, v3, 1, v4
    v_and_b32 v3, 4, v2
    v_or_b32 v3, v3, v4
    v_and_b32 v2, 7, v1
    v_xor_b32 v2, v2, v3
    v_lshlrev_b32 v2, 4, v2
    v_lshrrev_b32 v3, 3, v1
    s_lshl_b32 s42, s32, 7
    s_lshl_b32 s43, s28, 4
    s_add_u32 s42, s42, s43
    s_add_u32 s42, s42, 0
    v_add_u32 v3, s42, v3
    v_lshlrev_b32 v3, 12, v3
    v_add_u32 v6, v3, v2
    v_lshrrev_b32 v2, 4, v1
    v_add_u32 v2, 4, v2
    v_lshrrev_b32 v4, 1, v2
    v_lshrrev_b32 v3, 2, v2
    v_xor_b32 v4, v4, v3
    v_and_b32 v4, 1, v4
    v_and_b32 v3, 1, v2
    v_lshl_or_b32 v4, v3, 1, v4
    v_and_b32 v3, 4, v2
    v_or_b32 v3, v3, v4
    v_and_b32 v2, 7, v1
    v_xor_b32 v2, v2, v3
    v_lshlrev_b32 v2, 4, v2
    v_lshrrev_b32 v3, 3, v1
    s_lshl_b32 s42, s32, 7
    s_lshl_b32 s43, s28, 4
    s_add_u32 s42, s42, s43
    s_add_u32 s42, s42, 8
    v_add_u32 v3, s42, v3
    v_lshlrev_b32 v3, 12, v3
    v_add_u32 v7, v3, v2
    v_bfe_u32 v2, v1, 2, 2
    v_lshlrev_b32 v2, 8, v2
    v_lshrrev_b32 v3, 4, v1
    v_lshlrev_b32 v3, 6, v3
    v_add_u32 v2, v2, v3
    v_and_b32 v3, 3, v1
    v_lshlrev_b32 v3, 4, v3
    v_add_u32 v2, v2, v3
    s_mul_i32 s42, s31, 112
    s_lshl_b32 s43, s33, 3
    s_add_u32 s42, s42, s43
    s_and_b32 s43, s28, 3
    s_lshl_b32 s43, s43, 1
    s_add_u32 s42, s42, s43
    s_lshl_b32 s42, s42, 10
    v_add_u32 v8, s42, v2
    v_add_u32 v9, 1024, v8
    s_lshl_b32 s37, s28, 11
    s_add_u32 s38, s37, 16384
    s_mov_b32 s35, 0
    s_mov_b32 s36, 0
    s_add_u32 m0, s37, 0
    s_nop 0
    buffer_load_dwordx4 v6, s[12:15], s35 offen lds
    s_add_u32 m0, s37, 1024
    s_nop 0
    buffer_load_dwordx4 v7, s[12:15], s35 offen lds
    s_add_u32 m0, s38, 0
    s_nop 0
    buffer_load_dwordx4 v8, s[16:19], s36 offen lds
    s_add_u32 m0, s38, 1024
    s_nop 0
    buffer_load_dwordx4 v9, s[16:19], s36 offen lds
    s_add_u32 s35, s35, 128
    s_add_u32 s36, s36, 229376
    v_and_b32 v2, 15, v1
    v_lshrrev_b32 v5, 1, v2
    v_lshrrev_b32 v4, 1, v5
    v_lshrrev_b32 v3, 2, v5
    v_xor_b32 v4, v4, v3
    v_and_b32 v4, 1, v4
    v_and_b32 v3, 1, v5
    v_lshl_or_b32 v4, v3, 1, v4
    v_and_b32 v3, 4, v5
    v_or_b32 v3, v3, v4
    v_lshrrev_b32 v4, 4, v1
    v_and_b32 v5, 1, v4
    v_lshlrev_b32 v5, 1, v5
    v_lshrrev_b32 v4, 1, v4
    v_or_b32 v4, v4, v5
    s_lshl_b32 s42, s31, 2
    v_or_b32 v4, s42, v4
    v_xor_b32 v4, v4, v3
    v_lshlrev_b32 v4, 4, v4
    v_lshlrev_b32 v2, 7, v2
    v_add_u32 v2, v2, v4
    s_lshl_b32 s42, s29, 13
    v_add_u32 v10, s42, v2
    v_add_u32 v11, 65536, v10
    v_lshrrev_b32 v2, 5, v1
    v_lshlrev_b32 v2, 9, v2
    v_and_b32 v3, 3, v1
    v_lshlrev_b32 v3, 6, v3
    v_add_u32 v2, v2, v3
    v_bfe_u32 v3, v1, 2, 2
    v_lshlrev_b32 v3, 4, v3
    v_add_u32 v2, v2, v3
    v_bfe_u32 v3, v1, 4, 1
    v_lshlrev_b32 v3, 3, v3
    v_add_u32 v2, v2, v3
    s_lshl_b32 s42, s31, 13
    s_lshl_b32 s43, s30, 12
    s_add_u32 s42, s42, s43
    s_add_u32 s42, s42, 16384
    v_add_u32 v12, s42, v2
    v_add_u32 v13, 65536, v12
    v_mov_b32 v96, 0
    v_mov_b32 v97, 0
    v_mov_b32 v98, 0
    v_mov_b32 v99, 0
    v_mov_b32 v100, 0
    v_mov_b32 v101, 0
    v_mov_b32 v102, 0
    v_mov_b32 v103, 0
    v_mov_b32 v104, 0
    v_mov_b32 v105, 0
    v_mov_b32 v106, 0
    v_mov_b32 v107, 0
    v_mov_b32 v108, 0
    v_mov_b32 v109, 0
    v_mov_b32 v110, 0
    v_mov_b32 v111, 0
    v_mov_b32 v112, 0
    v_mov_b32 v113, 0
    v_mov_b32 v114, 0
    v_mov_b32 v115, 0
    v_mov_b32 v116, 0
    v_mov_b32 v117, 0
    v_mov_b32 v118, 0
    v_mov_b32 v119, 0
    v_mov_b32 v120, 0
    v_mov_b32 v121, 0
    v_mov_b32 v122, 0
    v_mov_b32 v123, 0
    v_mov_b32 v124, 0
    v_mov_b32 v125, 0
    v_mov_b32 v126, 0
    v_mov_b32 v127, 0
    v_mov_b32 v128, 0
    v_mov_b32 v129, 0
    v_mov_b32 v130, 0
    v_mov_b32 v131, 0
    v_mov_b32 v132, 0
    v_mov_b32 v133, 0
    v_mov_b32 v134, 0
    v_mov_b32 v135, 0
    v_mov_b32 v136, 0
    v_mov_b32 v137, 0
    v_mov_b32 v138, 0
    v_mov_b32 v139, 0
    v_mov_b32 v140, 0
    v_mov_b32 v141, 0
    v_mov_b32 v142, 0
    v_mov_b32 v143, 0
    v_mov_b32 v144, 0
    v_mov_b32 v145, 0
    v_mov_b32 v146, 0
    v_mov_b32 v147, 0
    v_mov_b32 v148, 0
    v_mov_b32 v149, 0
    v_mov_b32 v150, 0
    v_mov_b32 v151, 0
    v_mov_b32 v152, 0
    v_mov_b32 v153, 0
    v_mov_b32 v154, 0
    v_mov_b32 v155, 0
    v_mov_b32 v156, 0
    v_mov_b32 v157, 0
    v_mov_b32 v158, 0
    v_mov_b32 v159, 0
    s_add_u32 m0, s37, 32768
    s_nop 0
    buffer_load_dwordx4 v6, s[12:15], s35 offen lds
    s_add_u32 m0, s37, 33792
    s_nop 0
    buffer_load_dwordx4 v7, s[12:15], s35 offen lds
    s_add_u32 m0, s38, 32768
    s_nop 0
    buffer_load_dwordx4 v8, s[16:19], s36 offen lds
    s_add_u32 m0, s38, 33792
    s_nop 0
    buffer_load_dwordx4 v9, s[16:19], s36 offen lds
    s_add_u32 s35, s35, 128
    s_add_u32 s36, s36, 229376
    s_waitcnt vmcnt(4)
    s_barrier
    ds_read_b128 v[32:35], v10 offset:0
    ds_read_b128 v[36:39], v10 offset:2048
    ds_read_b128 v[40:43], v10 offset:4096
    ds_read_b128 v[44:47], v10 offset:6144
    ds_read_b64_tr_b16 v[64:65], v12 offset:0
    ds_read_b64_tr_b16 v[66:67], v12 offset:256
    ds_read_b64_tr_b16 v[68:69], v12 offset:1024
    ds_read_b64_tr_b16 v[70:71], v12 offset:1280
    ds_read_b64_tr_b16 v[72:73], v12 offset:2048
    ds_read_b64_tr_b16 v[74:75], v12 offset:2304
    ds_read_b64_tr_b16 v[76:77], v12 offset:3072
    ds_read_b64_tr_b16 v[78:79], v12 offset:3328
    s_waitcnt vmcnt(0) lgkmcnt(0)
    s_barrier
    v_mfma_f32_16x16x32_bf16 v[96:99], v[64:67], v[32:35], v[96:99]
    ds_read_b128 v[48:51], v10 offset:32768
    s_add_u32 m0, s37, 65536
    v_mfma_f32_16x16x32_bf16 v[100:103], v[64:67], v[36:39], v[100:103]
    buffer_load_dwordx4 v6, s[12:15], s35 offen lds
    ds_read_b128 v[52:55], v10 offset:34816
    v_mfma_f32_16x16x32_bf16 v[104:107], v[64:67], v[40:43], v[104:107]
    ds_read_b128 v[56:59], v10 offset:36864
    s_add_u32 m0, s37, 66560
    v_mfma_f32_16x16x32_bf16 v[108:111], v[64:67], v[44:47], v[108:111]
    buffer_load_dwordx4 v7, s[12:15], s35 offen lds
    ds_read_b128 v[60:63], v10 offset:38912
    v_mfma_f32_16x16x32_bf16 v[124:127], v[68:71], v[44:47], v[124:127]
    ds_read_b64_tr_b16 v[80:81], v12 offset:32768
    s_add_u32 m0, s38, 65536
    v_mfma_f32_16x16x32_bf16 v[120:123], v[68:71], v[40:43], v[120:123]
    buffer_load_dwordx4 v8, s[16:19], s36 offen lds
    ds_read_b64_tr_b16 v[82:83], v12 offset:33024
    v_mfma_f32_16x16x32_bf16 v[116:119], v[68:71], v[36:39], v[116:119]
    ds_read_b64_tr_b16 v[84:85], v12 offset:33792
    s_add_u32 m0, s38, 66560
    v_mfma_f32_16x16x32_bf16 v[112:115], v[68:71], v[32:35], v[112:115]
    buffer_load_dwordx4 v9, s[16:19], s36 offen lds
    s_add_u32 s35, s35, 128
    s_add_u32 s36, s36, 229376
    ds_read_b64_tr_b16 v[86:87], v12 offset:34048
    v_mfma_f32_16x16x32_bf16 v[128:131], v[72:75], v[32:35], v[128:131]
    ds_read_b64_tr_b16 v[88:89], v12 offset:34816
    s_add_u32 m0, s37, 98304
    v_mfma_f32_16x16x32_bf16 v[132:135], v[72:75], v[36:39], v[132:135]
    buffer_load_dwordx4 v6, s[12:15], s35 offen lds
    ds_read_b64_tr_b16 v[90:91], v12 offset:35072
    v_mfma_f32_16x16x32_bf16 v[136:139], v[72:75], v[40:43], v[136:139]
    ds_read_b64_tr_b16 v[92:93], v12 offset:35840
    s_add_u32 m0, s37, 99328
    v_mfma_f32_16x16x32_bf16 v[140:143], v[72:75], v[44:47], v[140:143]
    buffer_load_dwordx4 v7, s[12:15], s35 offen lds
    ds_read_b64_tr_b16 v[94:95], v12 offset:36096
    v_mfma_f32_16x16x32_bf16 v[156:159], v[76:79], v[44:47], v[156:159]
    s_add_u32 m0, s38, 98304
    v_mfma_f32_16x16x32_bf16 v[152:155], v[76:79], v[40:43], v[152:155]
    buffer_load_dwordx4 v8, s[16:19], s36 offen lds
    v_mfma_f32_16x16x32_bf16 v[148:151], v[76:79], v[36:39], v[148:151]
    s_add_u32 m0, s38, 99328
    v_mfma_f32_16x16x32_bf16 v[144:147], v[76:79], v[32:35], v[144:147]
    buffer_load_dwordx4 v9, s[16:19], s36 offen lds
    s_add_u32 s35, s35, 128
    s_add_u32 s36, s36, 229376
    s_waitcnt vmcnt(4) lgkmcnt(0)
    s_barrier
    v_mfma_f32_16x16x32_bf16 v[96:99], v[80:83], v[48:51], v[96:99]
    ds_read_b128 v[32:35], v11 offset:0
    s_add_u32 m0, s37, 0
    v_mfma_f32_16x16x32_bf16 v[100:103], v[80:83], v[52:55], v[100:103]
    buffer_load_dwordx4 v6, s[12:15], s35 offen lds
    ds_read_b128 v[36:39], v11 offset:2048
    v_mfma_f32_16x16x32_bf16 v[104:107], v[80:83], v[56:59], v[104:107]
    ds_read_b128 v[40:43], v11 offset:4096
    s_add_u32 m0, s37, 1024
    v_mfma_f32_16x16x32_bf16 v[108:111], v[80:83], v[60:63], v[108:111]
    buffer_load_dwordx4 v7, s[12:15], s35 offen lds
    ds_read_b128 v[44:47], v11 offset:6144
    v_mfma_f32_16x16x32_bf16 v[124:127], v[84:87], v[60:63], v[124:127]
    ds_read_b64_tr_b16 v[64:65], v13 offset:0
    s_add_u32 m0, s38, 0
    v_mfma_f32_16x16x32_bf16 v[120:123], v[84:87], v[56:59], v[120:123]
    buffer_load_dwordx4 v8, s[16:19], s36 offen lds
    ds_read_b64_tr_b16 v[66:67], v13 offset:256
    v_mfma_f32_16x16x32_bf16 v[116:119], v[84:87], v[52:55], v[116:119]
    ds_read_b64_tr_b16 v[68:69], v13 offset:1024
    s_add_u32 m0, s38, 1024
    v_mfma_f32_16x16x32_bf16 v[112:115], v[84:87], v[48:51], v[112:115]
    buffer_load_dwordx4 v9, s[16:19], s36 offen lds
    s_add_u32 s35, s35, 128
    s_add_u32 s36, s36, 229376
    ds_read_b64_tr_b16 v[70:71], v13 offset:1280
    v_mfma_f32_16x16x32_bf16 v[128:131], v[88:91], v[48:51], v[128:131]
    ds_read_b64_tr_b16 v[72:73], v13 offset:2048
    s_add_u32 m0, s37, 32768
    v_mfma_f32_16x16x32_bf16 v[132:135], v[88:91], v[52:55], v[132:135]
    buffer_load_dwordx4 v6, s[12:15], s35 offen lds
    ds_read_b64_tr_b16 v[74:75], v13 offset:2304
    v_mfma_f32_16x16x32_bf16 v[136:139], v[88:91], v[56:59], v[136:139]
    ds_read_b64_tr_b16 v[76:77], v13 offset:3072
    s_add_u32 m0, s37, 33792
    v_mfma_f32_16x16x32_bf16 v[140:143], v[88:91], v[60:63], v[140:143]
    buffer_load_dwordx4 v7, s[12:15], s35 offen lds
    ds_read_b64_tr_b16 v[78:79], v13 offset:3328
    v_mfma_f32_16x16x32_bf16 v[156:159], v[92:95], v[60:63], v[156:159]
    s_add_u32 m0, s38, 32768
    v_mfma_f32_16x16x32_bf16 v[152:155], v[92:95], v[56:59], v[152:155]
    buffer_load_dwordx4 v8, s[16:19], s36 offen lds
    v_mfma_f32_16x16x32_bf16 v[148:151], v[92:95], v[52:55], v[148:151]
    s_add_u32 m0, s38, 33792
    v_mfma_f32_16x16x32_bf16 v[144:147], v[92:95], v[48:51], v[144:147]
    buffer_load_dwordx4 v9, s[16:19], s36 offen lds
    s_add_u32 s35, s35, 128
    s_add_u32 s36, s36, 229376
    s_waitcnt vmcnt(8) lgkmcnt(0)
    s_barrier
    s_mov_b32 s34, 0
.p2align 6
L_s2_kernel_loop:
    v_mfma_f32_16x16x32_bf16 v[96:99], v[64:67], v[32:35], v[96:99]
    ds_read_b128 v[48:51], v11 offset:32768
    v_mfma_f32_16x16x32_bf16 v[100:103], v[64:67], v[36:39], v[100:103]
    ds_read_b128 v[52:55], v11 offset:34816
    v_mfma_f32_16x16x32_bf16 v[104:107], v[64:67], v[40:43], v[104:107]
    ds_read_b128 v[56:59], v11 offset:36864
    v_mfma_f32_16x16x32_bf16 v[108:111], v[64:67], v[44:47], v[108:111]
    ds_read_b128 v[60:63], v11 offset:38912
    v_mfma_f32_16x16x32_bf16 v[124:127], v[68:71], v[44:47], v[124:127]
    ds_read_b64_tr_b16 v[80:81], v13 offset:32768
    v_mfma_f32_16x16x32_bf16 v[120:123], v[68:71], v[40:43], v[120:123]
    ds_read_b64_tr_b16 v[82:83], v13 offset:33024
    v_mfma_f32_16x16x32_bf16 v[116:119], v[68:71], v[36:39], v[116:119]
    ds_read_b64_tr_b16 v[84:85], v13 offset:33792
    v_mfma_f32_16x16x32_bf16 v[112:115], v[68:71], v[32:35], v[112:115]
    ds_read_b64_tr_b16 v[86:87], v13 offset:34048
    s_add_u32 m0, s37, 65536
    v_mfma_f32_16x16x32_bf16 v[128:131], v[72:75], v[32:35], v[128:131]
    buffer_load_dwordx4 v6, s[12:15], s35 offen lds
    ds_read_b64_tr_b16 v[88:89], v13 offset:34816
    v_mfma_f32_16x16x32_bf16 v[132:135], v[72:75], v[36:39], v[132:135]
    ds_read_b64_tr_b16 v[90:91], v13 offset:35072
    s_add_u32 m0, s37, 66560
    v_mfma_f32_16x16x32_bf16 v[136:139], v[72:75], v[40:43], v[136:139]
    buffer_load_dwordx4 v7, s[12:15], s35 offen lds
    ds_read_b64_tr_b16 v[92:93], v13 offset:35840
    v_mfma_f32_16x16x32_bf16 v[140:143], v[72:75], v[44:47], v[140:143]
    ds_read_b64_tr_b16 v[94:95], v13 offset:36096
    s_add_u32 m0, s38, 65536
    v_mfma_f32_16x16x32_bf16 v[156:159], v[76:79], v[44:47], v[156:159]
    buffer_load_dwordx4 v8, s[16:19], s36 offen lds
    v_mfma_f32_16x16x32_bf16 v[152:155], v[76:79], v[40:43], v[152:155]
    s_add_u32 m0, s38, 66560
    v_mfma_f32_16x16x32_bf16 v[148:151], v[76:79], v[36:39], v[148:151]
    buffer_load_dwordx4 v9, s[16:19], s36 offen lds
    s_add_u32 s35, s35, 128
    s_add_u32 s36, s36, 229376
    v_mfma_f32_16x16x32_bf16 v[144:147], v[76:79], v[32:35], v[144:147]
    s_waitcnt vmcnt(8) lgkmcnt(0)
    s_barrier
    v_mfma_f32_16x16x32_bf16 v[96:99], v[80:83], v[48:51], v[96:99]
    ds_read_b128 v[32:35], v10 offset:0
    v_mfma_f32_16x16x32_bf16 v[100:103], v[80:83], v[52:55], v[100:103]
    ds_read_b128 v[36:39], v10 offset:2048
    v_mfma_f32_16x16x32_bf16 v[104:107], v[80:83], v[56:59], v[104:107]
    ds_read_b128 v[40:43], v10 offset:4096
    v_mfma_f32_16x16x32_bf16 v[108:111], v[80:83], v[60:63], v[108:111]
    ds_read_b128 v[44:47], v10 offset:6144
    v_mfma_f32_16x16x32_bf16 v[124:127], v[84:87], v[60:63], v[124:127]
    ds_read_b64_tr_b16 v[64:65], v12 offset:0
    v_mfma_f32_16x16x32_bf16 v[120:123], v[84:87], v[56:59], v[120:123]
    ds_read_b64_tr_b16 v[66:67], v12 offset:256
    v_mfma_f32_16x16x32_bf16 v[116:119], v[84:87], v[52:55], v[116:119]
    ds_read_b64_tr_b16 v[68:69], v12 offset:1024
    v_mfma_f32_16x16x32_bf16 v[112:115], v[84:87], v[48:51], v[112:115]
    ds_read_b64_tr_b16 v[70:71], v12 offset:1280
    s_add_u32 m0, s37, 98304
    v_mfma_f32_16x16x32_bf16 v[128:131], v[88:91], v[48:51], v[128:131]
    buffer_load_dwordx4 v6, s[12:15], s35 offen lds
    ds_read_b64_tr_b16 v[72:73], v12 offset:2048
    v_mfma_f32_16x16x32_bf16 v[132:135], v[88:91], v[52:55], v[132:135]
    ds_read_b64_tr_b16 v[74:75], v12 offset:2304
    s_add_u32 m0, s37, 99328
    v_mfma_f32_16x16x32_bf16 v[136:139], v[88:91], v[56:59], v[136:139]
    buffer_load_dwordx4 v7, s[12:15], s35 offen lds
    ds_read_b64_tr_b16 v[76:77], v12 offset:3072
    v_mfma_f32_16x16x32_bf16 v[140:143], v[88:91], v[60:63], v[140:143]
    ds_read_b64_tr_b16 v[78:79], v12 offset:3328
    s_add_u32 m0, s38, 98304
    v_mfma_f32_16x16x32_bf16 v[156:159], v[92:95], v[60:63], v[156:159]
    buffer_load_dwordx4 v8, s[16:19], s36 offen lds
    v_mfma_f32_16x16x32_bf16 v[152:155], v[92:95], v[56:59], v[152:155]
    s_add_u32 m0, s38, 99328
    v_mfma_f32_16x16x32_bf16 v[148:151], v[92:95], v[52:55], v[148:151]
    buffer_load_dwordx4 v9, s[16:19], s36 offen lds
    s_add_u32 s35, s35, 128
    s_add_u32 s36, s36, 229376
    v_mfma_f32_16x16x32_bf16 v[144:147], v[92:95], v[48:51], v[144:147]
    s_waitcnt vmcnt(8) lgkmcnt(0)
    s_barrier
    v_mfma_f32_16x16x32_bf16 v[96:99], v[64:67], v[32:35], v[96:99]
    ds_read_b128 v[48:51], v10 offset:32768
    v_mfma_f32_16x16x32_bf16 v[100:103], v[64:67], v[36:39], v[100:103]
    ds_read_b128 v[52:55], v10 offset:34816
    v_mfma_f32_16x16x32_bf16 v[104:107], v[64:67], v[40:43], v[104:107]
    ds_read_b128 v[56:59], v10 offset:36864
    v_mfma_f32_16x16x32_bf16 v[108:111], v[64:67], v[44:47], v[108:111]
    ds_read_b128 v[60:63], v10 offset:38912
    v_mfma_f32_16x16x32_bf16 v[124:127], v[68:71], v[44:47], v[124:127]
    ds_read_b64_tr_b16 v[80:81], v12 offset:32768
    v_mfma_f32_16x16x32_bf16 v[120:123], v[68:71], v[40:43], v[120:123]
    ds_read_b64_tr_b16 v[82:83], v12 offset:33024
    v_mfma_f32_16x16x32_bf16 v[116:119], v[68:71], v[36:39], v[116:119]
    ds_read_b64_tr_b16 v[84:85], v12 offset:33792
    v_mfma_f32_16x16x32_bf16 v[112:115], v[68:71], v[32:35], v[112:115]
    ds_read_b64_tr_b16 v[86:87], v12 offset:34048
    s_add_u32 m0, s37, 0
    v_mfma_f32_16x16x32_bf16 v[128:131], v[72:75], v[32:35], v[128:131]
    buffer_load_dwordx4 v6, s[12:15], s35 offen lds
    ds_read_b64_tr_b16 v[88:89], v12 offset:34816
    v_mfma_f32_16x16x32_bf16 v[132:135], v[72:75], v[36:39], v[132:135]
    ds_read_b64_tr_b16 v[90:91], v12 offset:35072
    s_add_u32 m0, s37, 1024
    v_mfma_f32_16x16x32_bf16 v[136:139], v[72:75], v[40:43], v[136:139]
    buffer_load_dwordx4 v7, s[12:15], s35 offen lds
    ds_read_b64_tr_b16 v[92:93], v12 offset:35840
    v_mfma_f32_16x16x32_bf16 v[140:143], v[72:75], v[44:47], v[140:143]
    ds_read_b64_tr_b16 v[94:95], v12 offset:36096
    s_add_u32 m0, s38, 0
    v_mfma_f32_16x16x32_bf16 v[156:159], v[76:79], v[44:47], v[156:159]
    buffer_load_dwordx4 v8, s[16:19], s36 offen lds
    v_mfma_f32_16x16x32_bf16 v[152:155], v[76:79], v[40:43], v[152:155]
    s_add_u32 m0, s38, 1024
    v_mfma_f32_16x16x32_bf16 v[148:151], v[76:79], v[36:39], v[148:151]
    buffer_load_dwordx4 v9, s[16:19], s36 offen lds
    s_add_u32 s35, s35, 128
    s_add_u32 s36, s36, 229376
    v_mfma_f32_16x16x32_bf16 v[144:147], v[76:79], v[32:35], v[144:147]
    s_waitcnt vmcnt(8) lgkmcnt(0)
    s_barrier
    v_mfma_f32_16x16x32_bf16 v[96:99], v[80:83], v[48:51], v[96:99]
    ds_read_b128 v[32:35], v11 offset:0
    v_mfma_f32_16x16x32_bf16 v[100:103], v[80:83], v[52:55], v[100:103]
    ds_read_b128 v[36:39], v11 offset:2048
    v_mfma_f32_16x16x32_bf16 v[104:107], v[80:83], v[56:59], v[104:107]
    ds_read_b128 v[40:43], v11 offset:4096
    v_mfma_f32_16x16x32_bf16 v[108:111], v[80:83], v[60:63], v[108:111]
    ds_read_b128 v[44:47], v11 offset:6144
    v_mfma_f32_16x16x32_bf16 v[124:127], v[84:87], v[60:63], v[124:127]
    ds_read_b64_tr_b16 v[64:65], v13 offset:0
    v_mfma_f32_16x16x32_bf16 v[120:123], v[84:87], v[56:59], v[120:123]
    ds_read_b64_tr_b16 v[66:67], v13 offset:256
    v_mfma_f32_16x16x32_bf16 v[116:119], v[84:87], v[52:55], v[116:119]
    ds_read_b64_tr_b16 v[68:69], v13 offset:1024
    v_mfma_f32_16x16x32_bf16 v[112:115], v[84:87], v[48:51], v[112:115]
    ds_read_b64_tr_b16 v[70:71], v13 offset:1280
    s_add_u32 m0, s37, 32768
    v_mfma_f32_16x16x32_bf16 v[128:131], v[88:91], v[48:51], v[128:131]
    buffer_load_dwordx4 v6, s[12:15], s35 offen lds
    ds_read_b64_tr_b16 v[72:73], v13 offset:2048
    v_mfma_f32_16x16x32_bf16 v[132:135], v[88:91], v[52:55], v[132:135]
    ds_read_b64_tr_b16 v[74:75], v13 offset:2304
    s_add_u32 m0, s37, 33792
    v_mfma_f32_16x16x32_bf16 v[136:139], v[88:91], v[56:59], v[136:139]
    buffer_load_dwordx4 v7, s[12:15], s35 offen lds
    ds_read_b64_tr_b16 v[76:77], v13 offset:3072
    v_mfma_f32_16x16x32_bf16 v[140:143], v[88:91], v[60:63], v[140:143]
    ds_read_b64_tr_b16 v[78:79], v13 offset:3328
    s_add_u32 m0, s38, 32768
    v_mfma_f32_16x16x32_bf16 v[156:159], v[92:95], v[60:63], v[156:159]
    buffer_load_dwordx4 v8, s[16:19], s36 offen lds
    v_mfma_f32_16x16x32_bf16 v[152:155], v[92:95], v[56:59], v[152:155]
    s_add_u32 m0, s38, 33792
    v_mfma_f32_16x16x32_bf16 v[148:151], v[92:95], v[52:55], v[148:151]
    buffer_load_dwordx4 v9, s[16:19], s36 offen lds
    s_add_u32 s35, s35, 128
    s_add_u32 s36, s36, 229376
    v_mfma_f32_16x16x32_bf16 v[144:147], v[92:95], v[48:51], v[144:147]
    s_waitcnt vmcnt(8) lgkmcnt(0)
    s_barrier
    s_add_u32 s34, s34, 1
    s_cmp_lt_u32 s34, 6
    s_cbranch_scc1 L_s2_kernel_loop
    v_mfma_f32_16x16x32_bf16 v[96:99], v[64:67], v[32:35], v[96:99]
    ds_read_b128 v[48:51], v11 offset:32768
    v_mfma_f32_16x16x32_bf16 v[100:103], v[64:67], v[36:39], v[100:103]
    ds_read_b128 v[52:55], v11 offset:34816
    v_mfma_f32_16x16x32_bf16 v[104:107], v[64:67], v[40:43], v[104:107]
    ds_read_b128 v[56:59], v11 offset:36864
    v_mfma_f32_16x16x32_bf16 v[108:111], v[64:67], v[44:47], v[108:111]
    ds_read_b128 v[60:63], v11 offset:38912
    v_mfma_f32_16x16x32_bf16 v[124:127], v[68:71], v[44:47], v[124:127]
    ds_read_b64_tr_b16 v[80:81], v13 offset:32768
    v_mfma_f32_16x16x32_bf16 v[120:123], v[68:71], v[40:43], v[120:123]
    ds_read_b64_tr_b16 v[82:83], v13 offset:33024
    v_mfma_f32_16x16x32_bf16 v[116:119], v[68:71], v[36:39], v[116:119]
    ds_read_b64_tr_b16 v[84:85], v13 offset:33792
    v_mfma_f32_16x16x32_bf16 v[112:115], v[68:71], v[32:35], v[112:115]
    ds_read_b64_tr_b16 v[86:87], v13 offset:34048
    s_add_u32 m0, s37, 65536
    v_mfma_f32_16x16x32_bf16 v[128:131], v[72:75], v[32:35], v[128:131]
    buffer_load_dwordx4 v6, s[12:15], s35 offen lds
    ds_read_b64_tr_b16 v[88:89], v13 offset:34816
    v_mfma_f32_16x16x32_bf16 v[132:135], v[72:75], v[36:39], v[132:135]
    ds_read_b64_tr_b16 v[90:91], v13 offset:35072
    s_add_u32 m0, s37, 66560
    v_mfma_f32_16x16x32_bf16 v[136:139], v[72:75], v[40:43], v[136:139]
    buffer_load_dwordx4 v7, s[12:15], s35 offen lds
    ds_read_b64_tr_b16 v[92:93], v13 offset:35840
    v_mfma_f32_16x16x32_bf16 v[140:143], v[72:75], v[44:47], v[140:143]
    ds_read_b64_tr_b16 v[94:95], v13 offset:36096
    s_add_u32 m0, s38, 65536
    v_mfma_f32_16x16x32_bf16 v[156:159], v[76:79], v[44:47], v[156:159]
    buffer_load_dwordx4 v8, s[16:19], s36 offen lds
    v_mfma_f32_16x16x32_bf16 v[152:155], v[76:79], v[40:43], v[152:155]
    s_add_u32 m0, s38, 66560
    v_mfma_f32_16x16x32_bf16 v[148:151], v[76:79], v[36:39], v[148:151]
    buffer_load_dwordx4 v9, s[16:19], s36 offen lds
    s_add_u32 s35, s35, 128
    s_add_u32 s36, s36, 229376
    v_mfma_f32_16x16x32_bf16 v[144:147], v[76:79], v[32:35], v[144:147]
    s_waitcnt vmcnt(8) lgkmcnt(0)
    s_barrier
    v_mfma_f32_16x16x32_bf16 v[96:99], v[80:83], v[48:51], v[96:99]
    ds_read_b128 v[32:35], v10 offset:0
    v_mfma_f32_16x16x32_bf16 v[100:103], v[80:83], v[52:55], v[100:103]
    ds_read_b128 v[36:39], v10 offset:2048
    v_mfma_f32_16x16x32_bf16 v[104:107], v[80:83], v[56:59], v[104:107]
    ds_read_b128 v[40:43], v10 offset:4096
    v_mfma_f32_16x16x32_bf16 v[108:111], v[80:83], v[60:63], v[108:111]
    ds_read_b128 v[44:47], v10 offset:6144
    v_mfma_f32_16x16x32_bf16 v[124:127], v[84:87], v[60:63], v[124:127]
    ds_read_b64_tr_b16 v[64:65], v12 offset:0
    v_mfma_f32_16x16x32_bf16 v[120:123], v[84:87], v[56:59], v[120:123]
    ds_read_b64_tr_b16 v[66:67], v12 offset:256
    v_mfma_f32_16x16x32_bf16 v[116:119], v[84:87], v[52:55], v[116:119]
    ds_read_b64_tr_b16 v[68:69], v12 offset:1024
    v_mfma_f32_16x16x32_bf16 v[112:115], v[84:87], v[48:51], v[112:115]
    ds_read_b64_tr_b16 v[70:71], v12 offset:1280
    s_add_u32 m0, s37, 98304
    v_mfma_f32_16x16x32_bf16 v[128:131], v[88:91], v[48:51], v[128:131]
    buffer_load_dwordx4 v6, s[12:15], s35 offen lds
    ds_read_b64_tr_b16 v[72:73], v12 offset:2048
    v_mfma_f32_16x16x32_bf16 v[132:135], v[88:91], v[52:55], v[132:135]
    ds_read_b64_tr_b16 v[74:75], v12 offset:2304
    s_add_u32 m0, s37, 99328
    v_mfma_f32_16x16x32_bf16 v[136:139], v[88:91], v[56:59], v[136:139]
    buffer_load_dwordx4 v7, s[12:15], s35 offen lds
    ds_read_b64_tr_b16 v[76:77], v12 offset:3072
    v_mfma_f32_16x16x32_bf16 v[140:143], v[88:91], v[60:63], v[140:143]
    ds_read_b64_tr_b16 v[78:79], v12 offset:3328
    s_add_u32 m0, s38, 98304
    v_mfma_f32_16x16x32_bf16 v[156:159], v[92:95], v[60:63], v[156:159]
    buffer_load_dwordx4 v8, s[16:19], s36 offen lds
    v_mfma_f32_16x16x32_bf16 v[152:155], v[92:95], v[56:59], v[152:155]
    s_add_u32 m0, s38, 99328
    v_mfma_f32_16x16x32_bf16 v[148:151], v[92:95], v[52:55], v[148:151]
    buffer_load_dwordx4 v9, s[16:19], s36 offen lds
    s_add_u32 s35, s35, 128
    s_add_u32 s36, s36, 229376
    v_mfma_f32_16x16x32_bf16 v[144:147], v[92:95], v[48:51], v[144:147]
    s_waitcnt vmcnt(8) lgkmcnt(0)
    s_barrier
    v_mfma_f32_16x16x32_bf16 v[96:99], v[64:67], v[32:35], v[96:99]
    ds_read_b128 v[48:51], v10 offset:32768
    v_mfma_f32_16x16x32_bf16 v[100:103], v[64:67], v[36:39], v[100:103]
    ds_read_b128 v[52:55], v10 offset:34816
    s_lshl_b32 s42, s32, 7
    s_lshl_b32 s43, s29, 6
    s_add_u32 s42, s42, s43
    s_lshl_b32 s43, s31, 5
    s_add_u32 s42, s42, s43
    v_and_b32 v2, 15, v1
    v_add_u32 v2, s42, v2
    v_lshlrev_b32 v3, 2, v2
    v_add_u32 v3, 33816576, v3
    v_lshlrev_b32 v4, 1, v2
    v_mfma_f32_16x16x32_bf16 v[104:107], v[64:67], v[40:43], v[104:107]
    ds_read_b128 v[56:59], v10 offset:36864
    v_mfma_f32_16x16x32_bf16 v[108:111], v[64:67], v[44:47], v[108:111]
    ds_read_b128 v[60:63], v10 offset:38912
    v_mfma_f32_16x16x32_bf16 v[124:127], v[68:71], v[44:47], v[124:127]
    ds_read_b64_tr_b16 v[80:81], v12 offset:32768
    buffer_load_dword v16, v3, s[20:23], 0 offen offset:0
    buffer_load_ushort v18, v4, s[24:27], 0 offen offset:0
    buffer_load_dword v17, v3, s[20:23], 0 offen offset:64
    buffer_load_ushort v19, v4, s[24:27], 0 offen offset:32
    v_mfma_f32_16x16x32_bf16 v[120:123], v[68:71], v[40:43], v[120:123]
    ds_read_b64_tr_b16 v[82:83], v12 offset:33024
    v_mfma_f32_16x16x32_bf16 v[116:119], v[68:71], v[36:39], v[116:119]
    ds_read_b64_tr_b16 v[84:85], v12 offset:33792
    v_mfma_f32_16x16x32_bf16 v[112:115], v[68:71], v[32:35], v[112:115]
    ds_read_b64_tr_b16 v[86:87], v12 offset:34048
    s_lshl_b32 s42, s32, 2
    s_lshl_b32 s43, s29, 1
    s_add_u32 s42, s42, s43
    s_add_u32 s42, s42, s31
    s_mul_i32 s42, s42, 112
    s_lshl_b32 s43, s33, 3
    s_add_u32 s42, s42, s43
    s_lshl_b32 s43, s30, 2
    s_add_u32 s42, s42, s43
    s_lshl_b32 s42, s42, 10
    s_add_u32 s42, s42, 15728640
    v_mfma_f32_16x16x32_bf16 v[128:131], v[72:75], v[32:35], v[128:131]
    ds_read_b64_tr_b16 v[88:89], v12 offset:34816
    v_mfma_f32_16x16x32_bf16 v[132:135], v[72:75], v[36:39], v[132:135]
    ds_read_b64_tr_b16 v[90:91], v12 offset:35072
    v_mfma_f32_16x16x32_bf16 v[136:139], v[72:75], v[40:43], v[136:139]
    ds_read_b64_tr_b16 v[92:93], v12 offset:35840
    buffer_load_dwordx4 v[160:163], v14, s[20:23], s42 offen offset:0
    buffer_load_dwordx4 v[164:167], v14, s[20:23], s42 offen offset:1024
    buffer_load_dwordx4 v[168:171], v14, s[20:23], s42 offen offset:2048
    buffer_load_dwordx4 v[172:175], v14, s[20:23], s42 offen offset:3072
    v_mfma_f32_16x16x32_bf16 v[140:143], v[72:75], v[44:47], v[140:143]
    ds_read_b64_tr_b16 v[94:95], v12 offset:36096
    v_mfma_f32_16x16x32_bf16 v[156:159], v[76:79], v[44:47], v[156:159]
    v_mfma_f32_16x16x32_bf16 v[152:155], v[76:79], v[40:43], v[152:155]
    v_mfma_f32_16x16x32_bf16 v[148:151], v[76:79], v[36:39], v[148:151]
    v_mfma_f32_16x16x32_bf16 v[144:147], v[76:79], v[32:35], v[144:147]
    s_waitcnt vmcnt(12) lgkmcnt(0)
    s_barrier
    v_mfma_f32_16x16x32_bf16 v[96:99], v[80:83], v[48:51], v[96:99]
    ds_read_b128 v[32:35], v11 offset:0
    v_mfma_f32_16x16x32_bf16 v[100:103], v[80:83], v[52:55], v[100:103]
    ds_read_b128 v[36:39], v11 offset:2048
    v_mfma_f32_16x16x32_bf16 v[104:107], v[80:83], v[56:59], v[104:107]
    ds_read_b128 v[40:43], v11 offset:4096
    v_mfma_f32_16x16x32_bf16 v[108:111], v[80:83], v[60:63], v[108:111]
    ds_read_b128 v[44:47], v11 offset:6144
    v_mfma_f32_16x16x32_bf16 v[124:127], v[84:87], v[60:63], v[124:127]
    ds_read_b64_tr_b16 v[64:65], v13 offset:0
    v_mfma_f32_16x16x32_bf16 v[120:123], v[84:87], v[56:59], v[120:123]
    ds_read_b64_tr_b16 v[66:67], v13 offset:256
    v_mfma_f32_16x16x32_bf16 v[116:119], v[84:87], v[52:55], v[116:119]
    ds_read_b64_tr_b16 v[68:69], v13 offset:1024
    v_mfma_f32_16x16x32_bf16 v[112:115], v[84:87], v[48:51], v[112:115]
    ds_read_b64_tr_b16 v[70:71], v13 offset:1280
    v_mfma_f32_16x16x32_bf16 v[128:131], v[88:91], v[48:51], v[128:131]
    ds_read_b64_tr_b16 v[72:73], v13 offset:2048
    v_mfma_f32_16x16x32_bf16 v[132:135], v[88:91], v[52:55], v[132:135]
    ds_read_b64_tr_b16 v[74:75], v13 offset:2304
    v_mfma_f32_16x16x32_bf16 v[136:139], v[88:91], v[56:59], v[136:139]
    ds_read_b64_tr_b16 v[76:77], v13 offset:3072
    v_mfma_f32_16x16x32_bf16 v[140:143], v[88:91], v[60:63], v[140:143]
    ds_read_b64_tr_b16 v[78:79], v13 offset:3328
    v_mfma_f32_16x16x32_bf16 v[156:159], v[92:95], v[60:63], v[156:159]
    v_mfma_f32_16x16x32_bf16 v[152:155], v[92:95], v[56:59], v[152:155]
    v_mfma_f32_16x16x32_bf16 v[148:151], v[92:95], v[52:55], v[148:151]
    v_mfma_f32_16x16x32_bf16 v[144:147], v[92:95], v[48:51], v[144:147]
    s_waitcnt vmcnt(8) lgkmcnt(0)
    s_barrier
    v_mfma_f32_16x16x32_bf16 v[96:99], v[64:67], v[32:35], v[96:99]
    ds_read_b128 v[48:51], v11 offset:32768
    v_mfma_f32_16x16x32_bf16 v[100:103], v[64:67], v[36:39], v[100:103]
    ds_read_b128 v[52:55], v11 offset:34816
    v_mfma_f32_16x16x32_bf16 v[104:107], v[64:67], v[40:43], v[104:107]
    ds_read_b128 v[56:59], v11 offset:36864
    v_mfma_f32_16x16x32_bf16 v[108:111], v[64:67], v[44:47], v[108:111]
    ds_read_b128 v[60:63], v11 offset:38912
    v_mfma_f32_16x16x32_bf16 v[124:127], v[68:71], v[44:47], v[124:127]
    ds_read_b64_tr_b16 v[80:81], v13 offset:32768
    v_mfma_f32_16x16x32_bf16 v[120:123], v[68:71], v[40:43], v[120:123]
    ds_read_b64_tr_b16 v[82:83], v13 offset:33024
    v_mfma_f32_16x16x32_bf16 v[116:119], v[68:71], v[36:39], v[116:119]
    ds_read_b64_tr_b16 v[84:85], v13 offset:33792
    v_mfma_f32_16x16x32_bf16 v[112:115], v[68:71], v[32:35], v[112:115]
    ds_read_b64_tr_b16 v[86:87], v13 offset:34048
    v_mfma_f32_16x16x32_bf16 v[128:131], v[72:75], v[32:35], v[128:131]
    ds_read_b64_tr_b16 v[88:89], v13 offset:34816
    v_mfma_f32_16x16x32_bf16 v[132:135], v[72:75], v[36:39], v[132:135]
    ds_read_b64_tr_b16 v[90:91], v13 offset:35072
    v_mfma_f32_16x16x32_bf16 v[136:139], v[72:75], v[40:43], v[136:139]
    ds_read_b64_tr_b16 v[92:93], v13 offset:35840
    v_mfma_f32_16x16x32_bf16 v[140:143], v[72:75], v[44:47], v[140:143]
    ds_read_b64_tr_b16 v[94:95], v13 offset:36096
    v_mfma_f32_16x16x32_bf16 v[156:159], v[76:79], v[44:47], v[156:159]
    v_mfma_f32_16x16x32_bf16 v[152:155], v[76:79], v[40:43], v[152:155]
    v_mfma_f32_16x16x32_bf16 v[148:151], v[76:79], v[36:39], v[148:151]
    v_mfma_f32_16x16x32_bf16 v[144:147], v[76:79], v[32:35], v[144:147]
    s_waitcnt lgkmcnt(0)
    s_barrier
    v_mfma_f32_16x16x32_bf16 v[96:99], v[80:83], v[48:51], v[96:99]
    v_mfma_f32_16x16x32_bf16 v[100:103], v[80:83], v[52:55], v[100:103]
    v_mfma_f32_16x16x32_bf16 v[104:107], v[80:83], v[56:59], v[104:107]
    v_mfma_f32_16x16x32_bf16 v[108:111], v[80:83], v[60:63], v[108:111]
    v_mfma_f32_16x16x32_bf16 v[124:127], v[84:87], v[60:63], v[124:127]
    v_mfma_f32_16x16x32_bf16 v[120:123], v[84:87], v[56:59], v[120:123]
    v_mfma_f32_16x16x32_bf16 v[116:119], v[84:87], v[52:55], v[116:119]
    v_mfma_f32_16x16x32_bf16 v[112:115], v[84:87], v[48:51], v[112:115]
    v_mfma_f32_16x16x32_bf16 v[128:131], v[88:91], v[48:51], v[128:131]
    v_mfma_f32_16x16x32_bf16 v[132:135], v[88:91], v[52:55], v[132:135]
    v_mfma_f32_16x16x32_bf16 v[136:139], v[88:91], v[56:59], v[136:139]
    v_mfma_f32_16x16x32_bf16 v[140:143], v[88:91], v[60:63], v[140:143]
    v_mfma_f32_16x16x32_bf16 v[156:159], v[92:95], v[60:63], v[156:159]
    v_mfma_f32_16x16x32_bf16 v[152:155], v[92:95], v[56:59], v[152:155]
    v_mfma_f32_16x16x32_bf16 v[148:151], v[92:95], v[52:55], v[148:151]
    v_mfma_f32_16x16x32_bf16 v[144:147], v[92:95], v[48:51], v[144:147]
    s_lshl_b32 s42, s28, 13
    v_add_u32 v2, s42, v14
    s_xor_b32 s42, s28, 4
    s_lshl_b32 s42, s42, 13
    v_add_u32 v3, s42, v14
    s_cmp_eq_u32 s31, 0
    s_cbranch_scc0 L_s2_kernel_k1
    ds_write_b128 v2, v[104:107] offset:0
    ds_write_b128 v2, v[108:111] offset:1024
    ds_write_b128 v2, v[120:123] offset:2048
    ds_write_b128 v2, v[124:127] offset:3072
    ds_write_b128 v2, v[136:139] offset:4096
    ds_write_b128 v2, v[140:143] offset:5120
    ds_write_b128 v2, v[152:155] offset:6144
    ds_write_b128 v2, v[156:159] offset:7168
    v_mov_b32 v32, v96
    v_mov_b32 v33, v97
    v_mov_b32 v34, v98
    v_mov_b32 v35, v99
    v_mov_b32 v36, v100
    v_mov_b32 v37, v101
    v_mov_b32 v38, v102
    v_mov_b32 v39, v103
    v_mov_b32 v40, v112
    v_mov_b32 v41, v113
    v_mov_b32 v42, v114
    v_mov_b32 v43, v115
    v_mov_b32 v44, v116
    v_mov_b32 v45, v117
    v_mov_b32 v46, v118
    v_mov_b32 v47, v119
    v_mov_b32 v48, v128
    v_mov_b32 v49, v129
    v_mov_b32 v50, v130
    v_mov_b32 v51, v131
    v_mov_b32 v52, v132
    v_mov_b32 v53, v133
    v_mov_b32 v54, v134
    v_mov_b32 v55, v135
    v_mov_b32 v56, v144
    v_mov_b32 v57, v145
    v_mov_b32 v58, v146
    v_mov_b32 v59, v147
    v_mov_b32 v60, v148
    v_mov_b32 v61, v149
    v_mov_b32 v62, v150
    v_mov_b32 v63, v151
    s_branch L_s2_kernel_kj
L_s2_kernel_k1:
    ds_write_b128 v2, v[96:99] offset:0
    ds_write_b128 v2, v[100:103] offset:1024
    ds_write_b128 v2, v[112:115] offset:2048
    ds_write_b128 v2, v[116:119] offset:3072
    ds_write_b128 v2, v[128:131] offset:4096
    ds_write_b128 v2, v[132:135] offset:5120
    ds_write_b128 v2, v[144:147] offset:6144
    ds_write_b128 v2, v[148:151] offset:7168
    v_mov_b32 v32, v104
    v_mov_b32 v33, v105
    v_mov_b32 v34, v106
    v_mov_b32 v35, v107
    v_mov_b32 v36, v108
    v_mov_b32 v37, v109
    v_mov_b32 v38, v110
    v_mov_b32 v39, v111
    v_mov_b32 v40, v120
    v_mov_b32 v41, v121
    v_mov_b32 v42, v122
    v_mov_b32 v43, v123
    v_mov_b32 v44, v124
    v_mov_b32 v45, v125
    v_mov_b32 v46, v126
    v_mov_b32 v47, v127
    v_mov_b32 v48, v136
    v_mov_b32 v49, v137
    v_mov_b32 v50, v138
    v_mov_b32 v51, v139
    v_mov_b32 v52, v140
    v_mov_b32 v53, v141
    v_mov_b32 v54, v142
    v_mov_b32 v55, v143
    v_mov_b32 v56, v152
    v_mov_b32 v57, v153
    v_mov_b32 v58, v154
    v_mov_b32 v59, v155
    v_mov_b32 v60, v156
    v_mov_b32 v61, v157
    v_mov_b32 v62, v158
    v_mov_b32 v63, v159
L_s2_kernel_kj:
    s_waitcnt lgkmcnt(0)
    s_barrier
    ds_read_b128 v[64:67], v3 offset:0
    ds_read_b128 v[68:71], v3 offset:1024
    ds_read_b128 v[72:75], v3 offset:2048
    ds_read_b128 v[76:79], v3 offset:3072
    ds_read_b128 v[80:83], v3 offset:4096
    ds_read_b128 v[84:87], v3 offset:5120
    ds_read_b128 v[88:91], v3 offset:6144
    ds_read_b128 v[92:95], v3 offset:7168
    s_waitcnt vmcnt(0)
    v_sub_f32 v20, 1.0, v16
    v_lshlrev_b32 v18, 16, v18
    v_mov_b32 v21, v20
    v_mul_f32 v24, v18, v20
    v_mov_b32 v25, v24
    v_sub_f32 v22, 1.0, v17
    v_lshlrev_b32 v19, 16, v19
    v_mov_b32 v23, v22
    v_mul_f32 v26, v19, v22
    v_mov_b32 v27, v26
    s_waitcnt lgkmcnt(0)
    v_pk_add_f32 v[32:33], v[32:33], v[64:65]
    v_pk_add_f32 v[34:35], v[34:35], v[66:67]
    v_pk_add_f32 v[36:37], v[36:37], v[68:69]
    v_pk_add_f32 v[38:39], v[38:39], v[70:71]
    v_pk_add_f32 v[40:41], v[40:41], v[72:73]
    v_pk_add_f32 v[42:43], v[42:43], v[74:75]
    v_pk_add_f32 v[44:45], v[44:45], v[76:77]
    v_pk_add_f32 v[46:47], v[46:47], v[78:79]
    v_pk_add_f32 v[48:49], v[48:49], v[80:81]
    v_pk_add_f32 v[50:51], v[50:51], v[82:83]
    v_pk_add_f32 v[52:53], v[52:53], v[84:85]
    v_pk_add_f32 v[54:55], v[54:55], v[86:87]
    v_pk_add_f32 v[56:57], v[56:57], v[88:89]
    v_pk_add_f32 v[58:59], v[58:59], v[90:91]
    v_pk_add_f32 v[60:61], v[60:61], v[92:93]
    v_pk_add_f32 v[62:63], v[62:63], v[94:95]
    v_pk_fma_f32 v[32:33], v[32:33], v[20:21], v[24:25]
    v_lshlrev_b32 v28, 16, v160
    v_and_b32 v29, 0xffff0000, v160
    v_pk_mul_f32 v[32:33], v[32:33], v[28:29]
    v_pk_fma_f32 v[34:35], v[34:35], v[20:21], v[24:25]
    v_lshlrev_b32 v30, 16, v161
    v_and_b32 v31, 0xffff0000, v161
    v_pk_mul_f32 v[34:35], v[34:35], v[30:31]
    v_pk_fma_f32 v[36:37], v[36:37], v[22:23], v[26:27]
    v_lshlrev_b32 v28, 16, v162
    v_and_b32 v29, 0xffff0000, v162
    v_pk_mul_f32 v[36:37], v[36:37], v[28:29]
    v_pk_fma_f32 v[38:39], v[38:39], v[22:23], v[26:27]
    v_lshlrev_b32 v30, 16, v163
    v_and_b32 v31, 0xffff0000, v163
    v_pk_mul_f32 v[38:39], v[38:39], v[30:31]
    v_pk_fma_f32 v[40:41], v[40:41], v[20:21], v[24:25]
    v_lshlrev_b32 v28, 16, v164
    v_and_b32 v29, 0xffff0000, v164
    v_pk_mul_f32 v[40:41], v[40:41], v[28:29]
    v_pk_fma_f32 v[42:43], v[42:43], v[20:21], v[24:25]
    v_lshlrev_b32 v30, 16, v165
    v_and_b32 v31, 0xffff0000, v165
    v_pk_mul_f32 v[42:43], v[42:43], v[30:31]
    v_pk_fma_f32 v[44:45], v[44:45], v[22:23], v[26:27]
    v_lshlrev_b32 v28, 16, v166
    v_and_b32 v29, 0xffff0000, v166
    v_pk_mul_f32 v[44:45], v[44:45], v[28:29]
    v_pk_fma_f32 v[46:47], v[46:47], v[22:23], v[26:27]
    v_lshlrev_b32 v30, 16, v167
    v_and_b32 v31, 0xffff0000, v167
    v_pk_mul_f32 v[46:47], v[46:47], v[30:31]
    v_pk_fma_f32 v[48:49], v[48:49], v[20:21], v[24:25]
    v_lshlrev_b32 v28, 16, v168
    v_and_b32 v29, 0xffff0000, v168
    v_pk_mul_f32 v[48:49], v[48:49], v[28:29]
    v_pk_fma_f32 v[50:51], v[50:51], v[20:21], v[24:25]
    v_lshlrev_b32 v30, 16, v169
    v_and_b32 v31, 0xffff0000, v169
    v_pk_mul_f32 v[50:51], v[50:51], v[30:31]
    v_pk_fma_f32 v[52:53], v[52:53], v[22:23], v[26:27]
    v_lshlrev_b32 v28, 16, v170
    v_and_b32 v29, 0xffff0000, v170
    v_pk_mul_f32 v[52:53], v[52:53], v[28:29]
    v_pk_fma_f32 v[54:55], v[54:55], v[22:23], v[26:27]
    v_lshlrev_b32 v30, 16, v171
    v_and_b32 v31, 0xffff0000, v171
    v_pk_mul_f32 v[54:55], v[54:55], v[30:31]
    v_pk_fma_f32 v[56:57], v[56:57], v[20:21], v[24:25]
    v_lshlrev_b32 v28, 16, v172
    v_and_b32 v29, 0xffff0000, v172
    v_pk_mul_f32 v[56:57], v[56:57], v[28:29]
    v_pk_fma_f32 v[58:59], v[58:59], v[20:21], v[24:25]
    v_lshlrev_b32 v30, 16, v173
    v_and_b32 v31, 0xffff0000, v173
    v_pk_mul_f32 v[58:59], v[58:59], v[30:31]
    v_pk_fma_f32 v[60:61], v[60:61], v[22:23], v[26:27]
    v_lshlrev_b32 v28, 16, v174
    v_and_b32 v29, 0xffff0000, v174
    v_pk_mul_f32 v[60:61], v[60:61], v[28:29]
    v_pk_fma_f32 v[62:63], v[62:63], v[22:23], v[26:27]
    v_lshlrev_b32 v30, 16, v175
    v_and_b32 v31, 0xffff0000, v175
    v_pk_mul_f32 v[62:63], v[62:63], v[30:31]
    s_lshl_b32 s42, s32, 3
    s_lshl_b32 s43, s29, 2
    s_add_u32 s42, s42, s43
    s_lshl_b32 s43, s31, 1
    s_add_u32 s42, s42, s43
    s_mul_i32 s42, s42, 88
    s_lshl_b32 s43, s33, 2
    s_add_u32 s42, s42, s43
    s_lshl_b32 s43, s30, 1
    s_add_u32 s42, s42, s43
    s_add_u32 s42, s42, 32
    s_lshl_b32 s42, s42, 10
    s_add_u32 s42, s42, 0
    v_cvt_pk_bf16_f32 v64, v32, v33
    v_cvt_pk_bf16_f32 v65, v34, v35
    v_cvt_pk_bf16_f32 v66, v40, v41
    v_cvt_pk_bf16_f32 v67, v42, v43
    buffer_store_dwordx4 v[64:67], v14, s[20:23], s42 offen offset:0 sc1
    v_cvt_pk_bf16_f32 v68, v48, v49
    v_cvt_pk_bf16_f32 v69, v50, v51
    v_cvt_pk_bf16_f32 v70, v56, v57
    v_cvt_pk_bf16_f32 v71, v58, v59
    buffer_store_dwordx4 v[68:71], v14, s[20:23], s42 offen offset:1024 sc1
    s_add_u32 s42, s42, 90112
    v_cvt_pk_bf16_f32 v72, v36, v37
    v_cvt_pk_bf16_f32 v73, v38, v39
    v_cvt_pk_bf16_f32 v74, v44, v45
    v_cvt_pk_bf16_f32 v75, v46, v47
    buffer_store_dwordx4 v[72:75], v14, s[20:23], s42 offen offset:0 sc1
    v_cvt_pk_bf16_f32 v76, v52, v53
    v_cvt_pk_bf16_f32 v77, v54, v55
    v_cvt_pk_bf16_f32 v78, v60, v61
    v_cvt_pk_bf16_f32 v79, v62, v63
    buffer_store_dwordx4 v[76:79], v14, s[20:23], s42 offen offset:1024 sc1
    s_branch L_s2_kernel_fin
L_s2_kernel_att:
    s_lshl_b32 s40, s40, 2
    s_sub_u32 s41, s41, 28
    s_add_u32 s32, s40, s41
    s_mov_b32 s24, s4
    s_mov_b32 s25, s5
    s_mov_b32 s26, 65536
    s_mov_b32 s27, 0x20000
    s_and_b32 s40, s28, 1
    s_lshl_b32 s40, s40, 10
    s_lshl_b32 s41, s32, 11
    s_add_u32 s41, s41, s40
    s_add_u32 m0, s40, 0
    s_nop 0
    buffer_load_dwordx4 v14, s[24:27], s41 offen lds
    s_lshl_b32 s35, s32, 7
    s_lshl_b32 s40, s28, 4
    s_add_u32 s35, s35, s40
    s_lshl_b32 s35, s35, 10
    s_add_u32 s35, s35, 11534336
    s_lshl_b32 s36, s28, 10
    s_add_u32 s36, s36, 33816576
    v_and_b32 v5, 15, v1
    v_lshlrev_b32 v5, 2, v5
    s_lshl_b32 s37, s28, 4
    s_mul_i32 s37, s37, 88
    s_add_u32 s37, s37, s32
    s_lshl_b32 s37, s37, 10
    s_add_u32 s37, s37, 0
    s_cmp_ge_u32 s28, 6
    s_cbranch_scc1 L_s2_kernel_nokv
    s_cmp_ge_u32 s28, 3
    s_cselect_b32 s40, 1, 0
    s_mul_i32 s41, s40, 3
    s_sub_u32 s41, s28, s41
    s_mul_i32 s40, s40, 6
    s_add_u32 s40, s40, s41
    s_mul_i32 s41, s32, 12
    s_add_u32 s40, s40, s41
    s_lshl_b32 s40, s40, 10
    s_add_u32 s40, s40, 30408704
    buffer_load_dwordx4 v[32:35], v14, s[20:23], s40 offen offset:0
    buffer_load_dwordx4 v[36:39], v14, s[20:23], s40 offen offset:3072
    s_add_u32 s40, s40, 393216
    buffer_load_dwordx4 v[40:43], v14, s[20:23], s40 offen offset:0
    buffer_load_dwordx4 v[44:47], v14, s[20:23], s40 offen offset:3072
    s_add_u32 s40, s40, 393216
    buffer_load_dwordx4 v[48:51], v14, s[20:23], s40 offen offset:0
    buffer_load_dwordx4 v[52:55], v14, s[20:23], s40 offen offset:3072
    s_add_u32 s40, s40, 393216
    buffer_load_dwordx4 v[56:59], v14, s[20:23], s40 offen offset:0
    buffer_load_dwordx4 v[60:63], v14, s[20:23], s40 offen offset:3072
    s_add_u32 s40, s40, 393216
    buffer_load_dwordx4 v[64:67], v14, s[20:23], s40 offen offset:0
    buffer_load_dwordx4 v[68:71], v14, s[20:23], s40 offen offset:3072
    s_add_u32 s40, s40, 393216
    buffer_load_dwordx4 v[72:75], v14, s[20:23], s40 offen offset:0
    buffer_load_dwordx4 v[76:79], v14, s[20:23], s40 offen offset:3072
    s_add_u32 s40, s40, 393216
    buffer_load_dwordx4 v[80:83], v14, s[20:23], s40 offen offset:0
    buffer_load_dwordx4 v[84:87], v14, s[20:23], s40 offen offset:3072
    s_add_u32 s40, s40, 393216
    buffer_load_dwordx4 v[88:91], v14, s[20:23], s40 offen offset:0
    buffer_load_dwordx4 v[92:95], v14, s[20:23], s40 offen offset:3072
    s_add_u32 s40, s40, 393216
    s_waitcnt vmcnt(0)
    v_pk_add_f32 v[32:33], v[32:33], v[64:65]
    v_pk_add_f32 v[34:35], v[34:35], v[66:67]
    v_pk_add_f32 v[36:37], v[36:37], v[68:69]
    v_pk_add_f32 v[38:39], v[38:39], v[70:71]
    v_pk_add_f32 v[40:41], v[40:41], v[72:73]
    v_pk_add_f32 v[42:43], v[42:43], v[74:75]
    v_pk_add_f32 v[44:45], v[44:45], v[76:77]
    v_pk_add_f32 v[46:47], v[46:47], v[78:79]
    v_pk_add_f32 v[48:49], v[48:49], v[80:81]
    v_pk_add_f32 v[50:51], v[50:51], v[82:83]
    v_pk_add_f32 v[52:53], v[52:53], v[84:85]
    v_pk_add_f32 v[54:55], v[54:55], v[86:87]
    v_pk_add_f32 v[56:57], v[56:57], v[88:89]
    v_pk_add_f32 v[58:59], v[58:59], v[90:91]
    v_pk_add_f32 v[60:61], v[60:61], v[92:93]
    v_pk_add_f32 v[62:63], v[62:63], v[94:95]
    v_pk_add_f32 v[32:33], v[32:33], v[48:49]
    v_pk_add_f32 v[34:35], v[34:35], v[50:51]
    v_pk_add_f32 v[36:37], v[36:37], v[52:53]
    v_pk_add_f32 v[38:39], v[38:39], v[54:55]
    v_pk_add_f32 v[40:41], v[40:41], v[56:57]
    v_pk_add_f32 v[42:43], v[42:43], v[58:59]
    v_pk_add_f32 v[44:45], v[44:45], v[60:61]
    v_pk_add_f32 v[46:47], v[46:47], v[62:63]
    v_pk_add_f32 v[32:33], v[32:33], v[40:41]
    v_pk_add_f32 v[34:35], v[34:35], v[42:43]
    v_pk_add_f32 v[36:37], v[36:37], v[44:45]
    v_pk_add_f32 v[38:39], v[38:39], v[46:47]
    v_cvt_pk_bf16_f32 v40, v32, v33
    v_cvt_pk_bf16_f32 v41, v34, v35
    v_cvt_pk_bf16_f32 v42, v36, v37
    v_cvt_pk_bf16_f32 v43, v38, v39
    s_lshl_b32 s40, s28, 10
    s_add_u32 s40, s40, 2048
    v_add_u32 v2, s40, v14
    ds_write_b128 v2, v[40:43]
L_s2_kernel_nokv:
    s_waitcnt vmcnt(0) lgkmcnt(0)
    buffer_load_dwordx4 v[112:115], v14, s[20:23], s35 offen
    buffer_load_dword v128, v5, s[20:23], s36 offen
    s_add_u32 s35, s35, 1024
    s_add_u32 s36, s36, 64
    buffer_load_dwordx4 v[116:119], v14, s[20:23], s35 offen
    buffer_load_dword v129, v5, s[20:23], s36 offen
    s_add_u32 s35, s35, 1024
    s_add_u32 s36, s36, 64
    buffer_load_dwordx4 v[120:123], v14, s[20:23], s35 offen
    buffer_load_dword v130, v5, s[20:23], s36 offen
    s_add_u32 s35, s35, 1024
    s_add_u32 s36, s36, 64
    s_barrier
    v_lshrrev_b32 v2, 2, v1
    v_lshlrev_b32 v2, 6, v2
    v_and_b32 v3, 3, v1
    v_lshlrev_b32 v3, 3, v3
    v_add_u32 v2, v2, v3
    ds_read_b64_tr_b16 v[32:33], v2 offset:0
    ds_read_b64_tr_b16 v[34:35], v2 offset:1024
    ds_read_b64_tr_b16 v[36:37], v2 offset:32
    ds_read_b64_tr_b16 v[38:39], v2 offset:1056
    ds_read_b128 v[40:43], v14 offset:2048
    ds_read_b128 v[44:47], v14 offset:3072
    ds_read_b128 v[48:51], v14 offset:4096
    ds_read_b128 v[52:55], v14 offset:5120
    ds_read_b128 v[56:59], v14 offset:6144
    ds_read_b128 v[60:63], v14 offset:7168
    s_waitcnt lgkmcnt(0)
    v_mov_b32 v24, 0x3f803f80
    v_mov_b32 v25, 0x3f803f80
    v_mov_b32 v26, 0x3f803f80
    v_mov_b32 v27, 0x3f803f80
    v_mov_b32 v28, 0x358637bd
    s_mov_b32 s34, 0
.p2align 6
L_s2_kernel_aloop:
    buffer_load_dwordx4 v[124:127], v14, s[20:23], s35 offen
    buffer_load_dword v131, v5, s[20:23], s36 offen
    s_add_u32 s35, s35, 1024
    s_add_u32 s36, s36, 64
    s_waitcnt vmcnt(6)
    v_mfma_f32_16x16x32_bf16 v[64:67], v[32:35], v[112:115], 0
    v_mfma_f32_16x16x32_bf16 v[68:71], v[36:39], v[112:115], 0
    s_nop 6
    v_max3_f32 v80, v64, v65, v66
    v_min3_f32 v81, v64, v65, v66
    v_max3_f32 v80, v80, v67, v68
    v_min3_f32 v81, v81, v67, v68
    v_max3_f32 v80, v80, v69, v70
    v_min3_f32 v81, v81, v69, v70
    v_max_f32 v80, v80, v71
    v_min_f32 v81, v81, v71
    v_sub_f32 v81, 0, v81
    v_mov_b32 v82, v80
    v_mov_b32 v83, v81
    s_nop 0
    v_permlane16_swap_b32 v80, v82
    v_permlane16_swap_b32 v81, v83
    v_max_f32 v80, v80, v82
    v_max_f32 v81, v81, v83
    v_mov_b32 v82, v80
    v_mov_b32 v83, v81
    s_nop 0
    v_permlane32_swap_b32 v80, v82
    v_permlane32_swap_b32 v81, v83
    v_max_f32 v80, v80, v82
    v_max_f32 v81, v81, v83
    v_mul_f32 v84, 0xbfb8aa3b, v80
    v_mul_f32 v85, 0xbfb8aa3b, v80
    v_mul_f32 v86, 0xbfb8aa3b, v81
    v_mul_f32 v87, 0xbfb8aa3b, v81
    v_mov_b32 v88, 0x3fb8aa3b
    v_mov_b32 v89, 0x3fb8aa3b
    v_mov_b32 v90, 0xbfb8aa3b
    v_mov_b32 v91, 0xbfb8aa3b
    v_pk_fma_f32 v[92:93], v[64:65], v[88:89], v[84:85]
    v_pk_fma_f32 v[100:101], v[64:65], v[90:91], v[86:87]
    v_pk_fma_f32 v[94:95], v[66:67], v[88:89], v[84:85]
    v_pk_fma_f32 v[102:103], v[66:67], v[90:91], v[86:87]
    v_pk_fma_f32 v[96:97], v[68:69], v[88:89], v[84:85]
    v_pk_fma_f32 v[104:105], v[68:69], v[90:91], v[86:87]
    v_pk_fma_f32 v[98:99], v[70:71], v[88:89], v[84:85]
    v_pk_fma_f32 v[106:107], v[70:71], v[90:91], v[86:87]
    v_exp_f32 v92, v92
    v_exp_f32 v100, v100
    v_exp_f32 v93, v93
    v_exp_f32 v101, v101
    v_exp_f32 v94, v94
    v_exp_f32 v102, v102
    v_exp_f32 v95, v95
    v_exp_f32 v103, v103
    v_exp_f32 v96, v96
    v_exp_f32 v104, v104
    v_exp_f32 v97, v97
    v_exp_f32 v105, v105
    v_exp_f32 v98, v98
    v_exp_f32 v106, v106
    v_exp_f32 v99, v99
    v_exp_f32 v107, v107
    v_cvt_pk_bf16_f32 v72, v92, v93
    v_cvt_pk_bf16_f32 v76, v100, v101
    v_cvt_pk_bf16_f32 v73, v94, v95
    v_cvt_pk_bf16_f32 v77, v102, v103
    v_cvt_pk_bf16_f32 v74, v96, v97
    v_cvt_pk_bf16_f32 v78, v104, v105
    v_cvt_pk_bf16_f32 v75, v98, v99
    v_cvt_pk_bf16_f32 v79, v106, v107
    s_nop 0
    v_mfma_f32_16x16x32_bf16 v[80:83], v[40:43], v[72:75], 0
    v_mfma_f32_16x16x32_bf16 v[84:87], v[44:47], v[72:75], 0
    v_mfma_f32_16x16x32_bf16 v[88:91], v[48:51], v[72:75], 0
    v_mfma_f32_16x16x32_bf16 v[92:95], v[24:27], v[72:75], 0
    v_mfma_f32_16x16x32_bf16 v[96:99], v[52:55], v[76:79], 0
    v_mfma_f32_16x16x32_bf16 v[100:103], v[56:59], v[76:79], 0
    v_mfma_f32_16x16x32_bf16 v[104:107], v[60:63], v[76:79], 0
    v_mfma_f32_16x16x32_bf16 v[108:111], v[24:27], v[76:79], 0
    s_nop 3
    v_rcp_f32 v92, v92
    s_nop 2
    v_rcp_f32 v108, v108
    v_fma_f32 v88, v88, v92, v28
    v_fma_f32 v88, v104, v108, v88
    v_rcp_f32 v88, v88
    s_nop 0
    v_mul_f32 v88, v88, v128
    v_mul_f32 v92, v92, v88
    v_mul_f32 v93, v92, 1.0
    v_mul_f32 v108, v108, v88
    v_mul_f32 v109, v108, 1.0
    v_pk_mul_f32 v[132:133], v[80:81], v[92:93]
    v_pk_mul_f32 v[134:135], v[82:83], v[92:93]
    v_pk_mul_f32 v[136:137], v[84:85], v[92:93]
    v_pk_mul_f32 v[138:139], v[86:87], v[92:93]
    v_pk_fma_f32 v[132:133], v[96:97], v[108:109], v[132:133]
    v_pk_fma_f32 v[134:135], v[98:99], v[108:109], v[134:135]
    v_pk_fma_f32 v[136:137], v[100:101], v[108:109], v[136:137]
    v_pk_fma_f32 v[138:139], v[102:103], v[108:109], v[138:139]
    v_cvt_pk_bf16_f32 v144, v132, v133
    v_cvt_pk_bf16_f32 v145, v134, v135
    v_cvt_pk_bf16_f32 v146, v136, v137
    v_cvt_pk_bf16_f32 v147, v138, v139
    buffer_store_dwordx4 v[144:147], v14, s[20:23], s37 offen sc1
    s_add_u32 s37, s37, 90112
    buffer_load_dwordx4 v[112:115], v14, s[20:23], s35 offen
    buffer_load_dword v128, v5, s[20:23], s36 offen
    s_add_u32 s35, s35, 1024
    s_add_u32 s36, s36, 64
    s_waitcnt vmcnt(7)
    v_mfma_f32_16x16x32_bf16 v[64:67], v[32:35], v[116:119], 0
    v_mfma_f32_16x16x32_bf16 v[68:71], v[36:39], v[116:119], 0
    s_nop 6
    v_max3_f32 v80, v64, v65, v66
    v_min3_f32 v81, v64, v65, v66
    v_max3_f32 v80, v80, v67, v68
    v_min3_f32 v81, v81, v67, v68
    v_max3_f32 v80, v80, v69, v70
    v_min3_f32 v81, v81, v69, v70
    v_max_f32 v80, v80, v71
    v_min_f32 v81, v81, v71
    v_sub_f32 v81, 0, v81
    v_mov_b32 v82, v80
    v_mov_b32 v83, v81
    s_nop 0
    v_permlane16_swap_b32 v80, v82
    v_permlane16_swap_b32 v81, v83
    v_max_f32 v80, v80, v82
    v_max_f32 v81, v81, v83
    v_mov_b32 v82, v80
    v_mov_b32 v83, v81
    s_nop 0
    v_permlane32_swap_b32 v80, v82
    v_permlane32_swap_b32 v81, v83
    v_max_f32 v80, v80, v82
    v_max_f32 v81, v81, v83
    v_mul_f32 v84, 0xbfb8aa3b, v80
    v_mul_f32 v85, 0xbfb8aa3b, v80
    v_mul_f32 v86, 0xbfb8aa3b, v81
    v_mul_f32 v87, 0xbfb8aa3b, v81
    v_mov_b32 v88, 0x3fb8aa3b
    v_mov_b32 v89, 0x3fb8aa3b
    v_mov_b32 v90, 0xbfb8aa3b
    v_mov_b32 v91, 0xbfb8aa3b
    v_pk_fma_f32 v[92:93], v[64:65], v[88:89], v[84:85]
    v_pk_fma_f32 v[100:101], v[64:65], v[90:91], v[86:87]
    v_pk_fma_f32 v[94:95], v[66:67], v[88:89], v[84:85]
    v_pk_fma_f32 v[102:103], v[66:67], v[90:91], v[86:87]
    v_pk_fma_f32 v[96:97], v[68:69], v[88:89], v[84:85]
    v_pk_fma_f32 v[104:105], v[68:69], v[90:91], v[86:87]
    v_pk_fma_f32 v[98:99], v[70:71], v[88:89], v[84:85]
    v_pk_fma_f32 v[106:107], v[70:71], v[90:91], v[86:87]
    v_exp_f32 v92, v92
    v_exp_f32 v100, v100
    v_exp_f32 v93, v93
    v_exp_f32 v101, v101
    v_exp_f32 v94, v94
    v_exp_f32 v102, v102
    v_exp_f32 v95, v95
    v_exp_f32 v103, v103
    v_exp_f32 v96, v96
    v_exp_f32 v104, v104
    v_exp_f32 v97, v97
    v_exp_f32 v105, v105
    v_exp_f32 v98, v98
    v_exp_f32 v106, v106
    v_exp_f32 v99, v99
    v_exp_f32 v107, v107
    v_cvt_pk_bf16_f32 v72, v92, v93
    v_cvt_pk_bf16_f32 v76, v100, v101
    v_cvt_pk_bf16_f32 v73, v94, v95
    v_cvt_pk_bf16_f32 v77, v102, v103
    v_cvt_pk_bf16_f32 v74, v96, v97
    v_cvt_pk_bf16_f32 v78, v104, v105
    v_cvt_pk_bf16_f32 v75, v98, v99
    v_cvt_pk_bf16_f32 v79, v106, v107
    s_nop 0
    v_mfma_f32_16x16x32_bf16 v[80:83], v[40:43], v[72:75], 0
    v_mfma_f32_16x16x32_bf16 v[84:87], v[44:47], v[72:75], 0
    v_mfma_f32_16x16x32_bf16 v[88:91], v[48:51], v[72:75], 0
    v_mfma_f32_16x16x32_bf16 v[92:95], v[24:27], v[72:75], 0
    v_mfma_f32_16x16x32_bf16 v[96:99], v[52:55], v[76:79], 0
    v_mfma_f32_16x16x32_bf16 v[100:103], v[56:59], v[76:79], 0
    v_mfma_f32_16x16x32_bf16 v[104:107], v[60:63], v[76:79], 0
    v_mfma_f32_16x16x32_bf16 v[108:111], v[24:27], v[76:79], 0
    s_nop 3
    v_rcp_f32 v92, v92
    s_nop 2
    v_rcp_f32 v108, v108
    v_fma_f32 v88, v88, v92, v28
    v_fma_f32 v88, v104, v108, v88
    v_rcp_f32 v88, v88
    s_nop 0
    v_mul_f32 v88, v88, v129
    v_mul_f32 v92, v92, v88
    v_mul_f32 v93, v92, 1.0
    v_mul_f32 v108, v108, v88
    v_mul_f32 v109, v108, 1.0
    v_pk_mul_f32 v[132:133], v[80:81], v[92:93]
    v_pk_mul_f32 v[134:135], v[82:83], v[92:93]
    v_pk_mul_f32 v[136:137], v[84:85], v[92:93]
    v_pk_mul_f32 v[138:139], v[86:87], v[92:93]
    v_pk_fma_f32 v[132:133], v[96:97], v[108:109], v[132:133]
    v_pk_fma_f32 v[134:135], v[98:99], v[108:109], v[134:135]
    v_pk_fma_f32 v[136:137], v[100:101], v[108:109], v[136:137]
    v_pk_fma_f32 v[138:139], v[102:103], v[108:109], v[138:139]
    v_cvt_pk_bf16_f32 v148, v132, v133
    v_cvt_pk_bf16_f32 v149, v134, v135
    v_cvt_pk_bf16_f32 v150, v136, v137
    v_cvt_pk_bf16_f32 v151, v138, v139
    buffer_store_dwordx4 v[148:151], v14, s[20:23], s37 offen sc1
    s_add_u32 s37, s37, 90112
    buffer_load_dwordx4 v[116:119], v14, s[20:23], s35 offen
    buffer_load_dword v129, v5, s[20:23], s36 offen
    s_add_u32 s35, s35, 1024
    s_add_u32 s36, s36, 64
    s_waitcnt vmcnt(8)
    v_mfma_f32_16x16x32_bf16 v[64:67], v[32:35], v[120:123], 0
    v_mfma_f32_16x16x32_bf16 v[68:71], v[36:39], v[120:123], 0
    s_nop 6
    v_max3_f32 v80, v64, v65, v66
    v_min3_f32 v81, v64, v65, v66
    v_max3_f32 v80, v80, v67, v68
    v_min3_f32 v81, v81, v67, v68
    v_max3_f32 v80, v80, v69, v70
    v_min3_f32 v81, v81, v69, v70
    v_max_f32 v80, v80, v71
    v_min_f32 v81, v81, v71
    v_sub_f32 v81, 0, v81
    v_mov_b32 v82, v80
    v_mov_b32 v83, v81
    s_nop 0
    v_permlane16_swap_b32 v80, v82
    v_permlane16_swap_b32 v81, v83
    v_max_f32 v80, v80, v82
    v_max_f32 v81, v81, v83
    v_mov_b32 v82, v80
    v_mov_b32 v83, v81
    s_nop 0
    v_permlane32_swap_b32 v80, v82
    v_permlane32_swap_b32 v81, v83
    v_max_f32 v80, v80, v82
    v_max_f32 v81, v81, v83
    v_mul_f32 v84, 0xbfb8aa3b, v80
    v_mul_f32 v85, 0xbfb8aa3b, v80
    v_mul_f32 v86, 0xbfb8aa3b, v81
    v_mul_f32 v87, 0xbfb8aa3b, v81
    v_mov_b32 v88, 0x3fb8aa3b
    v_mov_b32 v89, 0x3fb8aa3b
    v_mov_b32 v90, 0xbfb8aa3b
    v_mov_b32 v91, 0xbfb8aa3b
    v_pk_fma_f32 v[92:93], v[64:65], v[88:89], v[84:85]
    v_pk_fma_f32 v[100:101], v[64:65], v[90:91], v[86:87]
    v_pk_fma_f32 v[94:95], v[66:67], v[88:89], v[84:85]
    v_pk_fma_f32 v[102:103], v[66:67], v[90:91], v[86:87]
    v_pk_fma_f32 v[96:97], v[68:69], v[88:89], v[84:85]
    v_pk_fma_f32 v[104:105], v[68:69], v[90:91], v[86:87]
    v_pk_fma_f32 v[98:99], v[70:71], v[88:89], v[84:85]
    v_pk_fma_f32 v[106:107], v[70:71], v[90:91], v[86:87]
    v_exp_f32 v92, v92
    v_exp_f32 v100, v100
    v_exp_f32 v93, v93
    v_exp_f32 v101, v101
    v_exp_f32 v94, v94
    v_exp_f32 v102, v102
    v_exp_f32 v95, v95
    v_exp_f32 v103, v103
    v_exp_f32 v96, v96
    v_exp_f32 v104, v104
    v_exp_f32 v97, v97
    v_exp_f32 v105, v105
    v_exp_f32 v98, v98
    v_exp_f32 v106, v106
    v_exp_f32 v99, v99
    v_exp_f32 v107, v107
    v_cvt_pk_bf16_f32 v72, v92, v93
    v_cvt_pk_bf16_f32 v76, v100, v101
    v_cvt_pk_bf16_f32 v73, v94, v95
    v_cvt_pk_bf16_f32 v77, v102, v103
    v_cvt_pk_bf16_f32 v74, v96, v97
    v_cvt_pk_bf16_f32 v78, v104, v105
    v_cvt_pk_bf16_f32 v75, v98, v99
    v_cvt_pk_bf16_f32 v79, v106, v107
    s_nop 0
    v_mfma_f32_16x16x32_bf16 v[80:83], v[40:43], v[72:75], 0
    v_mfma_f32_16x16x32_bf16 v[84:87], v[44:47], v[72:75], 0
    v_mfma_f32_16x16x32_bf16 v[88:91], v[48:51], v[72:75], 0
    v_mfma_f32_16x16x32_bf16 v[92:95], v[24:27], v[72:75], 0
    v_mfma_f32_16x16x32_bf16 v[96:99], v[52:55], v[76:79], 0
    v_mfma_f32_16x16x32_bf16 v[100:103], v[56:59], v[76:79], 0
    v_mfma_f32_16x16x32_bf16 v[104:107], v[60:63], v[76:79], 0
    v_mfma_f32_16x16x32_bf16 v[108:111], v[24:27], v[76:79], 0
    s_nop 3
    v_rcp_f32 v92, v92
    s_nop 2
    v_rcp_f32 v108, v108
    v_fma_f32 v88, v88, v92, v28
    v_fma_f32 v88, v104, v108, v88
    v_rcp_f32 v88, v88
    s_nop 0
    v_mul_f32 v88, v88, v130
    v_mul_f32 v92, v92, v88
    v_mul_f32 v93, v92, 1.0
    v_mul_f32 v108, v108, v88
    v_mul_f32 v109, v108, 1.0
    v_pk_mul_f32 v[132:133], v[80:81], v[92:93]
    v_pk_mul_f32 v[134:135], v[82:83], v[92:93]
    v_pk_mul_f32 v[136:137], v[84:85], v[92:93]
    v_pk_mul_f32 v[138:139], v[86:87], v[92:93]
    v_pk_fma_f32 v[132:133], v[96:97], v[108:109], v[132:133]
    v_pk_fma_f32 v[134:135], v[98:99], v[108:109], v[134:135]
    v_pk_fma_f32 v[136:137], v[100:101], v[108:109], v[136:137]
    v_pk_fma_f32 v[138:139], v[102:103], v[108:109], v[138:139]
    v_cvt_pk_bf16_f32 v144, v132, v133
    v_cvt_pk_bf16_f32 v145, v134, v135
    v_cvt_pk_bf16_f32 v146, v136, v137
    v_cvt_pk_bf16_f32 v147, v138, v139
    buffer_store_dwordx4 v[144:147], v14, s[20:23], s37 offen sc1
    s_add_u32 s37, s37, 90112
    buffer_load_dwordx4 v[120:123], v14, s[20:23], s35 offen
    buffer_load_dword v130, v5, s[20:23], s36 offen
    s_add_u32 s35, s35, 1024
    s_add_u32 s36, s36, 64
    s_waitcnt vmcnt(9)
    v_mfma_f32_16x16x32_bf16 v[64:67], v[32:35], v[124:127], 0
    v_mfma_f32_16x16x32_bf16 v[68:71], v[36:39], v[124:127], 0
    s_nop 6
    v_max3_f32 v80, v64, v65, v66
    v_min3_f32 v81, v64, v65, v66
    v_max3_f32 v80, v80, v67, v68
    v_min3_f32 v81, v81, v67, v68
    v_max3_f32 v80, v80, v69, v70
    v_min3_f32 v81, v81, v69, v70
    v_max_f32 v80, v80, v71
    v_min_f32 v81, v81, v71
    v_sub_f32 v81, 0, v81
    v_mov_b32 v82, v80
    v_mov_b32 v83, v81
    s_nop 0
    v_permlane16_swap_b32 v80, v82
    v_permlane16_swap_b32 v81, v83
    v_max_f32 v80, v80, v82
    v_max_f32 v81, v81, v83
    v_mov_b32 v82, v80
    v_mov_b32 v83, v81
    s_nop 0
    v_permlane32_swap_b32 v80, v82
    v_permlane32_swap_b32 v81, v83
    v_max_f32 v80, v80, v82
    v_max_f32 v81, v81, v83
    v_mul_f32 v84, 0xbfb8aa3b, v80
    v_mul_f32 v85, 0xbfb8aa3b, v80
    v_mul_f32 v86, 0xbfb8aa3b, v81
    v_mul_f32 v87, 0xbfb8aa3b, v81
    v_mov_b32 v88, 0x3fb8aa3b
    v_mov_b32 v89, 0x3fb8aa3b
    v_mov_b32 v90, 0xbfb8aa3b
    v_mov_b32 v91, 0xbfb8aa3b
    v_pk_fma_f32 v[92:93], v[64:65], v[88:89], v[84:85]
    v_pk_fma_f32 v[100:101], v[64:65], v[90:91], v[86:87]
    v_pk_fma_f32 v[94:95], v[66:67], v[88:89], v[84:85]
    v_pk_fma_f32 v[102:103], v[66:67], v[90:91], v[86:87]
    v_pk_fma_f32 v[96:97], v[68:69], v[88:89], v[84:85]
    v_pk_fma_f32 v[104:105], v[68:69], v[90:91], v[86:87]
    v_pk_fma_f32 v[98:99], v[70:71], v[88:89], v[84:85]
    v_pk_fma_f32 v[106:107], v[70:71], v[90:91], v[86:87]
    v_exp_f32 v92, v92
    v_exp_f32 v100, v100
    v_exp_f32 v93, v93
    v_exp_f32 v101, v101
    v_exp_f32 v94, v94
    v_exp_f32 v102, v102
    v_exp_f32 v95, v95
    v_exp_f32 v103, v103
    v_exp_f32 v96, v96
    v_exp_f32 v104, v104
    v_exp_f32 v97, v97
    v_exp_f32 v105, v105
    v_exp_f32 v98, v98
    v_exp_f32 v106, v106
    v_exp_f32 v99, v99
    v_exp_f32 v107, v107
    v_cvt_pk_bf16_f32 v72, v92, v93
    v_cvt_pk_bf16_f32 v76, v100, v101
    v_cvt_pk_bf16_f32 v73, v94, v95
    v_cvt_pk_bf16_f32 v77, v102, v103
    v_cvt_pk_bf16_f32 v74, v96, v97
    v_cvt_pk_bf16_f32 v78, v104, v105
    v_cvt_pk_bf16_f32 v75, v98, v99
    v_cvt_pk_bf16_f32 v79, v106, v107
    s_nop 0
    v_mfma_f32_16x16x32_bf16 v[80:83], v[40:43], v[72:75], 0
    v_mfma_f32_16x16x32_bf16 v[84:87], v[44:47], v[72:75], 0
    v_mfma_f32_16x16x32_bf16 v[88:91], v[48:51], v[72:75], 0
    v_mfma_f32_16x16x32_bf16 v[92:95], v[24:27], v[72:75], 0
    v_mfma_f32_16x16x32_bf16 v[96:99], v[52:55], v[76:79], 0
    v_mfma_f32_16x16x32_bf16 v[100:103], v[56:59], v[76:79], 0
    v_mfma_f32_16x16x32_bf16 v[104:107], v[60:63], v[76:79], 0
    v_mfma_f32_16x16x32_bf16 v[108:111], v[24:27], v[76:79], 0
    s_nop 3
    v_rcp_f32 v92, v92
    s_nop 2
    v_rcp_f32 v108, v108
    v_fma_f32 v88, v88, v92, v28
    v_fma_f32 v88, v104, v108, v88
    v_rcp_f32 v88, v88
    s_nop 0
    v_mul_f32 v88, v88, v131
    v_mul_f32 v92, v92, v88
    v_mul_f32 v93, v92, 1.0
    v_mul_f32 v108, v108, v88
    v_mul_f32 v109, v108, 1.0
    v_pk_mul_f32 v[132:133], v[80:81], v[92:93]
    v_pk_mul_f32 v[134:135], v[82:83], v[92:93]
    v_pk_mul_f32 v[136:137], v[84:85], v[92:93]
    v_pk_mul_f32 v[138:139], v[86:87], v[92:93]
    v_pk_fma_f32 v[132:133], v[96:97], v[108:109], v[132:133]
    v_pk_fma_f32 v[134:135], v[98:99], v[108:109], v[134:135]
    v_pk_fma_f32 v[136:137], v[100:101], v[108:109], v[136:137]
    v_pk_fma_f32 v[138:139], v[102:103], v[108:109], v[138:139]
    v_cvt_pk_bf16_f32 v148, v132, v133
    v_cvt_pk_bf16_f32 v149, v134, v135
    v_cvt_pk_bf16_f32 v150, v136, v137
    v_cvt_pk_bf16_f32 v151, v138, v139
    buffer_store_dwordx4 v[148:151], v14, s[20:23], s37 offen sc1
    s_add_u32 s37, s37, 90112
    s_add_u32 s34, s34, 1
    s_cmp_lt_u32 s34, 3
    s_cbranch_scc1 L_s2_kernel_aloop
    buffer_load_dwordx4 v[124:127], v14, s[20:23], s35 offen
    buffer_load_dword v131, v5, s[20:23], s36 offen
    s_add_u32 s35, s35, 1024
    s_add_u32 s36, s36, 64
    s_waitcnt vmcnt(9)
    v_mfma_f32_16x16x32_bf16 v[64:67], v[32:35], v[112:115], 0
    v_mfma_f32_16x16x32_bf16 v[68:71], v[36:39], v[112:115], 0
    s_nop 6
    v_max3_f32 v80, v64, v65, v66
    v_min3_f32 v81, v64, v65, v66
    v_max3_f32 v80, v80, v67, v68
    v_min3_f32 v81, v81, v67, v68
    v_max3_f32 v80, v80, v69, v70
    v_min3_f32 v81, v81, v69, v70
    v_max_f32 v80, v80, v71
    v_min_f32 v81, v81, v71
    v_sub_f32 v81, 0, v81
    v_mov_b32 v82, v80
    v_mov_b32 v83, v81
    s_nop 0
    v_permlane16_swap_b32 v80, v82
    v_permlane16_swap_b32 v81, v83
    v_max_f32 v80, v80, v82
    v_max_f32 v81, v81, v83
    v_mov_b32 v82, v80
    v_mov_b32 v83, v81
    s_nop 0
    v_permlane32_swap_b32 v80, v82
    v_permlane32_swap_b32 v81, v83
    v_max_f32 v80, v80, v82
    v_max_f32 v81, v81, v83
    v_mul_f32 v84, 0xbfb8aa3b, v80
    v_mul_f32 v85, 0xbfb8aa3b, v80
    v_mul_f32 v86, 0xbfb8aa3b, v81
    v_mul_f32 v87, 0xbfb8aa3b, v81
    v_mov_b32 v88, 0x3fb8aa3b
    v_mov_b32 v89, 0x3fb8aa3b
    v_mov_b32 v90, 0xbfb8aa3b
    v_mov_b32 v91, 0xbfb8aa3b
    v_pk_fma_f32 v[92:93], v[64:65], v[88:89], v[84:85]
    v_pk_fma_f32 v[100:101], v[64:65], v[90:91], v[86:87]
    v_pk_fma_f32 v[94:95], v[66:67], v[88:89], v[84:85]
    v_pk_fma_f32 v[102:103], v[66:67], v[90:91], v[86:87]
    v_pk_fma_f32 v[96:97], v[68:69], v[88:89], v[84:85]
    v_pk_fma_f32 v[104:105], v[68:69], v[90:91], v[86:87]
    v_pk_fma_f32 v[98:99], v[70:71], v[88:89], v[84:85]
    v_pk_fma_f32 v[106:107], v[70:71], v[90:91], v[86:87]
    v_exp_f32 v92, v92
    v_exp_f32 v100, v100
    v_exp_f32 v93, v93
    v_exp_f32 v101, v101
    v_exp_f32 v94, v94
    v_exp_f32 v102, v102
    v_exp_f32 v95, v95
    v_exp_f32 v103, v103
    v_exp_f32 v96, v96
    v_exp_f32 v104, v104
    v_exp_f32 v97, v97
    v_exp_f32 v105, v105
    v_exp_f32 v98, v98
    v_exp_f32 v106, v106
    v_exp_f32 v99, v99
    v_exp_f32 v107, v107
    v_cvt_pk_bf16_f32 v72, v92, v93
    v_cvt_pk_bf16_f32 v76, v100, v101
    v_cvt_pk_bf16_f32 v73, v94, v95
    v_cvt_pk_bf16_f32 v77, v102, v103
    v_cvt_pk_bf16_f32 v74, v96, v97
    v_cvt_pk_bf16_f32 v78, v104, v105
    v_cvt_pk_bf16_f32 v75, v98, v99
    v_cvt_pk_bf16_f32 v79, v106, v107
    s_nop 0
    v_mfma_f32_16x16x32_bf16 v[80:83], v[40:43], v[72:75], 0
    v_mfma_f32_16x16x32_bf16 v[84:87], v[44:47], v[72:75], 0
    v_mfma_f32_16x16x32_bf16 v[88:91], v[48:51], v[72:75], 0
    v_mfma_f32_16x16x32_bf16 v[92:95], v[24:27], v[72:75], 0
    v_mfma_f32_16x16x32_bf16 v[96:99], v[52:55], v[76:79], 0
    v_mfma_f32_16x16x32_bf16 v[100:103], v[56:59], v[76:79], 0
    v_mfma_f32_16x16x32_bf16 v[104:107], v[60:63], v[76:79], 0
    v_mfma_f32_16x16x32_bf16 v[108:111], v[24:27], v[76:79], 0
    s_nop 3
    v_rcp_f32 v92, v92
    s_nop 2
    v_rcp_f32 v108, v108
    v_fma_f32 v88, v88, v92, v28
    v_fma_f32 v88, v104, v108, v88
    v_rcp_f32 v88, v88
    s_nop 0
    v_mul_f32 v88, v88, v128
    v_mul_f32 v92, v92, v88
    v_mul_f32 v93, v92, 1.0
    v_mul_f32 v108, v108, v88
    v_mul_f32 v109, v108, 1.0
    v_pk_mul_f32 v[132:133], v[80:81], v[92:93]
    v_pk_mul_f32 v[134:135], v[82:83], v[92:93]
    v_pk_mul_f32 v[136:137], v[84:85], v[92:93]
    v_pk_mul_f32 v[138:139], v[86:87], v[92:93]
    v_pk_fma_f32 v[132:133], v[96:97], v[108:109], v[132:133]
    v_pk_fma_f32 v[134:135], v[98:99], v[108:109], v[134:135]
    v_pk_fma_f32 v[136:137], v[100:101], v[108:109], v[136:137]
    v_pk_fma_f32 v[138:139], v[102:103], v[108:109], v[138:139]
    v_cvt_pk_bf16_f32 v144, v132, v133
    v_cvt_pk_bf16_f32 v145, v134, v135
    v_cvt_pk_bf16_f32 v146, v136, v137
    v_cvt_pk_bf16_f32 v147, v138, v139
    buffer_store_dwordx4 v[144:147], v14, s[20:23], s37 offen sc1
    s_add_u32 s37, s37, 90112
    s_waitcnt vmcnt(7)
    v_mfma_f32_16x16x32_bf16 v[64:67], v[32:35], v[116:119], 0
    v_mfma_f32_16x16x32_bf16 v[68:71], v[36:39], v[116:119], 0
    s_nop 6
    v_max3_f32 v80, v64, v65, v66
    v_min3_f32 v81, v64, v65, v66
    v_max3_f32 v80, v80, v67, v68
    v_min3_f32 v81, v81, v67, v68
    v_max3_f32 v80, v80, v69, v70
    v_min3_f32 v81, v81, v69, v70
    v_max_f32 v80, v80, v71
    v_min_f32 v81, v81, v71
    v_sub_f32 v81, 0, v81
    v_mov_b32 v82, v80
    v_mov_b32 v83, v81
    s_nop 0
    v_permlane16_swap_b32 v80, v82
    v_permlane16_swap_b32 v81, v83
    v_max_f32 v80, v80, v82
    v_max_f32 v81, v81, v83
    v_mov_b32 v82, v80
    v_mov_b32 v83, v81
    s_nop 0
    v_permlane32_swap_b32 v80, v82
    v_permlane32_swap_b32 v81, v83
    v_max_f32 v80, v80, v82
    v_max_f32 v81, v81, v83
    v_mul_f32 v84, 0xbfb8aa3b, v80
    v_mul_f32 v85, 0xbfb8aa3b, v80
    v_mul_f32 v86, 0xbfb8aa3b, v81
    v_mul_f32 v87, 0xbfb8aa3b, v81
    v_mov_b32 v88, 0x3fb8aa3b
    v_mov_b32 v89, 0x3fb8aa3b
    v_mov_b32 v90, 0xbfb8aa3b
    v_mov_b32 v91, 0xbfb8aa3b
    v_pk_fma_f32 v[92:93], v[64:65], v[88:89], v[84:85]
    v_pk_fma_f32 v[100:101], v[64:65], v[90:91], v[86:87]
    v_pk_fma_f32 v[94:95], v[66:67], v[88:89], v[84:85]
    v_pk_fma_f32 v[102:103], v[66:67], v[90:91], v[86:87]
    v_pk_fma_f32 v[96:97], v[68:69], v[88:89], v[84:85]
    v_pk_fma_f32 v[104:105], v[68:69], v[90:91], v[86:87]
    v_pk_fma_f32 v[98:99], v[70:71], v[88:89], v[84:85]
    v_pk_fma_f32 v[106:107], v[70:71], v[90:91], v[86:87]
    v_exp_f32 v92, v92
    v_exp_f32 v100, v100
    v_exp_f32 v93, v93
    v_exp_f32 v101, v101
    v_exp_f32 v94, v94
    v_exp_f32 v102, v102
    v_exp_f32 v95, v95
    v_exp_f32 v103, v103
    v_exp_f32 v96, v96
    v_exp_f32 v104, v104
    v_exp_f32 v97, v97
    v_exp_f32 v105, v105
    v_exp_f32 v98, v98
    v_exp_f32 v106, v106
    v_exp_f32 v99, v99
    v_exp_f32 v107, v107
    v_cvt_pk_bf16_f32 v72, v92, v93
    v_cvt_pk_bf16_f32 v76, v100, v101
    v_cvt_pk_bf16_f32 v73, v94, v95
    v_cvt_pk_bf16_f32 v77, v102, v103
    v_cvt_pk_bf16_f32 v74, v96, v97
    v_cvt_pk_bf16_f32 v78, v104, v105
    v_cvt_pk_bf16_f32 v75, v98, v99
    v_cvt_pk_bf16_f32 v79, v106, v107
    s_nop 0
    v_mfma_f32_16x16x32_bf16 v[80:83], v[40:43], v[72:75], 0
    v_mfma_f32_16x16x32_bf16 v[84:87], v[44:47], v[72:75], 0
    v_mfma_f32_16x16x32_bf16 v[88:91], v[48:51], v[72:75], 0
    v_mfma_f32_16x16x32_bf16 v[92:95], v[24:27], v[72:75], 0
    v_mfma_f32_16x16x32_bf16 v[96:99], v[52:55], v[76:79], 0
    v_mfma_f32_16x16x32_bf16 v[100:103], v[56:59], v[76:79], 0
    v_mfma_f32_16x16x32_bf16 v[104:107], v[60:63], v[76:79], 0
    v_mfma_f32_16x16x32_bf16 v[108:111], v[24:27], v[76:79], 0
    s_nop 3
    v_rcp_f32 v92, v92
    s_nop 2
    v_rcp_f32 v108, v108
    v_fma_f32 v88, v88, v92, v28
    v_fma_f32 v88, v104, v108, v88
    v_rcp_f32 v88, v88
    s_nop 0
    v_mul_f32 v88, v88, v129
    v_mul_f32 v92, v92, v88
    v_mul_f32 v93, v92, 1.0
    v_mul_f32 v108, v108, v88
    v_mul_f32 v109, v108, 1.0
    v_pk_mul_f32 v[132:133], v[80:81], v[92:93]
    v_pk_mul_f32 v[134:135], v[82:83], v[92:93]
    v_pk_mul_f32 v[136:137], v[84:85], v[92:93]
    v_pk_mul_f32 v[138:139], v[86:87], v[92:93]
    v_pk_fma_f32 v[132:133], v[96:97], v[108:109], v[132:133]
    v_pk_fma_f32 v[134:135], v[98:99], v[108:109], v[134:135]
    v_pk_fma_f32 v[136:137], v[100:101], v[108:109], v[136:137]
    v_pk_fma_f32 v[138:139], v[102:103], v[108:109], v[138:139]
    v_cvt_pk_bf16_f32 v148, v132, v133
    v_cvt_pk_bf16_f32 v149, v134, v135
    v_cvt_pk_bf16_f32 v150, v136, v137
    v_cvt_pk_bf16_f32 v151, v138, v139
    buffer_store_dwordx4 v[148:151], v14, s[20:23], s37 offen sc1
    s_add_u32 s37, s37, 90112
    s_waitcnt vmcnt(5)
    v_mfma_f32_16x16x32_bf16 v[64:67], v[32:35], v[120:123], 0
    v_mfma_f32_16x16x32_bf16 v[68:71], v[36:39], v[120:123], 0
    s_nop 6
    v_max3_f32 v80, v64, v65, v66
    v_min3_f32 v81, v64, v65, v66
    v_max3_f32 v80, v80, v67, v68
    v_min3_f32 v81, v81, v67, v68
    v_max3_f32 v80, v80, v69, v70
    v_min3_f32 v81, v81, v69, v70
    v_max_f32 v80, v80, v71
    v_min_f32 v81, v81, v71
    v_sub_f32 v81, 0, v81
    v_mov_b32 v82, v80
    v_mov_b32 v83, v81
    s_nop 0
    v_permlane16_swap_b32 v80, v82
    v_permlane16_swap_b32 v81, v83
    v_max_f32 v80, v80, v82
    v_max_f32 v81, v81, v83
    v_mov_b32 v82, v80
    v_mov_b32 v83, v81
    s_nop 0
    v_permlane32_swap_b32 v80, v82
    v_permlane32_swap_b32 v81, v83
    v_max_f32 v80, v80, v82
    v_max_f32 v81, v81, v83
    v_mul_f32 v84, 0xbfb8aa3b, v80
    v_mul_f32 v85, 0xbfb8aa3b, v80
    v_mul_f32 v86, 0xbfb8aa3b, v81
    v_mul_f32 v87, 0xbfb8aa3b, v81
    v_mov_b32 v88, 0x3fb8aa3b
    v_mov_b32 v89, 0x3fb8aa3b
    v_mov_b32 v90, 0xbfb8aa3b
    v_mov_b32 v91, 0xbfb8aa3b
    v_pk_fma_f32 v[92:93], v[64:65], v[88:89], v[84:85]
    v_pk_fma_f32 v[100:101], v[64:65], v[90:91], v[86:87]
    v_pk_fma_f32 v[94:95], v[66:67], v[88:89], v[84:85]
    v_pk_fma_f32 v[102:103], v[66:67], v[90:91], v[86:87]
    v_pk_fma_f32 v[96:97], v[68:69], v[88:89], v[84:85]
    v_pk_fma_f32 v[104:105], v[68:69], v[90:91], v[86:87]
    v_pk_fma_f32 v[98:99], v[70:71], v[88:89], v[84:85]
    v_pk_fma_f32 v[106:107], v[70:71], v[90:91], v[86:87]
    v_exp_f32 v92, v92
    v_exp_f32 v100, v100
    v_exp_f32 v93, v93
    v_exp_f32 v101, v101
    v_exp_f32 v94, v94
    v_exp_f32 v102, v102
    v_exp_f32 v95, v95
    v_exp_f32 v103, v103
    v_exp_f32 v96, v96
    v_exp_f32 v104, v104
    v_exp_f32 v97, v97
    v_exp_f32 v105, v105
    v_exp_f32 v98, v98
    v_exp_f32 v106, v106
    v_exp_f32 v99, v99
    v_exp_f32 v107, v107
    v_cvt_pk_bf16_f32 v72, v92, v93
    v_cvt_pk_bf16_f32 v76, v100, v101
    v_cvt_pk_bf16_f32 v73, v94, v95
    v_cvt_pk_bf16_f32 v77, v102, v103
    v_cvt_pk_bf16_f32 v74, v96, v97
    v_cvt_pk_bf16_f32 v78, v104, v105
    v_cvt_pk_bf16_f32 v75, v98, v99
    v_cvt_pk_bf16_f32 v79, v106, v107
    s_nop 0
    v_mfma_f32_16x16x32_bf16 v[80:83], v[40:43], v[72:75], 0
    v_mfma_f32_16x16x32_bf16 v[84:87], v[44:47], v[72:75], 0
    v_mfma_f32_16x16x32_bf16 v[88:91], v[48:51], v[72:75], 0
    v_mfma_f32_16x16x32_bf16 v[92:95], v[24:27], v[72:75], 0
    v_mfma_f32_16x16x32_bf16 v[96:99], v[52:55], v[76:79], 0
    v_mfma_f32_16x16x32_bf16 v[100:103], v[56:59], v[76:79], 0
    v_mfma_f32_16x16x32_bf16 v[104:107], v[60:63], v[76:79], 0
    v_mfma_f32_16x16x32_bf16 v[108:111], v[24:27], v[76:79], 0
    s_nop 3
    v_rcp_f32 v92, v92
    s_nop 2
    v_rcp_f32 v108, v108
    v_fma_f32 v88, v88, v92, v28
    v_fma_f32 v88, v104, v108, v88
    v_rcp_f32 v88, v88
    s_nop 0
    v_mul_f32 v88, v88, v130
    v_mul_f32 v92, v92, v88
    v_mul_f32 v93, v92, 1.0
    v_mul_f32 v108, v108, v88
    v_mul_f32 v109, v108, 1.0
    v_pk_mul_f32 v[132:133], v[80:81], v[92:93]
    v_pk_mul_f32 v[134:135], v[82:83], v[92:93]
    v_pk_mul_f32 v[136:137], v[84:85], v[92:93]
    v_pk_mul_f32 v[138:139], v[86:87], v[92:93]
    v_pk_fma_f32 v[132:133], v[96:97], v[108:109], v[132:133]
    v_pk_fma_f32 v[134:135], v[98:99], v[108:109], v[134:135]
    v_pk_fma_f32 v[136:137], v[100:101], v[108:109], v[136:137]
    v_pk_fma_f32 v[138:139], v[102:103], v[108:109], v[138:139]
    v_cvt_pk_bf16_f32 v144, v132, v133
    v_cvt_pk_bf16_f32 v145, v134, v135
    v_cvt_pk_bf16_f32 v146, v136, v137
    v_cvt_pk_bf16_f32 v147, v138, v139
    buffer_store_dwordx4 v[144:147], v14, s[20:23], s37 offen sc1
    s_add_u32 s37, s37, 90112
    s_waitcnt vmcnt(3)
    v_mfma_f32_16x16x32_bf16 v[64:67], v[32:35], v[124:127], 0
    v_mfma_f32_16x16x32_bf16 v[68:71], v[36:39], v[124:127], 0
    s_nop 6
    v_max3_f32 v80, v64, v65, v66
    v_min3_f32 v81, v64, v65, v66
    v_max3_f32 v80, v80, v67, v68
    v_min3_f32 v81, v81, v67, v68
    v_max3_f32 v80, v80, v69, v70
    v_min3_f32 v81, v81, v69, v70
    v_max_f32 v80, v80, v71
    v_min_f32 v81, v81, v71
    v_sub_f32 v81, 0, v81
    v_mov_b32 v82, v80
    v_mov_b32 v83, v81
    s_nop 0
    v_permlane16_swap_b32 v80, v82
    v_permlane16_swap_b32 v81, v83
    v_max_f32 v80, v80, v82
    v_max_f32 v81, v81, v83
    v_mov_b32 v82, v80
    v_mov_b32 v83, v81
    s_nop 0
    v_permlane32_swap_b32 v80, v82
    v_permlane32_swap_b32 v81, v83
    v_max_f32 v80, v80, v82
    v_max_f32 v81, v81, v83
    v_mul_f32 v84, 0xbfb8aa3b, v80
    v_mul_f32 v85, 0xbfb8aa3b, v80
    v_mul_f32 v86, 0xbfb8aa3b, v81
    v_mul_f32 v87, 0xbfb8aa3b, v81
    v_mov_b32 v88, 0x3fb8aa3b
    v_mov_b32 v89, 0x3fb8aa3b
    v_mov_b32 v90, 0xbfb8aa3b
    v_mov_b32 v91, 0xbfb8aa3b
    v_pk_fma_f32 v[92:93], v[64:65], v[88:89], v[84:85]
    v_pk_fma_f32 v[100:101], v[64:65], v[90:91], v[86:87]
    v_pk_fma_f32 v[94:95], v[66:67], v[88:89], v[84:85]
    v_pk_fma_f32 v[102:103], v[66:67], v[90:91], v[86:87]
    v_pk_fma_f32 v[96:97], v[68:69], v[88:89], v[84:85]
    v_pk_fma_f32 v[104:105], v[68:69], v[90:91], v[86:87]
    v_pk_fma_f32 v[98:99], v[70:71], v[88:89], v[84:85]
    v_pk_fma_f32 v[106:107], v[70:71], v[90:91], v[86:87]
    v_exp_f32 v92, v92
    v_exp_f32 v100, v100
    v_exp_f32 v93, v93
    v_exp_f32 v101, v101
    v_exp_f32 v94, v94
    v_exp_f32 v102, v102
    v_exp_f32 v95, v95
    v_exp_f32 v103, v103
    v_exp_f32 v96, v96
    v_exp_f32 v104, v104
    v_exp_f32 v97, v97
    v_exp_f32 v105, v105
    v_exp_f32 v98, v98
    v_exp_f32 v106, v106
    v_exp_f32 v99, v99
    v_exp_f32 v107, v107
    v_cvt_pk_bf16_f32 v72, v92, v93
    v_cvt_pk_bf16_f32 v76, v100, v101
    v_cvt_pk_bf16_f32 v73, v94, v95
    v_cvt_pk_bf16_f32 v77, v102, v103
    v_cvt_pk_bf16_f32 v74, v96, v97
    v_cvt_pk_bf16_f32 v78, v104, v105
    v_cvt_pk_bf16_f32 v75, v98, v99
    v_cvt_pk_bf16_f32 v79, v106, v107
    s_nop 0
    v_mfma_f32_16x16x32_bf16 v[80:83], v[40:43], v[72:75], 0
    v_mfma_f32_16x16x32_bf16 v[84:87], v[44:47], v[72:75], 0
    v_mfma_f32_16x16x32_bf16 v[88:91], v[48:51], v[72:75], 0
    v_mfma_f32_16x16x32_bf16 v[92:95], v[24:27], v[72:75], 0
    v_mfma_f32_16x16x32_bf16 v[96:99], v[52:55], v[76:79], 0
    v_mfma_f32_16x16x32_bf16 v[100:103], v[56:59], v[76:79], 0
    v_mfma_f32_16x16x32_bf16 v[104:107], v[60:63], v[76:79], 0
    v_mfma_f32_16x16x32_bf16 v[108:111], v[24:27], v[76:79], 0
    s_nop 3
    v_rcp_f32 v92, v92
    s_nop 2
    v_rcp_f32 v108, v108
    v_fma_f32 v88, v88, v92, v28
    v_fma_f32 v88, v104, v108, v88
    v_rcp_f32 v88, v88
    s_nop 0
    v_mul_f32 v88, v88, v131
    v_mul_f32 v92, v92, v88
    v_mul_f32 v93, v92, 1.0
    v_mul_f32 v108, v108, v88
    v_mul_f32 v109, v108, 1.0
    v_pk_mul_f32 v[132:133], v[80:81], v[92:93]
    v_pk_mul_f32 v[134:135], v[82:83], v[92:93]
    v_pk_mul_f32 v[136:137], v[84:85], v[92:93]
    v_pk_mul_f32 v[138:139], v[86:87], v[92:93]
    v_pk_fma_f32 v[132:133], v[96:97], v[108:109], v[132:133]
    v_pk_fma_f32 v[134:135], v[98:99], v[108:109], v[134:135]
    v_pk_fma_f32 v[136:137], v[100:101], v[108:109], v[136:137]
    v_pk_fma_f32 v[138:139], v[102:103], v[108:109], v[138:139]
    v_cvt_pk_bf16_f32 v148, v132, v133
    v_cvt_pk_bf16_f32 v149, v134, v135
    v_cvt_pk_bf16_f32 v150, v136, v137
    v_cvt_pk_bf16_f32 v151, v138, v139
    buffer_store_dwordx4 v[148:151], v14, s[20:23], s37 offen sc1
    s_add_u32 s37, s37, 90112
L_s2_kernel_fin:
L_s2_kernel_end:
    s_endpgm
.section .rodata,"a"
.p2align 6
.amdhsa_kernel s2_kernel
  .amdhsa_next_free_vgpr 192
  .amdhsa_next_free_sgpr 64
  .amdhsa_accum_offset 192
  .amdhsa_group_segment_fixed_size 0
  .amdhsa_kernarg_size 104
  .amdhsa_user_sgpr_count 2
  .amdhsa_user_sgpr_kernarg_segment_ptr 1
  .amdhsa_system_sgpr_workgroup_id_x 1
  .amdhsa_float_denorm_mode_32 3
.end_amdhsa_kernel
.text
.text
.globl s3_kernel
.p2align 8
.type s3_kernel,@function
s3_kernel:
    s_cmp_ge_u32 s2, 256
    s_cbranch_scc1 L_s3_kernel_end
    s_load_dwordx2 s[28:29], s[0:1], 80
    s_load_dwordx2 s[34:35], s[0:1], 96
    v_lshrrev_b32 v2, 6, v0
    v_and_b32 v1, 63, v0
    v_readfirstlane_b32 s20, v2
    s_and_b32 s3, s2, 7
    s_lshr_b32 s36, s2, 3
    s_lshr_b32 s37, s3, 1
    s_lshl_b32 s37, s37, 2
    s_and_b32 s38, s36, 3
    s_add_u32 s32, s37, s38
    s_and_b32 s37, s3, 1
    s_lshl_b32 s37, s37, 3
    s_lshr_b32 s38, s36, 2
    s_add_u32 s33, s37, s38
    s_and_b32 s21, s20, 3
    s_lshr_b32 s22, s20, 2
    s_lshl_b32 s36, s32, 3
    s_lshl_b32 s37, s21, 1
    s_add_u32 s36, s36, s37
    s_mul_i32 s36, s36, 88
    s_add_u32 s36, s36, s22
    s_lshl_b32 s36, s36, 10
    v_lshlrev_b32 v2, 4, v1
    v_add_u32 v5, s36, v2
    v_add_u32 v6, 90112, v5
    s_mul_i32 s36, s33, 360448
    s_lshl_b32 s27, s20, 10
    s_add_u32 s36, s36, s27
    v_add_u32 v7, s36, v2
    s_mov_b32 s24, 0
    s_mov_b32 s25, 0
    s_waitcnt lgkmcnt(0)
    s_mov_b32 s8, s34
    s_mov_b32 s9, s35
    s_mov_b32 s10, 11534336
    s_mov_b32 s11, 0x20000
    s_add_u32 s12, s34, 33824768
    s_addc_u32 s13, s35, 0
    s_mov_b32 s14, 5767168
    s_mov_b32 s15, 0x20000
    s_add_u32 m0, s27, 0
    s_nop 0
    buffer_load_dwordx4 v7, s[12:15], s25 offen lds
    s_add_u32 s25, s25, 8192
    buffer_load_dwordx4 v[80:83], v5, s[8:11], s24 offen
    buffer_load_dwordx4 v[84:87], v6, s[8:11], s24 offen
    s_add_u32 s24, s24, 2048
    s_add_u32 m0, s27, 8192
    s_nop 0
    buffer_load_dwordx4 v7, s[12:15], s25 offen lds
    s_add_u32 s25, s25, 8192
    buffer_load_dwordx4 v[88:91], v5, s[8:11], s24 offen
    buffer_load_dwordx4 v[92:95], v6, s[8:11], s24 offen
    s_add_u32 s24, s24, 2048
    v_lshrrev_b32 v2, 2, v1
    v_bfe_u32 v3, v1, 3, 2
    v_lshlrev_b32 v2, 7, v2
    v_and_b32 v4, 3, v1
    v_lshlrev_b32 v4, 3, v4
    v_add_u32 v2, v2, v4
    s_lshl_b32 s36, s22, 12
    v_add_u32 v2, s36, v2
    v_xor_b32 v4, 0, v3
    v_lshlrev_b32 v4, 5, v4
    v_add_u32 v8, v2, v4
    v_xor_b32 v4, 1, v3
    v_lshlrev_b32 v4, 5, v4
    v_add_u32 v9, v2, v4
    v_xor_b32 v4, 2, v3
    v_lshlrev_b32 v4, 5, v4
    v_add_u32 v10, v2, v4
    v_xor_b32 v4, 3, v3
    v_lshlrev_b32 v4, 5, v4
    v_add_u32 v11, v2, v4
    v_mov_b32 v16, 0
    v_mov_b32 v17, 0
    v_mov_b32 v18, 0
    v_mov_b32 v19, 0
    v_mov_b32 v20, 0
    v_mov_b32 v21, 0
    v_mov_b32 v22, 0
    v_mov_b32 v23, 0
    v_mov_b32 v24, 0
    v_mov_b32 v25, 0
    v_mov_b32 v26, 0
    v_mov_b32 v27, 0
    v_mov_b32 v28, 0
    v_mov_b32 v29, 0
    v_mov_b32 v30, 0
    v_mov_b32 v31, 0
    v_mov_b32 v32, 0
    v_mov_b32 v33, 0
    v_mov_b32 v34, 0
    v_mov_b32 v35, 0
    v_mov_b32 v36, 0
    v_mov_b32 v37, 0
    v_mov_b32 v38, 0
    v_mov_b32 v39, 0
    v_mov_b32 v40, 0
    v_mov_b32 v41, 0
    v_mov_b32 v42, 0
    v_mov_b32 v43, 0
    v_mov_b32 v44, 0
    v_mov_b32 v45, 0
    v_mov_b32 v46, 0
    v_mov_b32 v47, 0
    s_mov_b32 s16, s28
    s_mov_b32 s17, s29
    s_mov_b32 s18, 4194304
    s_mov_b32 s19, 0x20000
    s_waitcnt vmcnt(5)
    s_barrier
    ds_read_b64_tr_b16 v[48:49], v8 offset:0
    ds_read_b64_tr_b16 v[50:51], v8 offset:2048
    ds_read_b64_tr_b16 v[52:53], v9 offset:0
    ds_read_b64_tr_b16 v[54:55], v9 offset:2048
    ds_read_b64_tr_b16 v[56:57], v10 offset:0
    ds_read_b64_tr_b16 v[58:59], v10 offset:2048
    ds_read_b64_tr_b16 v[60:61], v11 offset:0
    ds_read_b64_tr_b16 v[62:63], v11 offset:2048
    s_waitcnt vmcnt(2) lgkmcnt(0)
    s_barrier
    v_mfma_f32_16x16x32_bf16 v[16:19], v[48:51], v[80:83], v[16:19]
    ds_read_b64_tr_b16 v[64:65], v8 offset:8192
    ds_read_b64_tr_b16 v[66:67], v8 offset:10240
    s_add_u32 m0, s27, 16384
    v_mfma_f32_16x16x32_bf16 v[20:23], v[52:55], v[80:83], v[20:23]
    buffer_load_dwordx4 v7, s[12:15], s25 offen lds
    s_add_u32 s25, s25, 8192
    ds_read_b64_tr_b16 v[68:69], v9 offset:8192
    ds_read_b64_tr_b16 v[70:71], v9 offset:10240
    v_mfma_f32_16x16x32_bf16 v[24:27], v[56:59], v[80:83], v[24:27]
    ds_read_b64_tr_b16 v[72:73], v10 offset:8192
    ds_read_b64_tr_b16 v[74:75], v10 offset:10240
    s_add_u32 m0, s27, 24576
    v_mfma_f32_16x16x32_bf16 v[28:31], v[60:63], v[80:83], v[28:31]
    buffer_load_dwordx4 v7, s[12:15], s25 offen lds
    s_add_u32 s25, s25, 8192
    ds_read_b64_tr_b16 v[76:77], v11 offset:8192
    ds_read_b64_tr_b16 v[78:79], v11 offset:10240
    s_add_u32 m0, s27, 0
    v_mfma_f32_16x16x32_bf16 v[44:47], v[60:63], v[84:87], v[44:47]
    buffer_load_dwordx4 v7, s[12:15], s25 offen lds
    s_add_u32 s25, s25, 8192
    v_mfma_f32_16x16x32_bf16 v[40:43], v[56:59], v[84:87], v[40:43]
    v_mfma_f32_16x16x32_bf16 v[36:39], v[52:55], v[84:87], v[36:39]
    v_mfma_f32_16x16x32_bf16 v[32:35], v[48:51], v[84:87], v[32:35]
    buffer_load_dwordx4 v[96:99], v5, s[8:11], s24 offen
    buffer_load_dwordx4 v[100:103], v6, s[8:11], s24 offen
    s_add_u32 s24, s24, 2048
    buffer_load_dwordx4 v[104:107], v5, s[8:11], s24 offen
    buffer_load_dwordx4 v[108:111], v6, s[8:11], s24 offen
    s_add_u32 s24, s24, 2048
    buffer_load_dwordx4 v[80:83], v5, s[8:11], s24 offen
    buffer_load_dwordx4 v[84:87], v6, s[8:11], s24 offen
    s_add_u32 s24, s24, 2048
    s_waitcnt vmcnt(8) lgkmcnt(0)
    s_barrier
    s_mov_b32 s23, 0
.p2align 6
L_s3_kernel_loop:
    v_mfma_f32_16x16x32_bf16 v[16:19], v[64:67], v[88:91], v[16:19]
    ds_read_b64_tr_b16 v[48:49], v8 offset:16384
    ds_read_b64_tr_b16 v[50:51], v8 offset:18432
    s_add_u32 m0, s27, 8192
    v_mfma_f32_16x16x32_bf16 v[20:23], v[68:71], v[88:91], v[20:23]
    buffer_load_dwordx4 v7, s[12:15], s25 offen lds
    s_add_u32 s25, s25, 8192
    ds_read_b64_tr_b16 v[52:53], v9 offset:16384
    ds_read_b64_tr_b16 v[54:55], v9 offset:18432
    v_mfma_f32_16x16x32_bf16 v[24:27], v[72:75], v[88:91], v[24:27]
    ds_read_b64_tr_b16 v[56:57], v10 offset:16384
    ds_read_b64_tr_b16 v[58:59], v10 offset:18432
    v_mfma_f32_16x16x32_bf16 v[28:31], v[76:79], v[88:91], v[28:31]
    ds_read_b64_tr_b16 v[60:61], v11 offset:16384
    ds_read_b64_tr_b16 v[62:63], v11 offset:18432
    v_mfma_f32_16x16x32_bf16 v[44:47], v[76:79], v[92:95], v[44:47]
    v_mfma_f32_16x16x32_bf16 v[40:43], v[72:75], v[92:95], v[40:43]
    v_mfma_f32_16x16x32_bf16 v[36:39], v[68:71], v[92:95], v[36:39]
    v_mfma_f32_16x16x32_bf16 v[32:35], v[64:67], v[92:95], v[32:35]
    buffer_load_dwordx4 v[88:91], v5, s[8:11], s24 offen
    buffer_load_dwordx4 v[92:95], v6, s[8:11], s24 offen
    s_add_u32 s24, s24, 2048
    s_waitcnt vmcnt(7) lgkmcnt(0)
    s_barrier
    v_mfma_f32_16x16x32_bf16 v[16:19], v[48:51], v[96:99], v[16:19]
    ds_read_b64_tr_b16 v[64:65], v8 offset:24576
    ds_read_b64_tr_b16 v[66:67], v8 offset:26624
    s_add_u32 m0, s27, 16384
    v_mfma_f32_16x16x32_bf16 v[20:23], v[52:55], v[96:99], v[20:23]
    buffer_load_dwordx4 v7, s[12:15], s25 offen lds
    s_add_u32 s25, s25, 8192
    ds_read_b64_tr_b16 v[68:69], v9 offset:24576
    ds_read_b64_tr_b16 v[70:71], v9 offset:26624
    v_mfma_f32_16x16x32_bf16 v[24:27], v[56:59], v[96:99], v[24:27]
    ds_read_b64_tr_b16 v[72:73], v10 offset:24576
    ds_read_b64_tr_b16 v[74:75], v10 offset:26624
    v_mfma_f32_16x16x32_bf16 v[28:31], v[60:63], v[96:99], v[28:31]
    ds_read_b64_tr_b16 v[76:77], v11 offset:24576
    ds_read_b64_tr_b16 v[78:79], v11 offset:26624
    v_mfma_f32_16x16x32_bf16 v[44:47], v[60:63], v[100:103], v[44:47]
    v_mfma_f32_16x16x32_bf16 v[40:43], v[56:59], v[100:103], v[40:43]
    v_mfma_f32_16x16x32_bf16 v[36:39], v[52:55], v[100:103], v[36:39]
    v_mfma_f32_16x16x32_bf16 v[32:35], v[48:51], v[100:103], v[32:35]
    buffer_load_dwordx4 v[96:99], v5, s[8:11], s24 offen
    buffer_load_dwordx4 v[100:103], v6, s[8:11], s24 offen
    s_add_u32 s24, s24, 2048
    s_waitcnt vmcnt(8) lgkmcnt(0)
    s_barrier
    v_mfma_f32_16x16x32_bf16 v[16:19], v[64:67], v[104:107], v[16:19]
    ds_read_b64_tr_b16 v[48:49], v8 offset:0
    ds_read_b64_tr_b16 v[50:51], v8 offset:2048
    s_add_u32 m0, s27, 24576
    v_mfma_f32_16x16x32_bf16 v[20:23], v[68:71], v[104:107], v[20:23]
    buffer_load_dwordx4 v7, s[12:15], s25 offen lds
    s_add_u32 s25, s25, 8192
    ds_read_b64_tr_b16 v[52:53], v9 offset:0
    ds_read_b64_tr_b16 v[54:55], v9 offset:2048
    v_mfma_f32_16x16x32_bf16 v[24:27], v[72:75], v[104:107], v[24:27]
    ds_read_b64_tr_b16 v[56:57], v10 offset:0
    ds_read_b64_tr_b16 v[58:59], v10 offset:2048
    v_mfma_f32_16x16x32_bf16 v[28:31], v[76:79], v[104:107], v[28:31]
    ds_read_b64_tr_b16 v[60:61], v11 offset:0
    ds_read_b64_tr_b16 v[62:63], v11 offset:2048
    v_mfma_f32_16x16x32_bf16 v[44:47], v[76:79], v[108:111], v[44:47]
    v_mfma_f32_16x16x32_bf16 v[40:43], v[72:75], v[108:111], v[40:43]
    v_mfma_f32_16x16x32_bf16 v[36:39], v[68:71], v[108:111], v[36:39]
    v_mfma_f32_16x16x32_bf16 v[32:35], v[64:67], v[108:111], v[32:35]
    buffer_load_dwordx4 v[104:107], v5, s[8:11], s24 offen
    buffer_load_dwordx4 v[108:111], v6, s[8:11], s24 offen
    s_add_u32 s24, s24, 2048
    s_waitcnt vmcnt(8) lgkmcnt(0)
    s_barrier
    v_mfma_f32_16x16x32_bf16 v[16:19], v[48:51], v[80:83], v[16:19]
    ds_read_b64_tr_b16 v[64:65], v8 offset:8192
    ds_read_b64_tr_b16 v[66:67], v8 offset:10240
    s_add_u32 m0, s27, 0
    v_mfma_f32_16x16x32_bf16 v[20:23], v[52:55], v[80:83], v[20:23]
    buffer_load_dwordx4 v7, s[12:15], s25 offen lds
    s_add_u32 s25, s25, 8192
    ds_read_b64_tr_b16 v[68:69], v9 offset:8192
    ds_read_b64_tr_b16 v[70:71], v9 offset:10240
    v_mfma_f32_16x16x32_bf16 v[24:27], v[56:59], v[80:83], v[24:27]
    ds_read_b64_tr_b16 v[72:73], v10 offset:8192
    ds_read_b64_tr_b16 v[74:75], v10 offset:10240
    v_mfma_f32_16x16x32_bf16 v[28:31], v[60:63], v[80:83], v[28:31]
    ds_read_b64_tr_b16 v[76:77], v11 offset:8192
    ds_read_b64_tr_b16 v[78:79], v11 offset:10240
    v_mfma_f32_16x16x32_bf16 v[44:47], v[60:63], v[84:87], v[44:47]
    v_mfma_f32_16x16x32_bf16 v[40:43], v[56:59], v[84:87], v[40:43]
    v_mfma_f32_16x16x32_bf16 v[36:39], v[52:55], v[84:87], v[36:39]
    v_mfma_f32_16x16x32_bf16 v[32:35], v[48:51], v[84:87], v[32:35]
    buffer_load_dwordx4 v[80:83], v5, s[8:11], s24 offen
    buffer_load_dwordx4 v[84:87], v6, s[8:11], s24 offen
    s_add_u32 s24, s24, 2048
    s_waitcnt vmcnt(8) lgkmcnt(0)
    s_barrier
    s_add_u32 s23, s23, 1
    s_cmp_lt_u32 s23, 9
    s_cbranch_scc1 L_s3_kernel_loop
    v_mfma_f32_16x16x32_bf16 v[16:19], v[64:67], v[88:91], v[16:19]
    ds_read_b64_tr_b16 v[48:49], v8 offset:16384
    ds_read_b64_tr_b16 v[50:51], v8 offset:18432
    s_add_u32 m0, s27, 8192
    v_mfma_f32_16x16x32_bf16 v[20:23], v[68:71], v[88:91], v[20:23]
    buffer_load_dwordx4 v7, s[12:15], s25 offen lds
    s_add_u32 s25, s25, 8192
    ds_read_b64_tr_b16 v[52:53], v9 offset:16384
    ds_read_b64_tr_b16 v[54:55], v9 offset:18432
    v_mfma_f32_16x16x32_bf16 v[24:27], v[72:75], v[88:91], v[24:27]
    ds_read_b64_tr_b16 v[56:57], v10 offset:16384
    ds_read_b64_tr_b16 v[58:59], v10 offset:18432
    v_mfma_f32_16x16x32_bf16 v[28:31], v[76:79], v[88:91], v[28:31]
    ds_read_b64_tr_b16 v[60:61], v11 offset:16384
    ds_read_b64_tr_b16 v[62:63], v11 offset:18432
    v_mfma_f32_16x16x32_bf16 v[44:47], v[76:79], v[92:95], v[44:47]
    v_mfma_f32_16x16x32_bf16 v[40:43], v[72:75], v[92:95], v[40:43]
    v_mfma_f32_16x16x32_bf16 v[36:39], v[68:71], v[92:95], v[36:39]
    v_mfma_f32_16x16x32_bf16 v[32:35], v[64:67], v[92:95], v[32:35]
    buffer_load_dwordx4 v[88:91], v5, s[8:11], s24 offen
    buffer_load_dwordx4 v[92:95], v6, s[8:11], s24 offen
    s_add_u32 s24, s24, 2048
    s_waitcnt vmcnt(8) lgkmcnt(0)
    s_barrier
    v_mfma_f32_16x16x32_bf16 v[16:19], v[48:51], v[96:99], v[16:19]
    ds_read_b64_tr_b16 v[64:65], v8 offset:24576
    ds_read_b64_tr_b16 v[66:67], v8 offset:26624
    s_add_u32 m0, s27, 16384
    v_mfma_f32_16x16x32_bf16 v[20:23], v[52:55], v[96:99], v[20:23]
    buffer_load_dwordx4 v7, s[12:15], s25 offen lds
    s_add_u32 s25, s25, 8192
    ds_read_b64_tr_b16 v[68:69], v9 offset:24576
    ds_read_b64_tr_b16 v[70:71], v9 offset:26624
    v_mfma_f32_16x16x32_bf16 v[24:27], v[56:59], v[96:99], v[24:27]
    ds_read_b64_tr_b16 v[72:73], v10 offset:24576
    ds_read_b64_tr_b16 v[74:75], v10 offset:26624
    v_mfma_f32_16x16x32_bf16 v[28:31], v[60:63], v[96:99], v[28:31]
    ds_read_b64_tr_b16 v[76:77], v11 offset:24576
    ds_read_b64_tr_b16 v[78:79], v11 offset:26624
    v_mfma_f32_16x16x32_bf16 v[44:47], v[60:63], v[100:103], v[44:47]
    v_mfma_f32_16x16x32_bf16 v[40:43], v[56:59], v[100:103], v[40:43]
    v_mfma_f32_16x16x32_bf16 v[36:39], v[52:55], v[100:103], v[36:39]
    v_mfma_f32_16x16x32_bf16 v[32:35], v[48:51], v[100:103], v[32:35]
    buffer_load_dwordx4 v[96:99], v5, s[8:11], s24 offen
    buffer_load_dwordx4 v[100:103], v6, s[8:11], s24 offen
    s_add_u32 s24, s24, 2048
    s_waitcnt vmcnt(8) lgkmcnt(0)
    s_barrier
    v_mfma_f32_16x16x32_bf16 v[16:19], v[64:67], v[104:107], v[16:19]
    ds_read_b64_tr_b16 v[48:49], v8 offset:0
    ds_read_b64_tr_b16 v[50:51], v8 offset:2048
    s_add_u32 m0, s27, 24576
    v_mfma_f32_16x16x32_bf16 v[20:23], v[68:71], v[104:107], v[20:23]
    buffer_load_dwordx4 v7, s[12:15], s25 offen lds
    s_add_u32 s25, s25, 8192
    ds_read_b64_tr_b16 v[52:53], v9 offset:0
    ds_read_b64_tr_b16 v[54:55], v9 offset:2048
    v_mfma_f32_16x16x32_bf16 v[24:27], v[72:75], v[104:107], v[24:27]
    ds_read_b64_tr_b16 v[56:57], v10 offset:0
    ds_read_b64_tr_b16 v[58:59], v10 offset:2048
    v_mfma_f32_16x16x32_bf16 v[28:31], v[76:79], v[104:107], v[28:31]
    ds_read_b64_tr_b16 v[60:61], v11 offset:0
    ds_read_b64_tr_b16 v[62:63], v11 offset:2048
    v_mfma_f32_16x16x32_bf16 v[44:47], v[76:79], v[108:111], v[44:47]
    v_mfma_f32_16x16x32_bf16 v[40:43], v[72:75], v[108:111], v[40:43]
    v_mfma_f32_16x16x32_bf16 v[36:39], v[68:71], v[108:111], v[36:39]
    v_mfma_f32_16x16x32_bf16 v[32:35], v[64:67], v[108:111], v[32:35]
    buffer_load_dwordx4 v[104:107], v5, s[8:11], s24 offen
    buffer_load_dwordx4 v[108:111], v6, s[8:11], s24 offen
    s_add_u32 s24, s24, 2048
    s_waitcnt vmcnt(8) lgkmcnt(0)
    s_barrier
    v_mfma_f32_16x16x32_bf16 v[16:19], v[48:51], v[80:83], v[16:19]
    ds_read_b64_tr_b16 v[64:65], v8 offset:8192
    ds_read_b64_tr_b16 v[66:67], v8 offset:10240
    v_mfma_f32_16x16x32_bf16 v[20:23], v[52:55], v[80:83], v[20:23]
    ds_read_b64_tr_b16 v[68:69], v9 offset:8192
    ds_read_b64_tr_b16 v[70:71], v9 offset:10240
    v_mfma_f32_16x16x32_bf16 v[24:27], v[56:59], v[80:83], v[24:27]
    ds_read_b64_tr_b16 v[72:73], v10 offset:8192
    ds_read_b64_tr_b16 v[74:75], v10 offset:10240
    v_mfma_f32_16x16x32_bf16 v[28:31], v[60:63], v[80:83], v[28:31]
    ds_read_b64_tr_b16 v[76:77], v11 offset:8192
    ds_read_b64_tr_b16 v[78:79], v11 offset:10240
    v_mfma_f32_16x16x32_bf16 v[44:47], v[60:63], v[84:87], v[44:47]
    v_mfma_f32_16x16x32_bf16 v[40:43], v[56:59], v[84:87], v[40:43]
    v_mfma_f32_16x16x32_bf16 v[36:39], v[52:55], v[84:87], v[36:39]
    v_mfma_f32_16x16x32_bf16 v[32:35], v[48:51], v[84:87], v[32:35]
    s_waitcnt vmcnt(5) lgkmcnt(0)
    s_barrier
    v_mfma_f32_16x16x32_bf16 v[16:19], v[64:67], v[88:91], v[16:19]
    ds_read_b64_tr_b16 v[48:49], v8 offset:16384
    ds_read_b64_tr_b16 v[50:51], v8 offset:18432
    v_mfma_f32_16x16x32_bf16 v[20:23], v[68:71], v[88:91], v[20:23]
    ds_read_b64_tr_b16 v[52:53], v9 offset:16384
    ds_read_b64_tr_b16 v[54:55], v9 offset:18432
    v_mfma_f32_16x16x32_bf16 v[24:27], v[72:75], v[88:91], v[24:27]
    ds_read_b64_tr_b16 v[56:57], v10 offset:16384
    ds_read_b64_tr_b16 v[58:59], v10 offset:18432
    v_mfma_f32_16x16x32_bf16 v[28:31], v[76:79], v[88:91], v[28:31]
    ds_read_b64_tr_b16 v[60:61], v11 offset:16384
    ds_read_b64_tr_b16 v[62:63], v11 offset:18432
    v_mfma_f32_16x16x32_bf16 v[44:47], v[76:79], v[92:95], v[44:47]
    v_mfma_f32_16x16x32_bf16 v[40:43], v[72:75], v[92:95], v[40:43]
    v_mfma_f32_16x16x32_bf16 v[36:39], v[68:71], v[92:95], v[36:39]
    v_mfma_f32_16x16x32_bf16 v[32:35], v[64:67], v[92:95], v[32:35]
    s_waitcnt vmcnt(2) lgkmcnt(0)
    s_barrier
    v_mfma_f32_16x16x32_bf16 v[16:19], v[48:51], v[96:99], v[16:19]
    ds_read_b64_tr_b16 v[64:65], v8 offset:24576
    ds_read_b64_tr_b16 v[66:67], v8 offset:26624
    v_mfma_f32_16x16x32_bf16 v[20:23], v[52:55], v[96:99], v[20:23]
    ds_read_b64_tr_b16 v[68:69], v9 offset:24576
    ds_read_b64_tr_b16 v[70:71], v9 offset:26624
    v_mfma_f32_16x16x32_bf16 v[24:27], v[56:59], v[96:99], v[24:27]
    ds_read_b64_tr_b16 v[72:73], v10 offset:24576
    ds_read_b64_tr_b16 v[74:75], v10 offset:26624
    v_mfma_f32_16x16x32_bf16 v[28:31], v[60:63], v[96:99], v[28:31]
    ds_read_b64_tr_b16 v[76:77], v11 offset:24576
    ds_read_b64_tr_b16 v[78:79], v11 offset:26624
    v_mfma_f32_16x16x32_bf16 v[44:47], v[60:63], v[100:103], v[44:47]
    v_mfma_f32_16x16x32_bf16 v[40:43], v[56:59], v[100:103], v[40:43]
    v_mfma_f32_16x16x32_bf16 v[36:39], v[52:55], v[100:103], v[36:39]
    v_mfma_f32_16x16x32_bf16 v[32:35], v[48:51], v[100:103], v[32:35]
    s_waitcnt vmcnt(0) lgkmcnt(0)
    s_barrier
    v_mfma_f32_16x16x32_bf16 v[16:19], v[64:67], v[104:107], v[16:19]
    v_mfma_f32_16x16x32_bf16 v[20:23], v[68:71], v[104:107], v[20:23]
    v_mfma_f32_16x16x32_bf16 v[24:27], v[72:75], v[104:107], v[24:27]
    v_mfma_f32_16x16x32_bf16 v[28:31], v[76:79], v[104:107], v[28:31]
    v_mfma_f32_16x16x32_bf16 v[44:47], v[76:79], v[108:111], v[44:47]
    v_mfma_f32_16x16x32_bf16 v[40:43], v[72:75], v[108:111], v[40:43]
    v_mfma_f32_16x16x32_bf16 v[36:39], v[68:71], v[108:111], v[36:39]
    v_mfma_f32_16x16x32_bf16 v[32:35], v[64:67], v[108:111], v[32:35]
    v_and_b32 v2, 15, v1
    s_lshl_b32 s36, s21, 5
    s_lshl_b32 s37, s22, 7
    s_add_u32 s36, s36, s37
    v_add_u32 v2, s36, v2
    v_mul_u32_u24 v2, 272, v2
    v_lshrrev_b32 v3, 4, v1
    v_lshlrev_b32 v3, 4, v3
    v_add_u32 v2, v2, v3
    ds_write_b128 v2, v[16:19] offset:0
    ds_write_b128 v2, v[20:23] offset:64
    ds_write_b128 v2, v[24:27] offset:128
    ds_write_b128 v2, v[28:31] offset:192
    ds_write_b128 v2, v[32:35] offset:4352
    ds_write_b128 v2, v[36:39] offset:4416
    ds_write_b128 v2, v[40:43] offset:4480
    ds_write_b128 v2, v[44:47] offset:4544
    v_lshrrev_b32 v3, 3, v1
    s_lshl_b32 s36, s20, 4
    v_add_u32 v3, s36, v3
    v_mul_u32_u24 v4, 272, v3
    v_and_b32 v2, 7, v1
    v_lshlrev_b32 v5, 5, v2
    v_add_u32 v4, v4, v5
    s_lshl_b32 s36, s32, 7
    v_add_u32 v3, s36, v3
    v_lshlrev_b32 v3, 11, v3
    v_lshlrev_b32 v2, 4, v2
    v_add_u32 v3, v3, v2
    s_lshl_b32 s36, s33, 7
    v_add_u32 v3, s36, v3
    s_waitcnt lgkmcnt(0)
    s_barrier
    ds_read_b128 v[48:51], v4 offset:0
    ds_read_b128 v[52:55], v4 offset:16
    ds_read_b128 v[56:59], v4 offset:34816
    ds_read_b128 v[60:63], v4 offset:34832
    ds_read_b128 v[64:67], v4 offset:2176
    ds_read_b128 v[68:71], v4 offset:2192
    ds_read_b128 v[72:75], v4 offset:36992
    ds_read_b128 v[76:79], v4 offset:37008
    s_waitcnt lgkmcnt(4)
    v_pk_add_f32 v[48:49], v[48:49], v[56:57]
    v_pk_add_f32 v[50:51], v[50:51], v[58:59]
    v_pk_add_f32 v[52:53], v[52:53], v[60:61]
    v_pk_add_f32 v[54:55], v[54:55], v[62:63]
    v_cvt_pk_bf16_f32 v56, v48, v49
    v_cvt_pk_bf16_f32 v57, v50, v51
    v_cvt_pk_bf16_f32 v58, v52, v53
    v_cvt_pk_bf16_f32 v59, v54, v55
    buffer_store_dwordx4 v[56:59], v3, s[16:19], 0 offen sc1
    v_add_u32 v3, 16384, v3
    s_waitcnt lgkmcnt(0)
    v_pk_add_f32 v[64:65], v[64:65], v[72:73]
    v_pk_add_f32 v[66:67], v[66:67], v[74:75]
    v_pk_add_f32 v[68:69], v[68:69], v[76:77]
    v_pk_add_f32 v[70:71], v[70:71], v[78:79]
    v_cvt_pk_bf16_f32 v72, v64, v65
    v_cvt_pk_bf16_f32 v73, v66, v67
    v_cvt_pk_bf16_f32 v74, v68, v69
    v_cvt_pk_bf16_f32 v75, v70, v71
    buffer_store_dwordx4 v[72:75], v3, s[16:19], 0 offen sc1
    s_endpgm
L_s3_kernel_end:
    s_endpgm
.section .rodata,"a"
.p2align 6
.amdhsa_kernel s3_kernel
  .amdhsa_next_free_vgpr 112
  .amdhsa_next_free_sgpr 48
  .amdhsa_accum_offset 112
  .amdhsa_group_segment_fixed_size 0
  .amdhsa_kernarg_size 104
  .amdhsa_user_sgpr_count 2
  .amdhsa_user_sgpr_kernarg_segment_ptr 1
  .amdhsa_system_sgpr_workgroup_id_x 1
  .amdhsa_float_denorm_mode_32 3
.end_amdhsa_kernel
.text
L_text_end:
```
